```python
import torch

def _softmax(x, axis=-1):
    return torch.softmax(x, dim=axis)
def _gelu(x):
    return torch.nn.functional.gelu(x, approximate="tanh")
def _silu(x):
    return torch.nn.functional.silu(x)
def _sigmoid(x):
    return torch.sigmoid(x)
def _layernorm(x, axis=-1, eps=1e-5):
    m = x.mean(dim=axis, keepdim=True)
    v = x.var(dim=axis, keepdim=True, unbiased=False)
    return (x - m) / torch.sqrt(v + eps)
def _scatter_add(tgt, idx, src, axis=0):
    return tgt.clone().index_add_(axis, idx, src)
def _segment_sum(src, seg, n):
    out = torch.zeros((n,) + src.shape[1:], dtype=src.dtype)
    return out.index_add_(0, seg, src)
def _pad(x, pw):
    flat = tuple(v for pair in reversed(pw) for v in pair)
    return torch.nn.functional.pad(x, flat)

kernel_name = 'standalone__mha_softmax__near_ridge'

def setup_inputs():

    _w = (lambda a: (lambda t: t.to(torch.bfloat16) if t.is_floating_point() else t)(torch.as_tensor(a)))
    B, H, Sq, Sk, D = 16, 32, 384, 512, 192
    return {
        "q": _w((lambda *s: torch.randn(*s, dtype=torch.bfloat16) * 0.8)(B, H, Sq, D)),
        "k": _w((lambda *s: torch.randn(*s, dtype=torch.bfloat16) * 0.8)(B, H, Sk, D)),
        "v": _w((lambda *s: torch.randn(*s, dtype=torch.bfloat16) * 0.05)(B, H, Sk, D)),
    }

def reference(q, k, v):
    scale = q.shape[-1] ** -0.5
    scores = torch.einsum("bhqd,bhkd->bhqk", q, k) * scale
    p = _softmax(scores, axis=-1)
    return torch.einsum("bhqk,bhkd->bhqd", p, v)
```

```asm
; @launch grid=(256,1,1) block=(256,1,1) lds=163840
.amdgcn_target "amdgcn-amd-amdhsa--gfx950"
.text
.globl standalone__mha_softmax__near_ridge_kernel
.p2align 8
.type standalone__mha_softmax__near_ridge_kernel,@function
standalone__mha_softmax__near_ridge_kernel:
  s_cmp_ge_u32 s2, 256
  s_cbranch_scc1 L_done
  s_load_dwordx4 s[4:7], s[0:1], 0
  s_load_dwordx4 s[40:43], s[0:1], 16
  v_lshrrev_b32 v24, 6, v0
  v_and_b32 v25, 63, v0
  v_readfirstlane_b32 s24, v24
  s_nop 0
  s_getpc_b64 s[44:45]
L_gp:
  s_lshr_b32 s46, s2, 3
  s_and_b32 s46, s46, 31
  s_lshl_b32 s46, s46, 2
  s_add_u32 s46, s46, s24
  s_mul_i32 s46, s46, 6
  v_min_u32 v34, 5, v25
  v_add_u32 v34, s46, v34
  v_lshlrev_b32 v34, 6, v34
  v_min_u32 v34, L_done-L_gp, v34
  global_load_dword v250, v34, s[44:45]
  v_lshrrev_b32 v28, 3, v25
  v_lshl_add_u32 v29, v24, 3, v28
  v_bfe_u32 v30, v29, 3, 1
  v_and_b32 v31, 2, v29
  v_lshrrev_b32 v32, 1, v29
  v_xor_b32 v32, v32, v29
  v_and_b32 v32, 4, v32
  v_or3_b32 v30, v30, v31, v32
  v_and_b32 v31, 7, v25
  v_xor_b32 v31, v31, v30
  v_lshlrev_b32 v31, 4, v31
  v_mul_u32_u24 v32, 384, v28
  v_add_u32 v8, v31, v32
  v_xor_b32 v23, 0x50, v8
  s_lshl_b32 s25, s24, 10
  s_mul_i32 s36, s24, 12288
  s_add_u32 s36, s36, 98304
  s_and_b32 s3, s2, 7
  s_lshl_b32 s3, s3, 6
  s_lshr_b32 s35, s2, 3
  s_add_u32 s3, s3, s35
  s_mul_i32 s28, s3, 147456
  s_mul_i32 s35, s24, 36864
  s_add_u32 s28, s28, s35
  s_mul_i32 s53, s3, 196608
  s_mul_i32 s35, s24, 3072
  s_add_u32 s26, s53, s35
  s_mov_b32 s56, s26
  s_mov_b32 s58, s26
  s_add_u32 s57, s26, 196608
  s_mov_b32 s59, s57
  s_lshr_b32 s35, s2, 3
  s_mul_i32 s35, s35, 1
  s_and_b32 s37, s2, 7
  s_mul_i32 s37, s37, 2
  s_add_u32 s35, s35, s37
  s_and_b32 s35, s35, 15
  s_mul_i32 s35, s35, 12288
  s_add_u32 s26, s26, s35
  s_mov_b32 s55, s26
  s_mov_b32 s27, s26
  s_mov_b32 s52, s28
  s_waitcnt lgkmcnt(0)
  s_mov_b32 s12, s6
  s_and_b32 s13, s7, 0xffff
  s_mov_b32 s14, 100663296
  s_mov_b32 s15, 0x20000
  s_mov_b32 s8, s4
  s_and_b32 s9, s5, 0xffff
  s_mov_b32 s10, 75497472
  s_mov_b32 s11, 0x20000
  s_mov_b32 s16, s40
  s_and_b32 s17, s41, 0xffff
  s_mov_b32 s18, 100663296
  s_mov_b32 s19, 0x20000
  s_mov_b32 s20, s42
  s_and_b32 s21, s43, 0xffff
  s_mov_b32 s22, 75497472
  s_mov_b32 s23, 0x20000
  s_getreg_b32 s37, hwreg(HW_REG_XCC_ID, 0, 1)
  s_cmp_eq_u32 s37, 1
  s_cselect_b64 vcc, -1, 0
  s_add_u32 m0, s25, 0
  s_nop 0
  buffer_load_dwordx4 v8, s[12:15], s26 offen offset:0 nt lds
  s_cbranch_vccnz L_go0
  s_waitcnt vmcnt(0)
L_go0:
  s_add_u32 m0, s25, 3968
  s_nop 0
  buffer_load_dwordx4 v8, s[12:15], s26 offen offset:128 nt lds
  s_cbranch_vccnz L_go1
  s_waitcnt vmcnt(0)
L_go1:
  s_add_u32 m0, s25, 7936
  s_nop 0
  buffer_load_dwordx4 v8, s[12:15], s26 offen offset:256 nt lds
  s_cbranch_vccnz L_go2
  s_waitcnt vmcnt(0)
L_go2:
  s_add_u32 s35, s28, 0
  s_add_u32 m0, s25, 12288
  s_nop 0
  buffer_load_dwordx4 v8, s[8:11], s35 offen offset:0 nt lds
  s_cbranch_vccnz L_go3
  s_waitcnt vmcnt(0)
L_go3:
  s_add_u32 m0, s25, 16256
  s_nop 0
  buffer_load_dwordx4 v8, s[8:11], s35 offen offset:128 nt lds
  s_cbranch_vccnz L_go4
  s_waitcnt vmcnt(0)
L_go4:
  s_add_u32 m0, s25, 20224
  s_nop 0
  buffer_load_dwordx4 v8, s[8:11], s35 offen offset:256 nt lds
  s_cbranch_vccnz L_go5
  s_waitcnt vmcnt(0)
L_go5:
  s_add_u32 s35, s28, 3072
  s_add_u32 m0, s25, 61440
  s_nop 0
  buffer_load_dwordx4 v8, s[8:11], s35 offen offset:0 nt lds
  s_cbranch_vccnz L_go6
  s_waitcnt vmcnt(0)
L_go6:
  s_add_u32 m0, s25, 65408
  s_nop 0
  buffer_load_dwordx4 v8, s[8:11], s35 offen offset:128 nt lds
  s_cbranch_vccnz L_go7
  s_waitcnt vmcnt(0)
L_go7:
  s_add_u32 m0, s25, 69376
  s_nop 0
  buffer_load_dwordx4 v8, s[8:11], s35 offen offset:256 nt lds
  s_add_u32 s35, s28, 6144
  s_add_u32 m0, s25, 24576
  s_nop 0
  buffer_load_dwordx4 v8, s[8:11], s35 offen offset:0 nt lds
  s_add_u32 m0, s25, 28544
  s_nop 0
  buffer_load_dwordx4 v8, s[8:11], s35 offen offset:128 nt lds
  s_add_u32 m0, s25, 32512
  s_nop 0
  buffer_load_dwordx4 v8, s[8:11], s35 offen offset:256 nt lds
  s_add_u32 s35, s28, 9216
  s_add_u32 m0, s25, 73728
  s_nop 0
  buffer_load_dwordx4 v8, s[8:11], s35 offen offset:0 nt lds
  s_add_u32 m0, s25, 77696
  s_nop 0
  buffer_load_dwordx4 v8, s[8:11], s35 offen offset:128 nt lds
  s_add_u32 m0, s25, 81664
  s_nop 0
  buffer_load_dwordx4 v8, s[8:11], s35 offen offset:256 nt lds
  s_add_u32 s35, s28, 12288
  s_add_u32 m0, s25, 36864
  s_nop 0
  buffer_load_dwordx4 v8, s[8:11], s35 offen offset:0 nt lds
  s_add_u32 m0, s25, 40832
  s_nop 0
  buffer_load_dwordx4 v8, s[8:11], s35 offen offset:128 nt lds
  s_add_u32 m0, s25, 44800
  s_nop 0
  buffer_load_dwordx4 v8, s[8:11], s35 offen offset:256 nt lds
  s_add_u32 s35, s28, 15360
  s_add_u32 m0, s25, 86016
  s_nop 0
  buffer_load_dwordx4 v8, s[8:11], s35 offen offset:0 nt lds
  s_add_u32 m0, s25, 89984
  s_nop 0
  buffer_load_dwordx4 v8, s[8:11], s35 offen offset:128 nt lds
  s_add_u32 m0, s25, 93952
  s_nop 0
  buffer_load_dwordx4 v8, s[8:11], s35 offen offset:256 nt lds
  s_add_u32 s26, s26, 12288
  s_cmp_eq_u32 s26, s57
  s_cselect_b32 s26, s56, s26
  s_add_u32 s35, s28, 24576
  s_add_u32 m0, s36, 0
  s_nop 0
  buffer_load_dwordx4 v8, s[8:11], s35 offen offset:0 nt lds
  s_add_u32 s35, s28, 27648
  s_add_u32 m0, s36, 1024
  s_nop 0
  buffer_load_dwordx4 v23, s[8:11], s35 offen offset:0 nt lds
  s_add_u32 s35, s28, 30720
  s_add_u32 m0, s36, 2048
  s_nop 0
  buffer_load_dwordx4 v8, s[8:11], s35 offen offset:0 nt lds
  s_add_u32 s35, s28, 33792
  s_add_u32 m0, s36, 3072
  s_nop 0
  buffer_load_dwordx4 v23, s[8:11], s35 offen offset:0 nt lds
  s_add_u32 s35, s28, 24576
  s_add_u32 m0, s36, 3968
  s_nop 0
  buffer_load_dwordx4 v8, s[8:11], s35 offen offset:128 nt lds
  s_add_u32 s35, s28, 27648
  s_add_u32 m0, s36, 4992
  s_nop 0
  buffer_load_dwordx4 v23, s[8:11], s35 offen offset:128 nt lds
  s_add_u32 s35, s28, 30720
  s_add_u32 m0, s36, 6016
  s_nop 0
  buffer_load_dwordx4 v8, s[8:11], s35 offen offset:128 nt lds
  s_add_u32 s35, s28, 33792
  s_add_u32 m0, s36, 7040
  s_nop 0
  buffer_load_dwordx4 v23, s[8:11], s35 offen offset:128 nt lds
  s_add_u32 s35, s28, 24576
  s_add_u32 m0, s36, 7936
  s_nop 0
  buffer_load_dwordx4 v8, s[8:11], s35 offen offset:256 nt lds
  s_add_u32 s35, s28, 27648
  s_add_u32 m0, s36, 8960
  s_nop 0
  buffer_load_dwordx4 v23, s[8:11], s35 offen offset:256 nt lds
  s_add_u32 s35, s28, 30720
  s_add_u32 m0, s36, 9984
  s_nop 0
  buffer_load_dwordx4 v8, s[8:11], s35 offen offset:256 nt lds
  s_add_u32 s35, s28, 33792
  s_add_u32 m0, s36, 11008
  s_nop 0
  buffer_load_dwordx4 v23, s[8:11], s35 offen offset:256 nt lds
  v_and_b32 v26, 15, v25
  v_lshrrev_b32 v27, 4, v25
  v_bfe_u32 v30, v26, 3, 1
  v_and_b32 v31, 2, v26
  v_lshrrev_b32 v32, 1, v26
  v_xor_b32 v32, v32, v26
  v_and_b32 v32, 4, v32
  v_or3_b32 v30, v30, v31, v32
  v_xor_b32 v31, v27, v30
  v_lshlrev_b32 v31, 4, v31
  v_lshl_add_u32 v0, v26, 7, v31
  v_xor_b32 v1, 64, v0
  s_and_b32 s35, s24, 1
  s_mul_i32 s35, s35, 0x50
  v_xor_b32 v31, s35, v0
  v_add_u32 v2, s36, v31
  v_xor_b32 v3, 64, v2
  v_and_b32 v33, 7, v26
  v_lshl_add_u32 v29, v24, 3, v33
  v_bfe_u32 v30, v29, 3, 1
  v_and_b32 v31, 2, v29
  v_lshrrev_b32 v32, 1, v29
  v_xor_b32 v32, v32, v29
  v_and_b32 v32, 4, v32
  v_or3_b32 v30, v30, v31, v32
  v_xor_b32 v31, v27, v30
  v_lshlrev_b32 v31, 4, v31
  v_lshl_add_u32 v31, v33, 7, v31
  v_lshrrev_b32 v32, 3, v26
  v_mul_u32_u24 v32, 49152, v32
  v_add3_u32 v21, v31, v32, s25
  v_xor_b32 v22, 64, v21
  v_lshrrev_b32 v33, 2, v26
  v_lshl_add_u32 v29, v27, 2, v33
  v_bfe_u32 v30, v29, 3, 1
  v_and_b32 v31, 2, v29
  v_lshrrev_b32 v32, 1, v29
  v_xor_b32 v32, v32, v29
  v_and_b32 v32, 4, v32
  v_or3_b32 v30, v30, v31, v32
  v_bfe_u32 v31, v26, 1, 1
  v_xor_b32 v31, v31, v30
  v_lshlrev_b32 v31, 4, v31
  v_lshl_add_u32 v31, v29, 7, v31
  v_and_b32 v32, 1, v26
  v_lshlrev_b32 v32, 3, v32
  v_add_u32 v32, 49152, v32
  v_add_u32 v4, v31, v32
  v_xor_b32 v5, 32, v4
  v_xor_b32 v6, 64, v4
  v_xor_b32 v7, 96, v4
  s_mov_b32 s30, 0x3dd53b95
  s_mov_b32 s31, 0xbdd53b95
  s_lshl_b32 s50, s25, 2
  s_add_u32 s50, s50, 147456
  s_mov_b32 s33, 0
  s_mov_b32 s38, 0
  s_waitcnt vmcnt(18) lgkmcnt(0)
  ds_read_b128 a[140:143], v21 offset:12288
  ds_read_b128 a[144:147], v22 offset:12288
  ds_read_b128 a[148:151], v21 offset:16384
  ds_read_b128 a[152:155], v22 offset:16384
  ds_read_b128 a[156:159], v21 offset:20480
  ds_read_b128 a[160:163], v22 offset:20480
  ds_read_b128 a[164:167], v21 offset:24576
  ds_read_b128 a[168:171], v22 offset:24576
  ds_read_b128 a[172:175], v21 offset:28672
  ds_read_b128 a[176:179], v22 offset:28672
  ds_read_b128 a[180:183], v21 offset:32768
  ds_read_b128 a[184:187], v22 offset:32768
  s_waitcnt vmcnt(12) lgkmcnt(0)
  s_barrier
  ds_read_b128 a[188:191], v21 offset:36864
  ds_read_b128 a[192:195], v22 offset:36864
  ds_read_b128 a[196:199], v21 offset:40960
  ds_read_b128 a[200:203], v22 offset:40960
  ds_read_b128 a[204:207], v21 offset:45056
  ds_read_b128 a[208:211], v22 offset:45056
  ds_read_b128 a[0:3], v0 offset:0
  ds_read_b128 a[4:7], v0 offset:2048
  ds_read_b128 a[8:11], v1 offset:0
  ds_read_b128 a[12:15], v1 offset:2048
  ds_read_b128 a[16:19], v0 offset:4096
  ds_read_b128 a[20:23], v0 offset:6144
  s_waitcnt lgkmcnt(6)
  ds_read_b128 a[24:27], v1 offset:4096
  ds_read_b128 a[28:31], v1 offset:6144
  ds_read_b128 a[32:35], v0 offset:8192
  ds_read_b128 a[36:39], v0 offset:10240
  ds_read_b128 a[40:43], v1 offset:8192
  ds_read_b128 a[44:47], v1 offset:10240
  s_add_u32 s35, s28, 18432
  s_add_u32 m0, s25, 36864
  s_nop 0
  buffer_load_dwordx4 v8, s[8:11], s35 offen offset:0 nt lds
  s_add_u32 m0, s25, 40832
  s_nop 0
  buffer_load_dwordx4 v8, s[8:11], s35 offen offset:128 nt lds
  s_add_u32 m0, s25, 44800
  s_nop 0
  buffer_load_dwordx4 v8, s[8:11], s35 offen offset:256 nt lds
  s_add_u32 s35, s28, 21504
  s_add_u32 m0, s25, 86016
  s_nop 0
  buffer_load_dwordx4 v8, s[8:11], s35 offen offset:0 nt lds
  s_add_u32 m0, s25, 89984
  s_nop 0
  buffer_load_dwordx4 v8, s[8:11], s35 offen offset:128 nt lds
  s_add_u32 m0, s25, 93952
  s_nop 0
  buffer_load_dwordx4 v8, s[8:11], s35 offen offset:256 nt lds
  s_waitcnt lgkmcnt(0)
  v_mfma_f32_16x16x32_bf16 v[24:27], a[0:3], a[140:143], 0
  v_mfma_f32_16x16x32_bf16 v[28:31], a[0:3], a[164:167], 0
  v_mfma_f32_16x16x32_bf16 v[32:35], a[0:3], a[188:191], 0
  v_mfma_f32_16x16x32_bf16 v[80:83], a[4:7], a[188:191], 0
  v_mfma_f32_16x16x32_bf16 v[76:79], a[4:7], a[164:167], 0
  v_mfma_f32_16x16x32_bf16 v[72:75], a[4:7], a[140:143], 0
  v_mfma_f32_16x16x32_bf16 v[24:27], a[8:11], a[144:147], v[24:27]
  v_mfma_f32_16x16x32_bf16 v[28:31], a[8:11], a[168:171], v[28:31]
  v_mfma_f32_16x16x32_bf16 v[32:35], a[8:11], a[192:195], v[32:35]
  v_mfma_f32_16x16x32_bf16 v[80:83], a[12:15], a[192:195], v[80:83]
  v_mfma_f32_16x16x32_bf16 v[76:79], a[12:15], a[168:171], v[76:79]
  v_mfma_f32_16x16x32_bf16 v[72:75], a[12:15], a[144:147], v[72:75]
  v_mfma_f32_16x16x32_bf16 v[24:27], a[16:19], a[148:151], v[24:27]
  v_mfma_f32_16x16x32_bf16 v[28:31], a[16:19], a[172:175], v[28:31]
  v_mfma_f32_16x16x32_bf16 v[32:35], a[16:19], a[196:199], v[32:35]
  v_mfma_f32_16x16x32_bf16 v[80:83], a[20:23], a[196:199], v[80:83]
  v_mfma_f32_16x16x32_bf16 v[76:79], a[20:23], a[172:175], v[76:79]
  v_mfma_f32_16x16x32_bf16 v[72:75], a[20:23], a[148:151], v[72:75]
  v_mfma_f32_16x16x32_bf16 v[24:27], a[24:27], a[152:155], v[24:27]
  v_mfma_f32_16x16x32_bf16 v[28:31], a[24:27], a[176:179], v[28:31]
  v_mfma_f32_16x16x32_bf16 v[32:35], a[24:27], a[200:203], v[32:35]
  v_mfma_f32_16x16x32_bf16 v[80:83], a[28:31], a[200:203], v[80:83]
  v_mfma_f32_16x16x32_bf16 v[76:79], a[28:31], a[176:179], v[76:79]
  v_mfma_f32_16x16x32_bf16 v[72:75], a[28:31], a[152:155], v[72:75]
  v_mfma_f32_16x16x32_bf16 v[24:27], a[32:35], a[156:159], v[24:27]
  v_mfma_f32_16x16x32_bf16 v[28:31], a[32:35], a[180:183], v[28:31]
  v_mfma_f32_16x16x32_bf16 v[32:35], a[32:35], a[204:207], v[32:35]
  v_mfma_f32_16x16x32_bf16 v[80:83], a[36:39], a[204:207], v[80:83]
  v_mfma_f32_16x16x32_bf16 v[76:79], a[36:39], a[180:183], v[76:79]
  v_mfma_f32_16x16x32_bf16 v[72:75], a[36:39], a[156:159], v[72:75]
  v_mfma_f32_16x16x32_bf16 v[24:27], a[40:43], a[160:163], v[24:27]
  v_mfma_f32_16x16x32_bf16 v[28:31], a[40:43], a[184:187], v[28:31]
  v_mfma_f32_16x16x32_bf16 v[32:35], a[40:43], a[208:211], v[32:35]
  v_mfma_f32_16x16x32_bf16 v[80:83], a[44:47], a[208:211], v[80:83]
  v_mfma_f32_16x16x32_bf16 v[76:79], a[44:47], a[184:187], v[76:79]
  v_mfma_f32_16x16x32_bf16 v[72:75], a[44:47], a[160:163], v[72:75]
  s_add_u32 m0, s25, 12288
  s_nop 0
  buffer_load_dwordx4 v8, s[12:15], s26 offen offset:0 nt lds
  s_add_u32 m0, s25, 16256
  s_nop 0
  buffer_load_dwordx4 v8, s[12:15], s26 offen offset:128 nt lds
  s_add_u32 m0, s25, 20224
  s_nop 0
  buffer_load_dwordx4 v8, s[12:15], s26 offen offset:256 nt lds
  s_add_u32 s26, s26, 12288
  s_cmp_eq_u32 s26, s57
  s_cselect_b32 s26, s56, s26
  s_mov_b32 s29, s28
  s_cmp_eq_u32 s33, 0
  s_mov_b32 s35, 1879048192
  s_cselect_b32 s34, 6291456, s35
  s_cselect_b32 s35, 4718592, s35
  s_add_u32 s28, s28, s35
  s_add_u32 s34, s34, s55
  s_mov_b32 s32, -3
  v_mov_b32 v15, 0
  v_mov_b32 v16, 0
  v_mov_b32 v17, 0
  v_mov_b32 v18, 0
  v_mov_b32 v19, 0
  v_mov_b32 v20, 0
  v_max3_f32 v56, v32, v33, v34
  v_max3_f32 v52, v28, v29, v30
  v_max3_f32 v48, v24, v25, v26
  v_max3_f32 v56, v56, v35, v80
  v_max3_f32 v52, v52, v31, v76
  v_max3_f32 v48, v48, v27, v72
  v_max3_f32 v56, v56, v81, v82
  v_max3_f32 v52, v52, v77, v78
  v_max3_f32 v48, v48, v73, v74
  v_max3_f32 v56, v56, v83, v79
  v_max3_f32 v48, v48, v52, v75
  v_max_f32 v48, v48, v56
  v_mov_b32 v52, v48
  s_nop 1
  v_permlane32_swap_b32 v52, v48
  v_max_f32 v48, v48, v52
  v_mov_b32 v52, v48
  s_nop 1
  v_permlane16_swap_b32 v52, v48
  v_max_f32 v48, v48, v52
  v_sub_f32 v10, 0x4266823a, v48
  v_sub_f32 v11, 0x4266823a, v48
  v_sub_f32 v12, 0x4266823a, v48
  v_sub_f32 v13, 0x4266823a, v48
  v_mul_f32 v9, s30, v10
  v_fmamk_f32 v24, v24, 0x3dd53b95, v9
  v_exp_f32 v24, v24
  v_fmamk_f32 v25, v25, 0x3dd53b95, v9
  v_add_f32 v15, v15, v24
  v_exp_f32 v25, v25
  v_fmamk_f32 v26, v26, 0x3dd53b95, v9
  v_add_f32 v15, v15, v25
  v_cvt_pk_bf16_f32 v24, v24, v25
  v_exp_f32 v26, v26
  v_fmamk_f32 v27, v27, 0x3dd53b95, v9
  v_add_f32 v15, v15, v26
  v_exp_f32 v27, v27
  v_fmamk_f32 v72, v72, 0x3dd53b95, v9
  v_add_f32 v15, v15, v27
  v_cvt_pk_bf16_f32 v25, v26, v27
  v_exp_f32 v72, v72
  v_fmamk_f32 v73, v73, 0x3dd53b95, v9
  v_add_f32 v15, v15, v72
  v_exp_f32 v73, v73
  v_fmamk_f32 v74, v74, 0x3dd53b95, v9
  v_add_f32 v15, v15, v73
  v_cvt_pk_bf16_f32 v26, v72, v73
  v_exp_f32 v74, v74
  v_fmamk_f32 v75, v75, 0x3dd53b95, v9
  v_add_f32 v15, v15, v74
  v_exp_f32 v75, v75
  v_fmamk_f32 v28, v28, 0x3dd53b95, v9
  v_add_f32 v15, v15, v75
  v_cvt_pk_bf16_f32 v27, v74, v75
  v_exp_f32 v28, v28
  v_fmamk_f32 v29, v29, 0x3dd53b95, v9
  v_add_f32 v16, v16, v28
  v_exp_f32 v29, v29
  v_fmamk_f32 v30, v30, 0x3dd53b95, v9
  v_add_f32 v16, v16, v29
  v_cvt_pk_bf16_f32 v28, v28, v29
  v_exp_f32 v30, v30
  v_fmamk_f32 v31, v31, 0x3dd53b95, v9
  v_add_f32 v16, v16, v30
  v_exp_f32 v31, v31
  v_fmamk_f32 v76, v76, 0x3dd53b95, v9
  v_add_f32 v16, v16, v31
  v_cvt_pk_bf16_f32 v29, v30, v31
  v_exp_f32 v76, v76
  v_fmamk_f32 v77, v77, 0x3dd53b95, v9
  v_add_f32 v16, v16, v76
  v_exp_f32 v77, v77
  v_fmamk_f32 v78, v78, 0x3dd53b95, v9
  v_add_f32 v16, v16, v77
  v_cvt_pk_bf16_f32 v30, v76, v77
  v_exp_f32 v78, v78
  v_fmamk_f32 v79, v79, 0x3dd53b95, v9
  v_add_f32 v16, v16, v78
  v_exp_f32 v79, v79
  v_fmamk_f32 v32, v32, 0x3dd53b95, v9
  v_add_f32 v16, v16, v79
  v_cvt_pk_bf16_f32 v31, v78, v79
  v_exp_f32 v32, v32
  v_fmamk_f32 v33, v33, 0x3dd53b95, v9
  v_add_f32 v17, v17, v32
  v_exp_f32 v33, v33
  v_fmamk_f32 v34, v34, 0x3dd53b95, v9
  v_add_f32 v17, v17, v33
  v_cvt_pk_bf16_f32 v32, v32, v33
  v_exp_f32 v34, v34
  v_fmamk_f32 v35, v35, 0x3dd53b95, v9
  v_add_f32 v17, v17, v34
  v_exp_f32 v35, v35
  v_fmamk_f32 v80, v80, 0x3dd53b95, v9
  v_add_f32 v17, v17, v35
  v_cvt_pk_bf16_f32 v33, v34, v35
  v_exp_f32 v80, v80
  v_fmamk_f32 v81, v81, 0x3dd53b95, v9
  v_add_f32 v17, v17, v80
  v_exp_f32 v81, v81
  v_fmamk_f32 v82, v82, 0x3dd53b95, v9
  v_add_f32 v17, v17, v81
  v_cvt_pk_bf16_f32 v34, v80, v81
  v_exp_f32 v82, v82
  v_fmamk_f32 v83, v83, 0x3dd53b95, v9
  v_add_f32 v17, v17, v82
  v_exp_f32 v83, v83
  s_nop 0
  v_add_f32 v17, v17, v83
  v_cvt_pk_bf16_f32 v35, v82, v83
  s_add_u32 m0, s25, 61440
  s_nop 0
  buffer_load_dwordx4 v8, s[16:19], s27 offen offset:0 nt lds
  s_add_u32 m0, s25, 65408
  s_nop 0
  buffer_load_dwordx4 v8, s[16:19], s27 offen offset:128 nt lds
  s_add_u32 m0, s25, 69376
  s_nop 0
  buffer_load_dwordx4 v8, s[16:19], s27 offen offset:256 nt lds
  s_waitcnt vmcnt(12) lgkmcnt(0)
  ds_read_b128 a[48:51], v2 offset:0
  ds_read_b128 a[72:75], v2 offset:2048
  ds_read_b128 a[52:55], v3 offset:0
  ds_read_b128 a[76:79], v3 offset:2048
  ds_read_b128 a[56:59], v2 offset:4096
  ds_read_b128 a[80:83], v2 offset:6144
  ds_read_b128 a[60:63], v3 offset:4096
  ds_read_b128 a[84:87], v3 offset:6144
  ds_read_b128 a[64:67], v2 offset:8192
  ds_read_b128 a[88:91], v2 offset:10240
  ds_read_b128 a[68:71], v3 offset:8192
  ds_read_b128 a[92:95], v3 offset:10240
  s_waitcnt lgkmcnt(0)
  v_mfma_f32_16x16x32_bf16 v[40:43], a[0:3], a[48:51], 0
  v_mfma_f32_16x16x32_bf16 v[44:47], a[0:3], a[72:75], 0
  v_mfma_f32_16x16x32_bf16 v[92:95], a[4:7], a[72:75], 0
  s_add_u32 m0, s25, 24576
  v_mfma_f32_16x16x32_bf16 v[88:91], a[4:7], a[48:51], 0
  buffer_load_dwordx4 v8, s[12:15], s26 offen offset:0 nt lds
  v_mfma_f32_16x16x32_bf16 v[40:43], a[8:11], a[52:55], v[40:43]
  v_mfma_f32_16x16x32_bf16 v[44:47], a[8:11], a[76:79], v[44:47]
  v_mfma_f32_16x16x32_bf16 v[92:95], a[12:15], a[76:79], v[92:95]
  s_add_u32 m0, s25, 28544
  v_mfma_f32_16x16x32_bf16 v[88:91], a[12:15], a[52:55], v[88:91]
  buffer_load_dwordx4 v8, s[12:15], s26 offen offset:128 nt lds
  v_mfma_f32_16x16x32_bf16 v[40:43], a[16:19], a[56:59], v[40:43]
  v_mfma_f32_16x16x32_bf16 v[44:47], a[16:19], a[80:83], v[44:47]
  v_mfma_f32_16x16x32_bf16 v[92:95], a[20:23], a[80:83], v[92:95]
  s_add_u32 m0, s25, 32512
  v_mfma_f32_16x16x32_bf16 v[88:91], a[20:23], a[56:59], v[88:91]
  buffer_load_dwordx4 v8, s[12:15], s26 offen offset:256 nt lds
  v_mfma_f32_16x16x32_bf16 v[40:43], a[24:27], a[60:63], v[40:43]
  v_mfma_f32_16x16x32_bf16 v[44:47], a[24:27], a[84:87], v[44:47]
  v_mfma_f32_16x16x32_bf16 v[92:95], a[28:31], a[84:87], v[92:95]
  s_add_u32 s27, s27, 12288
  s_cmp_eq_u32 s27, s59
  s_cselect_b32 s27, s58, s27
  s_add_u32 m0, s25, 73728
  v_mfma_f32_16x16x32_bf16 v[88:91], a[28:31], a[60:63], v[88:91]
  buffer_load_dwordx4 v8, s[16:19], s27 offen offset:0 nt lds
  v_mfma_f32_16x16x32_bf16 v[40:43], a[32:35], a[64:67], v[40:43]
  v_mfma_f32_16x16x32_bf16 v[44:47], a[32:35], a[88:91], v[44:47]
  v_mfma_f32_16x16x32_bf16 v[92:95], a[36:39], a[88:91], v[92:95]
  s_add_u32 m0, s25, 77696
  v_mfma_f32_16x16x32_bf16 v[88:91], a[36:39], a[64:67], v[88:91]
  buffer_load_dwordx4 v8, s[16:19], s27 offen offset:128 nt lds
  v_mfma_f32_16x16x32_bf16 v[40:43], a[40:43], a[68:71], v[40:43]
  v_mfma_f32_16x16x32_bf16 v[44:47], a[40:43], a[92:95], v[44:47]
  v_mfma_f32_16x16x32_bf16 v[92:95], a[44:47], a[92:95], v[92:95]
  s_add_u32 m0, s25, 81664
  v_mfma_f32_16x16x32_bf16 v[88:91], a[44:47], a[68:71], v[88:91]
  buffer_load_dwordx4 v8, s[16:19], s27 offen offset:256 nt lds
  s_add_u32 s26, s26, 12288
  s_cmp_eq_u32 s26, s57
  s_cselect_b32 s26, s56, s26
  s_add_u32 s27, s27, 12288
  s_cmp_eq_u32 s27, s59
  s_cselect_b32 s27, s58, s27
  s_waitcnt vmcnt(12) lgkmcnt(0)
  ds_read_b128 a[212:215], v21 offset:36864
  ds_read_b128 a[216:219], v22 offset:36864
  ds_read_b128 a[220:223], v21 offset:40960
  ds_read_b128 a[224:227], v22 offset:40960
  ds_read_b128 a[228:231], v21 offset:45056
  ds_read_b128 a[232:235], v22 offset:45056
  s_waitcnt lgkmcnt(0)
  v_mfma_f32_16x16x32_bf16 v[36:39], a[0:3], a[212:215], 0
  v_mfma_f32_16x16x32_bf16 v[84:87], a[4:7], a[212:215], 0
  v_mfma_f32_16x16x32_bf16 v[36:39], a[8:11], a[216:219], v[36:39]
  v_mfma_f32_16x16x32_bf16 v[84:87], a[12:15], a[216:219], v[84:87]
  v_mfma_f32_16x16x32_bf16 v[36:39], a[16:19], a[220:223], v[36:39]
  v_mfma_f32_16x16x32_bf16 v[84:87], a[20:23], a[220:223], v[84:87]
  v_mfma_f32_16x16x32_bf16 v[36:39], a[24:27], a[224:227], v[36:39]
  v_mfma_f32_16x16x32_bf16 v[84:87], a[28:31], a[224:227], v[84:87]
  v_mfma_f32_16x16x32_bf16 v[36:39], a[32:35], a[228:231], v[36:39]
  v_mfma_f32_16x16x32_bf16 v[84:87], a[36:39], a[228:231], v[84:87]
  v_mfma_f32_16x16x32_bf16 v[36:39], a[40:43], a[232:235], v[36:39]
  v_mfma_f32_16x16x32_bf16 v[84:87], a[44:47], a[232:235], v[84:87]
  s_waitcnt vmcnt(9) lgkmcnt(0)
  s_barrier
  ds_read_b128 a[236:239], v0 offset:12288
  ds_read_b128 a[248:251], v2 offset:0
  ds_read_b128 a[252:255], v2 offset:2048
  ds_read_b128 a[240:243], v0 offset:14336
  s_nop 1
  v_fmamk_f32 v36, v36, 0x3dd53b95, v9
  v_exp_f32 v36, v36
  v_fmamk_f32 v37, v37, 0x3dd53b95, v9
  v_add_f32 v18, v18, v36
  v_exp_f32 v37, v37
  s_waitcnt lgkmcnt(3)
L_q1:
  v_mfma_f32_16x16x32_bf16 v[48:51], a[236:239], a[140:143], v[10:13]
  ds_read_b128 a[244:247], v1 offset:12288
  v_fmamk_f32 v38, v38, 0x3dd53b95, v9
  v_mfma_f32_16x16x32_bf16 v[52:55], a[236:239], a[164:167], v[10:13]
  v_add_f32 v18, v18, v37
  v_cvt_pk_bf16_f32 v36, v36, v37
  v_mfma_f32_16x16x32_bf16 v[56:59], a[236:239], a[188:191], v[10:13]
  s_add_u32 m0, s25, 36864
  v_exp_f32 v38, v38
  v_mfma_f32_16x16x32_bf16 v[60:63], a[236:239], a[212:215], v[10:13]
  s_waitcnt lgkmcnt(2)
  v_fmamk_f32 v39, v39, 0x3dd53b95, v9
  v_add_f32 v18, v18, v38
  v_mfma_f32_16x16x32_bf16 v[64:67], a[236:239], a[248:251], v[10:13]
  buffer_load_dwordx4 v8, s[12:15], s26 offen offset:0 nt lds
  v_mfma_f32_16x16x32_bf16 v[68:71], a[236:239], a[252:255], v[10:13]
  s_waitcnt lgkmcnt(1)
  v_exp_f32 v39, v39
  v_mfma_f32_16x16x32_bf16 v[104:107], a[240:243], a[252:255], v[10:13]
  ds_read_b128 a[252:255], v3 offset:2048
  v_fmamk_f32 v84, v84, 0x3dd53b95, v9
  v_mfma_f32_16x16x32_bf16 v[100:103], a[240:243], a[248:251], v[10:13]
  v_add_f32 v18, v18, v39
  v_cvt_pk_bf16_f32 v37, v38, v39
  v_mfma_f32_16x16x32_bf16 v[96:99], a[240:243], a[212:215], v[10:13]
  v_exp_f32 v84, v84
  v_mfma_f32_16x16x32_bf16 v[80:83], a[240:243], a[188:191], v[10:13]
  ds_read_b128 a[248:251], v3 offset:0
  v_fmamk_f32 v85, v85, 0x3dd53b95, v9
  v_mfma_f32_16x16x32_bf16 v[76:79], a[240:243], a[164:167], v[10:13]
  ds_read_b128 a[236:239], v1 offset:14336
  v_add_f32 v18, v18, v84
  v_mfma_f32_16x16x32_bf16 v[72:75], a[240:243], a[140:143], v[10:13]
  s_waitcnt lgkmcnt(3)
  v_exp_f32 v85, v85
  v_mfma_f32_16x16x32_bf16 v[48:51], a[244:247], a[144:147], v[48:51]
  ds_read_b128 a[240:243], v0 offset:16384
  v_fmamk_f32 v86, v86, 0x3dd53b95, v9
  v_mfma_f32_16x16x32_bf16 v[52:55], a[244:247], a[168:171], v[52:55]
  v_add_f32 v18, v18, v85
  v_cvt_pk_bf16_f32 v38, v84, v85
  v_mfma_f32_16x16x32_bf16 v[56:59], a[244:247], a[192:195], v[56:59]
  s_add_u32 m0, s25, 40832
  v_exp_f32 v86, v86
  v_mfma_f32_16x16x32_bf16 v[60:63], a[244:247], a[216:219], v[60:63]
  s_waitcnt lgkmcnt(2)
  v_fmamk_f32 v87, v87, 0x3dd53b95, v9
  v_add_f32 v18, v18, v86
  v_mfma_f32_16x16x32_bf16 v[64:67], a[244:247], a[248:251], v[64:67]
  buffer_load_dwordx4 v8, s[12:15], s26 offen offset:128 nt lds
  v_mfma_f32_16x16x32_bf16 v[68:71], a[244:247], a[252:255], v[68:71]
  s_waitcnt lgkmcnt(1)
  v_exp_f32 v87, v87
  v_mfma_f32_16x16x32_bf16 v[104:107], a[236:239], a[252:255], v[104:107]
  ds_read_b128 a[252:255], v2 offset:6144
  v_fmamk_f32 v40, v40, 0x3dd53b95, v9
  v_mfma_f32_16x16x32_bf16 v[100:103], a[236:239], a[248:251], v[100:103]
  v_add_f32 v18, v18, v87
  v_cvt_pk_bf16_f32 v39, v86, v87
  v_mfma_f32_16x16x32_bf16 v[96:99], a[236:239], a[216:219], v[96:99]
  v_exp_f32 v40, v40
  v_mfma_f32_16x16x32_bf16 v[80:83], a[236:239], a[192:195], v[80:83]
  ds_read_b128 a[248:251], v2 offset:4096
  v_fmamk_f32 v41, v41, 0x3dd53b95, v9
  v_mfma_f32_16x16x32_bf16 v[76:79], a[236:239], a[168:171], v[76:79]
  ds_read_b128 a[244:247], v0 offset:18432
  v_add_f32 v19, v19, v40
  v_mfma_f32_16x16x32_bf16 v[72:75], a[236:239], a[144:147], v[72:75]
  s_waitcnt lgkmcnt(3)
  v_exp_f32 v41, v41
  v_mfma_f32_16x16x32_bf16 v[48:51], a[240:243], a[148:151], v[48:51]
  ds_read_b128 a[236:239], v1 offset:16384
  v_fmamk_f32 v42, v42, 0x3dd53b95, v9
  v_mfma_f32_16x16x32_bf16 v[52:55], a[240:243], a[172:175], v[52:55]
  v_add_f32 v19, v19, v41
  v_cvt_pk_bf16_f32 v40, v40, v41
  v_mfma_f32_16x16x32_bf16 v[56:59], a[240:243], a[196:199], v[56:59]
  s_add_u32 m0, s25, 44800
  v_exp_f32 v42, v42
  v_mfma_f32_16x16x32_bf16 v[60:63], a[240:243], a[220:223], v[60:63]
  s_waitcnt lgkmcnt(2)
  v_fmamk_f32 v43, v43, 0x3dd53b95, v9
  v_add_f32 v19, v19, v42
  v_mfma_f32_16x16x32_bf16 v[64:67], a[240:243], a[248:251], v[64:67]
  buffer_load_dwordx4 v8, s[12:15], s26 offen offset:256 nt lds
  v_mfma_f32_16x16x32_bf16 v[68:71], a[240:243], a[252:255], v[68:71]
  s_waitcnt lgkmcnt(1)
  v_exp_f32 v43, v43
  v_mfma_f32_16x16x32_bf16 v[104:107], a[244:247], a[252:255], v[104:107]
  ds_read_b128 a[252:255], v3 offset:6144
  v_fmamk_f32 v88, v88, 0x3dd53b95, v9
  v_mfma_f32_16x16x32_bf16 v[100:103], a[244:247], a[248:251], v[100:103]
  v_add_f32 v19, v19, v43
  v_cvt_pk_bf16_f32 v41, v42, v43
  v_mfma_f32_16x16x32_bf16 v[96:99], a[244:247], a[220:223], v[96:99]
  s_add_u32 s26, s26, 12288
  v_exp_f32 v88, v88
  v_mfma_f32_16x16x32_bf16 v[80:83], a[244:247], a[196:199], v[80:83]
  ds_read_b128 a[248:251], v3 offset:4096
  s_cmp_eq_u32 s26, s57
  v_fmamk_f32 v89, v89, 0x3dd53b95, v9
  v_mfma_f32_16x16x32_bf16 v[76:79], a[244:247], a[172:175], v[76:79]
  ds_read_b128 a[240:243], v1 offset:18432
  s_cselect_b32 s26, s56, s26
  v_add_f32 v19, v19, v88
  v_mfma_f32_16x16x32_bf16 v[72:75], a[244:247], a[148:151], v[72:75]
  s_waitcnt lgkmcnt(3)
  v_exp_f32 v89, v89
  v_mfma_f32_16x16x32_bf16 v[48:51], a[236:239], a[152:155], v[48:51]
  ds_read_b128 a[244:247], v0 offset:20480
  v_fmamk_f32 v90, v90, 0x3dd53b95, v9
  v_mfma_f32_16x16x32_bf16 v[52:55], a[236:239], a[176:179], v[52:55]
  v_add_f32 v19, v19, v89
  v_cvt_pk_bf16_f32 v42, v88, v89
  v_mfma_f32_16x16x32_bf16 v[56:59], a[236:239], a[200:203], v[56:59]
  s_add_u32 m0, s25, 86016
  v_exp_f32 v90, v90
  v_mfma_f32_16x16x32_bf16 v[60:63], a[236:239], a[224:227], v[60:63]
  s_waitcnt lgkmcnt(2)
  v_fmamk_f32 v91, v91, 0x3dd53b95, v9
  v_add_f32 v19, v19, v90
  v_mfma_f32_16x16x32_bf16 v[64:67], a[236:239], a[248:251], v[64:67]
  buffer_load_dwordx4 v8, s[16:19], s27 offen offset:0 nt lds
  v_mfma_f32_16x16x32_bf16 v[68:71], a[236:239], a[252:255], v[68:71]
  s_waitcnt lgkmcnt(1)
  v_exp_f32 v91, v91
  v_mfma_f32_16x16x32_bf16 v[104:107], a[240:243], a[252:255], v[104:107]
  ds_read_b128 a[252:255], v2 offset:10240
  v_fmamk_f32 v44, v44, 0x3dd53b95, v9
  v_mfma_f32_16x16x32_bf16 v[100:103], a[240:243], a[248:251], v[100:103]
  v_add_f32 v19, v19, v91
  v_cvt_pk_bf16_f32 v43, v90, v91
  v_mfma_f32_16x16x32_bf16 v[96:99], a[240:243], a[224:227], v[96:99]
  v_exp_f32 v44, v44
  v_mfma_f32_16x16x32_bf16 v[80:83], a[240:243], a[200:203], v[80:83]
  ds_read_b128 a[248:251], v2 offset:8192
  v_fmamk_f32 v45, v45, 0x3dd53b95, v9
  v_mfma_f32_16x16x32_bf16 v[76:79], a[240:243], a[176:179], v[76:79]
  ds_read_b128 a[236:239], v0 offset:22528
  v_add_f32 v20, v20, v44
  v_mfma_f32_16x16x32_bf16 v[72:75], a[240:243], a[152:155], v[72:75]
  s_waitcnt lgkmcnt(3)
  v_exp_f32 v45, v45
  v_mfma_f32_16x16x32_bf16 v[48:51], a[244:247], a[156:159], v[48:51]
  ds_read_b128 a[240:243], v1 offset:20480
  v_fmamk_f32 v46, v46, 0x3dd53b95, v9
  v_mfma_f32_16x16x32_bf16 v[52:55], a[244:247], a[180:183], v[52:55]
  v_add_f32 v20, v20, v45
  v_cvt_pk_bf16_f32 v44, v44, v45
  v_mfma_f32_16x16x32_bf16 v[56:59], a[244:247], a[204:207], v[56:59]
  s_add_u32 m0, s25, 89984
  v_exp_f32 v46, v46
  v_mfma_f32_16x16x32_bf16 v[60:63], a[244:247], a[228:231], v[60:63]
  s_waitcnt lgkmcnt(2)
  v_fmamk_f32 v47, v47, 0x3dd53b95, v9
  v_add_f32 v20, v20, v46
  v_mfma_f32_16x16x32_bf16 v[64:67], a[244:247], a[248:251], v[64:67]
  buffer_load_dwordx4 v8, s[16:19], s27 offen offset:128 nt lds
  v_mfma_f32_16x16x32_bf16 v[68:71], a[244:247], a[252:255], v[68:71]
  s_waitcnt lgkmcnt(1)
  v_exp_f32 v47, v47
  v_mfma_f32_16x16x32_bf16 v[104:107], a[236:239], a[252:255], v[104:107]
  ds_read_b128 a[252:255], v3 offset:10240
  v_fmamk_f32 v92, v92, 0x3dd53b95, v9
  v_mfma_f32_16x16x32_bf16 v[100:103], a[236:239], a[248:251], v[100:103]
  v_add_f32 v20, v20, v47
  v_cvt_pk_bf16_f32 v45, v46, v47
  v_mfma_f32_16x16x32_bf16 v[96:99], a[236:239], a[228:231], v[96:99]
  s_waitcnt vmcnt(11)
  v_exp_f32 v92, v92
  v_mfma_f32_16x16x32_bf16 v[80:83], a[236:239], a[204:207], v[80:83]
  ds_read_b128 a[248:251], v3 offset:8192
  v_fmamk_f32 v93, v93, 0x3dd53b95, v9
  v_mfma_f32_16x16x32_bf16 v[76:79], a[236:239], a[180:183], v[76:79]
  ds_read_b128 a[244:247], v1 offset:22528
  s_barrier
  v_add_f32 v20, v20, v92
  v_mfma_f32_16x16x32_bf16 v[72:75], a[236:239], a[156:159], v[72:75]
  s_waitcnt lgkmcnt(3)
  v_exp_f32 v93, v93
  v_mfma_f32_16x16x32_bf16 v[48:51], a[240:243], a[160:163], v[48:51]
  ds_read_b64_tr_b16 a[236:237], v4 offset:12288
  v_fmamk_f32 v94, v94, 0x3dd53b95, v9
  v_mfma_f32_16x16x32_bf16 v[52:55], a[240:243], a[184:187], v[52:55]
  v_add_f32 v20, v20, v93
  v_cvt_pk_bf16_f32 v46, v92, v93
  v_mfma_f32_16x16x32_bf16 v[56:59], a[240:243], a[208:211], v[56:59]
  s_add_u32 m0, s25, 93952
  v_exp_f32 v94, v94
  v_mfma_f32_16x16x32_bf16 v[60:63], a[240:243], a[232:235], v[60:63]
  ds_read_b64_tr_b16 a[238:239], v4 offset:14336
  s_waitcnt lgkmcnt(3)
  v_fmamk_f32 v95, v95, 0x3dd53b95, v9
  v_mfma_f32_16x16x32_bf16 v[64:67], a[240:243], a[248:251], v[64:67]
  buffer_load_dwordx4 v8, s[16:19], s27 offen offset:256 nt lds
  v_add_f32 v20, v20, v94
  v_mfma_f32_16x16x32_bf16 v[68:71], a[240:243], a[252:255], v[68:71]
  s_waitcnt lgkmcnt(2)
  v_exp_f32 v95, v95
  v_mfma_f32_16x16x32_bf16 v[104:107], a[244:247], a[252:255], v[104:107]
  ds_read_b64_tr_b16 a[240:241], v5 offset:12288
  v_mul_f32 v48, s30, v48
  v_mfma_f32_16x16x32_bf16 v[100:103], a[244:247], a[248:251], v[100:103]
  v_add_f32 v20, v20, v95
  v_cvt_pk_bf16_f32 v47, v94, v95
  v_mfma_f32_16x16x32_bf16 v[96:99], a[244:247], a[232:235], v[96:99]
  s_add_u32 s27, s27, 12288
  v_exp_f32 v48, v48
  v_mfma_f32_16x16x32_bf16 v[80:83], a[244:247], a[208:211], v[80:83]
  ds_read_b64_tr_b16 a[242:243], v5 offset:14336
  s_cmp_eq_u32 s27, s59
  v_mul_f32 v49, s30, v49
  v_mfma_f32_16x16x32_bf16 v[76:79], a[244:247], a[184:187], v[76:79]
  s_cselect_b32 s27, s58, s27
  v_add_f32 v15, v15, v48
  v_mfma_f32_16x16x32_bf16 v[72:75], a[244:247], a[160:163], v[72:75]
  s_waitcnt lgkmcnt(2)
  v_exp_f32 v49, v49
  v_mfma_f32_16x16x32_bf16 a[0:3], a[236:239], v[24:27], 0
  ds_read_b64_tr_b16 a[244:245], v6 offset:12288
  v_mul_f32 v50, s30, v50
  v_mfma_f32_16x16x32_bf16 a[4:7], a[236:239], v[28:31], 0
  v_add_f32 v15, v15, v49
  v_cvt_pk_bf16_f32 v48, v48, v49
  v_mfma_f32_16x16x32_bf16 a[8:11], a[236:239], v[32:35], 0
  s_add_u32 m0, s25, 0
  v_exp_f32 v50, v50
  v_mfma_f32_16x16x32_bf16 a[12:15], a[236:239], v[36:39], 0
  ds_read_b64_tr_b16 a[246:247], v6 offset:14336
  v_mul_f32 v51, s30, v51
  v_mfma_f32_16x16x32_bf16 a[16:19], a[236:239], v[40:43], 0
  buffer_load_dwordx4 v8, s[12:15], s26 offen offset:0 nt lds
  v_add_f32 v15, v15, v50
  v_mfma_f32_16x16x32_bf16 a[20:23], a[236:239], v[44:47], 0
  s_waitcnt lgkmcnt(2)
  v_exp_f32 v51, v51
  v_mfma_f32_16x16x32_bf16 a[44:47], a[240:243], v[44:47], 0
  ds_read_b64_tr_b16 a[236:237], v7 offset:12288
  v_mul_f32 v72, s30, v72
  v_mfma_f32_16x16x32_bf16 a[40:43], a[240:243], v[40:43], 0
  v_add_f32 v15, v15, v51
  v_cvt_pk_bf16_f32 v49, v50, v51
  v_mfma_f32_16x16x32_bf16 a[36:39], a[240:243], v[36:39], 0
  s_add_u32 m0, s25, 3968
  v_exp_f32 v72, v72
  v_mfma_f32_16x16x32_bf16 a[32:35], a[240:243], v[32:35], 0
  ds_read_b64_tr_b16 a[238:239], v7 offset:14336
  v_mul_f32 v73, s30, v73
  v_mfma_f32_16x16x32_bf16 a[28:31], a[240:243], v[28:31], 0
  buffer_load_dwordx4 v8, s[12:15], s26 offen offset:128 nt lds
  v_add_f32 v15, v15, v72
  v_mfma_f32_16x16x32_bf16 a[24:27], a[240:243], v[24:27], 0
  s_waitcnt lgkmcnt(2)
  v_exp_f32 v73, v73
  v_mfma_f32_16x16x32_bf16 a[48:51], a[244:247], v[24:27], 0
  ds_read_b64_tr_b16 a[240:241], v4 offset:16384
  v_mul_f32 v74, s30, v74
  v_mfma_f32_16x16x32_bf16 a[52:55], a[244:247], v[28:31], 0
  v_add_f32 v15, v15, v73
  v_cvt_pk_bf16_f32 v50, v72, v73
  v_mfma_f32_16x16x32_bf16 a[56:59], a[244:247], v[32:35], 0
  s_add_u32 m0, s25, 7936
  v_exp_f32 v74, v74
  v_mfma_f32_16x16x32_bf16 a[60:63], a[244:247], v[36:39], 0
  ds_read_b64_tr_b16 a[242:243], v4 offset:18432
  v_mul_f32 v75, s30, v75
  v_mfma_f32_16x16x32_bf16 a[64:67], a[244:247], v[40:43], 0
  buffer_load_dwordx4 v8, s[12:15], s26 offen offset:256 nt lds
  v_add_f32 v15, v15, v74
  v_mfma_f32_16x16x32_bf16 a[68:71], a[244:247], v[44:47], 0
  s_waitcnt lgkmcnt(2)
  v_exp_f32 v75, v75
  v_mfma_f32_16x16x32_bf16 a[92:95], a[236:239], v[44:47], 0
  ds_read_b64_tr_b16 a[244:245], v5 offset:16384
  v_mul_f32 v52, s30, v52
  v_mfma_f32_16x16x32_bf16 a[88:91], a[236:239], v[40:43], 0
  v_add_f32 v15, v15, v75
  v_cvt_pk_bf16_f32 v51, v74, v75
  v_mfma_f32_16x16x32_bf16 a[84:87], a[236:239], v[36:39], 0
  s_add_u32 s26, s26, 12288
  v_exp_f32 v52, v52
  v_mfma_f32_16x16x32_bf16 a[80:83], a[236:239], v[32:35], 0
  ds_read_b64_tr_b16 a[246:247], v5 offset:18432
  s_cmp_eq_u32 s26, s57
  v_mul_f32 v53, s30, v53
  v_mfma_f32_16x16x32_bf16 a[76:79], a[236:239], v[28:31], 0
  s_cselect_b32 s26, s56, s26
  v_add_f32 v16, v16, v52
  v_mfma_f32_16x16x32_bf16 a[72:75], a[236:239], v[24:27], 0
  s_waitcnt lgkmcnt(2)
  v_exp_f32 v53, v53
  v_mfma_f32_16x16x32_bf16 a[96:99], a[240:243], v[24:27], 0
  ds_read_b64_tr_b16 a[236:237], v6 offset:16384
  v_mul_f32 v54, s30, v54
  v_mfma_f32_16x16x32_bf16 a[100:103], a[240:243], v[28:31], 0
  v_add_f32 v16, v16, v53
  v_cvt_pk_bf16_f32 v52, v52, v53
  v_mfma_f32_16x16x32_bf16 a[104:107], a[240:243], v[32:35], 0
  s_add_u32 m0, s25, 49152
  v_exp_f32 v54, v54
  v_mfma_f32_16x16x32_bf16 a[108:111], a[240:243], v[36:39], 0
  ds_read_b64_tr_b16 a[238:239], v6 offset:18432
  v_mul_f32 v55, s30, v55
  v_mfma_f32_16x16x32_bf16 a[112:115], a[240:243], v[40:43], 0
  buffer_load_dwordx4 v8, s[16:19], s27 offen offset:0 nt lds
  v_add_f32 v16, v16, v54
  v_mfma_f32_16x16x32_bf16 a[116:119], a[240:243], v[44:47], 0
  s_waitcnt lgkmcnt(2)
  v_exp_f32 v55, v55
  v_mfma_f32_16x16x32_bf16 v[108:111], a[244:247], v[44:47], 0
  ds_read_b64_tr_b16 a[240:241], v7 offset:16384
  v_mul_f32 v76, s30, v76
  v_mfma_f32_16x16x32_bf16 a[136:139], a[244:247], v[40:43], 0
  v_add_f32 v16, v16, v55
  v_cvt_pk_bf16_f32 v53, v54, v55
  v_mfma_f32_16x16x32_bf16 a[132:135], a[244:247], v[36:39], 0
  s_add_u32 m0, s25, 53120
  v_exp_f32 v76, v76
  v_mfma_f32_16x16x32_bf16 a[128:131], a[244:247], v[32:35], 0
  ds_read_b64_tr_b16 a[242:243], v7 offset:18432
  v_mul_f32 v77, s30, v77
  v_mfma_f32_16x16x32_bf16 a[124:127], a[244:247], v[28:31], 0
  buffer_load_dwordx4 v8, s[16:19], s27 offen offset:128 nt lds
  v_add_f32 v16, v16, v76
  v_mfma_f32_16x16x32_bf16 a[120:123], a[244:247], v[24:27], 0
  s_waitcnt lgkmcnt(2)
  v_exp_f32 v77, v77
  v_mfma_f32_16x16x32_bf16 v[112:115], a[236:239], v[24:27], 0
  ds_read_b64_tr_b16 a[244:245], v4 offset:20480
  v_mul_f32 v78, s30, v78
  v_mfma_f32_16x16x32_bf16 v[116:119], a[236:239], v[28:31], 0
  v_add_f32 v16, v16, v77
  v_cvt_pk_bf16_f32 v54, v76, v77
  v_mfma_f32_16x16x32_bf16 v[120:123], a[236:239], v[32:35], 0
  s_add_u32 m0, s25, 57088
  v_exp_f32 v78, v78
  v_mfma_f32_16x16x32_bf16 v[124:127], a[236:239], v[36:39], 0
  ds_read_b64_tr_b16 a[246:247], v4 offset:22528
  v_mul_f32 v79, s30, v79
  v_mfma_f32_16x16x32_bf16 v[128:131], a[236:239], v[40:43], 0
  buffer_load_dwordx4 v8, s[16:19], s27 offen offset:256 nt lds
  v_add_f32 v16, v16, v78
  v_mfma_f32_16x16x32_bf16 v[132:135], a[236:239], v[44:47], 0
  s_waitcnt lgkmcnt(2)
  v_exp_f32 v79, v79
  v_mfma_f32_16x16x32_bf16 v[156:159], a[240:243], v[44:47], 0
  ds_read_b64_tr_b16 a[236:237], v5 offset:20480
  v_mul_f32 v56, s30, v56
  v_mfma_f32_16x16x32_bf16 v[152:155], a[240:243], v[40:43], 0
  v_add_f32 v16, v16, v79
  v_cvt_pk_bf16_f32 v55, v78, v79
  v_mfma_f32_16x16x32_bf16 v[148:151], a[240:243], v[36:39], 0
  s_add_u32 s27, s27, 12288
  v_exp_f32 v56, v56
  v_mfma_f32_16x16x32_bf16 v[144:147], a[240:243], v[32:35], 0
  ds_read_b64_tr_b16 a[238:239], v5 offset:22528
  s_cmp_eq_u32 s27, s59
  v_mul_f32 v57, s30, v57
  v_mfma_f32_16x16x32_bf16 v[140:143], a[240:243], v[28:31], 0
  s_cselect_b32 s27, s58, s27
  v_add_f32 v17, v17, v56
  v_mfma_f32_16x16x32_bf16 v[136:139], a[240:243], v[24:27], 0
  s_waitcnt lgkmcnt(2)
  v_exp_f32 v57, v57
  v_mfma_f32_16x16x32_bf16 v[160:163], a[244:247], v[24:27], 0
  ds_read_b64_tr_b16 a[240:241], v6 offset:20480
  v_mul_f32 v58, s30, v58
  v_mfma_f32_16x16x32_bf16 v[164:167], a[244:247], v[28:31], 0
  v_add_f32 v17, v17, v57
  v_cvt_pk_bf16_f32 v56, v56, v57
  v_mfma_f32_16x16x32_bf16 v[168:171], a[244:247], v[32:35], 0
  v_exp_f32 v58, v58
  v_mfma_f32_16x16x32_bf16 v[172:175], a[244:247], v[36:39], 0
  ds_read_b64_tr_b16 a[242:243], v6 offset:22528
  v_mul_f32 v59, s30, v59
  v_mfma_f32_16x16x32_bf16 v[176:179], a[244:247], v[40:43], 0
  v_add_f32 v17, v17, v58
  v_mfma_f32_16x16x32_bf16 v[180:183], a[244:247], v[44:47], 0
  s_waitcnt lgkmcnt(2)
  v_exp_f32 v59, v59
  v_mfma_f32_16x16x32_bf16 v[204:207], a[236:239], v[44:47], 0
  ds_read_b64_tr_b16 a[244:245], v7 offset:20480
  v_mul_f32 v80, s30, v80
  v_mfma_f32_16x16x32_bf16 v[200:203], a[236:239], v[40:43], 0
  v_add_f32 v17, v17, v59
  v_cvt_pk_bf16_f32 v57, v58, v59
  v_mfma_f32_16x16x32_bf16 v[196:199], a[236:239], v[36:39], 0
  v_exp_f32 v80, v80
  v_mfma_f32_16x16x32_bf16 v[192:195], a[236:239], v[32:35], 0
  ds_read_b64_tr_b16 a[246:247], v7 offset:22528
  v_mul_f32 v81, s30, v81
  v_mfma_f32_16x16x32_bf16 v[188:191], a[236:239], v[28:31], 0
  v_add_f32 v17, v17, v80
  v_mfma_f32_16x16x32_bf16 v[184:187], a[236:239], v[24:27], 0
  s_waitcnt lgkmcnt(2)
  v_exp_f32 v81, v81
  v_mfma_f32_16x16x32_bf16 v[208:211], a[240:243], v[24:27], 0
  v_mul_f32 v82, s30, v82
  v_mul_f32 v83, s30, v83
  v_mfma_f32_16x16x32_bf16 v[212:215], a[240:243], v[28:31], 0
  v_add_f32 v17, v17, v81
  v_cvt_pk_bf16_f32 v58, v80, v81
  v_mfma_f32_16x16x32_bf16 v[216:219], a[240:243], v[32:35], 0
  s_waitcnt vmcnt(12) lgkmcnt(0)
  v_exp_f32 v82, v82
  v_mfma_f32_16x16x32_bf16 v[220:223], a[240:243], v[36:39], 0
  s_barrier
  v_mfma_f32_16x16x32_bf16 v[224:227], a[240:243], v[40:43], 0
  ds_read_b128 a[236:239], v0 offset:24576
  v_add_f32 v17, v17, v82
  v_mfma_f32_16x16x32_bf16 v[228:231], a[240:243], v[44:47], 0
  v_exp_f32 v83, v83
  v_mfma_f32_16x16x32_bf16 v[252:255], a[244:247], v[44:47], 0
  ds_read_b128 a[248:251], v2 offset:0
  v_mul_f32 v60, s30, v60
  v_mfma_f32_16x16x32_bf16 v[248:251], a[244:247], v[40:43], 0
  v_add_f32 v17, v17, v83
  v_cvt_pk_bf16_f32 v59, v82, v83
  v_mfma_f32_16x16x32_bf16 v[244:247], a[244:247], v[36:39], 0
  v_exp_f32 v60, v60
  v_mfma_f32_16x16x32_bf16 v[240:243], a[244:247], v[32:35], 0
  ds_read_b128 a[252:255], v2 offset:2048
  v_mul_f32 v61, s30, v61
  v_mfma_f32_16x16x32_bf16 v[236:239], a[244:247], v[28:31], 0
  ds_read_b128 a[240:243], v0 offset:26624
  v_add_f32 v18, v18, v60
  v_mfma_f32_16x16x32_bf16 v[232:235], a[244:247], v[24:27], 0
  s_waitcnt lgkmcnt(3)
  v_exp_f32 v61, v61
  s_branch L_b1q
L_loop:
  v_mfma_f32_16x16x32_bf16 a[0:3], a[236:239], v[24:27], a[0:3]
  ds_read_b64_tr_b16 a[244:245], v6 offset:12288
  v_mul_f32 v50, s30, v50
  v_mfma_f32_16x16x32_bf16 a[4:7], a[236:239], v[28:31], a[4:7]
  v_add_f32 v15, v15, v49
  v_cvt_pk_bf16_f32 v48, v48, v49
  v_mfma_f32_16x16x32_bf16 a[8:11], a[236:239], v[32:35], a[8:11]
  v_exp_f32 v50, v50
  v_mfma_f32_16x16x32_bf16 a[12:15], a[236:239], v[36:39], a[12:15]
  ds_read_b64_tr_b16 a[246:247], v6 offset:14336
  v_mul_f32 v51, s30, v51
  v_mfma_f32_16x16x32_bf16 a[16:19], a[236:239], v[40:43], a[16:19]
  v_add_f32 v15, v15, v50
  v_mfma_f32_16x16x32_bf16 a[20:23], a[236:239], v[44:47], a[20:23]
  s_waitcnt lgkmcnt(2)
  v_exp_f32 v51, v51
  v_mfma_f32_16x16x32_bf16 a[44:47], a[240:243], v[44:47], a[44:47]
  ds_read_b64_tr_b16 a[236:237], v7 offset:12288
  v_mul_f32 v72, s30, v72
  v_mfma_f32_16x16x32_bf16 a[40:43], a[240:243], v[40:43], a[40:43]
  v_add_f32 v15, v15, v51
  v_cvt_pk_bf16_f32 v49, v50, v51
  v_mfma_f32_16x16x32_bf16 a[36:39], a[240:243], v[36:39], a[36:39]
  v_exp_f32 v72, v72
  v_mfma_f32_16x16x32_bf16 a[32:35], a[240:243], v[32:35], a[32:35]
  ds_read_b64_tr_b16 a[238:239], v7 offset:14336
  v_mul_f32 v73, s30, v73
  v_mfma_f32_16x16x32_bf16 a[28:31], a[240:243], v[28:31], a[28:31]
  v_add_f32 v15, v15, v72
  v_mfma_f32_16x16x32_bf16 a[24:27], a[240:243], v[24:27], a[24:27]
  s_waitcnt lgkmcnt(2)
  v_exp_f32 v73, v73
  v_mfma_f32_16x16x32_bf16 a[48:51], a[244:247], v[24:27], a[48:51]
  ds_read_b64_tr_b16 a[240:241], v4 offset:16384
  v_mul_f32 v74, s30, v74
  v_mfma_f32_16x16x32_bf16 a[52:55], a[244:247], v[28:31], a[52:55]
  v_add_f32 v15, v15, v73
  v_cvt_pk_bf16_f32 v50, v72, v73
  v_mfma_f32_16x16x32_bf16 a[56:59], a[244:247], v[32:35], a[56:59]
  v_exp_f32 v74, v74
  v_mfma_f32_16x16x32_bf16 a[60:63], a[244:247], v[36:39], a[60:63]
  ds_read_b64_tr_b16 a[242:243], v4 offset:18432
  v_mul_f32 v75, s30, v75
  v_mfma_f32_16x16x32_bf16 a[64:67], a[244:247], v[40:43], a[64:67]
  v_add_f32 v15, v15, v74
  v_mfma_f32_16x16x32_bf16 a[68:71], a[244:247], v[44:47], a[68:71]
  s_waitcnt lgkmcnt(2)
  v_exp_f32 v75, v75
  v_mfma_f32_16x16x32_bf16 a[92:95], a[236:239], v[44:47], a[92:95]
  ds_read_b64_tr_b16 a[244:245], v5 offset:16384
  v_mul_f32 v52, s30, v52
  v_mfma_f32_16x16x32_bf16 a[88:91], a[236:239], v[40:43], a[88:91]
  v_add_f32 v15, v15, v75
  v_cvt_pk_bf16_f32 v51, v74, v75
  v_mfma_f32_16x16x32_bf16 a[84:87], a[236:239], v[36:39], a[84:87]
  v_exp_f32 v52, v52
  v_mfma_f32_16x16x32_bf16 a[80:83], a[236:239], v[32:35], a[80:83]
  ds_read_b64_tr_b16 a[246:247], v5 offset:18432
  v_mul_f32 v53, s30, v53
  v_mfma_f32_16x16x32_bf16 a[76:79], a[236:239], v[28:31], a[76:79]
  v_add_f32 v16, v16, v52
  v_mfma_f32_16x16x32_bf16 a[72:75], a[236:239], v[24:27], a[72:75]
  s_waitcnt lgkmcnt(2)
  v_exp_f32 v53, v53
  v_mfma_f32_16x16x32_bf16 a[96:99], a[240:243], v[24:27], a[96:99]
  ds_read_b64_tr_b16 a[236:237], v6 offset:16384
  v_mul_f32 v54, s30, v54
  v_mfma_f32_16x16x32_bf16 a[100:103], a[240:243], v[28:31], a[100:103]
  v_add_f32 v16, v16, v53
  v_cvt_pk_bf16_f32 v52, v52, v53
  v_mfma_f32_16x16x32_bf16 a[104:107], a[240:243], v[32:35], a[104:107]
  v_exp_f32 v54, v54
  v_mfma_f32_16x16x32_bf16 a[108:111], a[240:243], v[36:39], a[108:111]
  ds_read_b64_tr_b16 a[238:239], v6 offset:18432
  v_mul_f32 v55, s30, v55
  v_mfma_f32_16x16x32_bf16 a[112:115], a[240:243], v[40:43], a[112:115]
  v_add_f32 v16, v16, v54
  v_mfma_f32_16x16x32_bf16 a[116:119], a[240:243], v[44:47], a[116:119]
  s_waitcnt lgkmcnt(2)
  v_exp_f32 v55, v55
  v_mfma_f32_16x16x32_bf16 v[108:111], a[244:247], v[44:47], v[108:111]
  ds_read_b64_tr_b16 a[240:241], v7 offset:16384
  v_mul_f32 v76, s30, v76
  v_mfma_f32_16x16x32_bf16 a[136:139], a[244:247], v[40:43], a[136:139]
  v_add_f32 v16, v16, v55
  v_cvt_pk_bf16_f32 v53, v54, v55
  v_mfma_f32_16x16x32_bf16 a[132:135], a[244:247], v[36:39], a[132:135]
  v_exp_f32 v76, v76
  v_mfma_f32_16x16x32_bf16 a[128:131], a[244:247], v[32:35], a[128:131]
  ds_read_b64_tr_b16 a[242:243], v7 offset:18432
  v_mul_f32 v77, s30, v77
  v_mfma_f32_16x16x32_bf16 a[124:127], a[244:247], v[28:31], a[124:127]
  v_add_f32 v16, v16, v76
  v_mfma_f32_16x16x32_bf16 a[120:123], a[244:247], v[24:27], a[120:123]
  s_waitcnt lgkmcnt(2)
  v_exp_f32 v77, v77
  v_mfma_f32_16x16x32_bf16 v[112:115], a[236:239], v[24:27], v[112:115]
  ds_read_b64_tr_b16 a[244:245], v4 offset:20480
  v_mul_f32 v78, s30, v78
  v_mfma_f32_16x16x32_bf16 v[116:119], a[236:239], v[28:31], v[116:119]
  v_add_f32 v16, v16, v77
  v_cvt_pk_bf16_f32 v54, v76, v77
  v_mfma_f32_16x16x32_bf16 v[120:123], a[236:239], v[32:35], v[120:123]
  v_exp_f32 v78, v78
  v_mfma_f32_16x16x32_bf16 v[124:127], a[236:239], v[36:39], v[124:127]
  ds_read_b64_tr_b16 a[246:247], v4 offset:22528
  v_mul_f32 v79, s30, v79
  v_mfma_f32_16x16x32_bf16 v[128:131], a[236:239], v[40:43], v[128:131]
  v_add_f32 v16, v16, v78
  v_mfma_f32_16x16x32_bf16 v[132:135], a[236:239], v[44:47], v[132:135]
  s_waitcnt lgkmcnt(2)
  v_exp_f32 v79, v79
  v_mfma_f32_16x16x32_bf16 v[156:159], a[240:243], v[44:47], v[156:159]
  ds_read_b64_tr_b16 a[236:237], v5 offset:20480
  v_mul_f32 v56, s30, v56
  v_mfma_f32_16x16x32_bf16 v[152:155], a[240:243], v[40:43], v[152:155]
  v_add_f32 v16, v16, v79
  v_cvt_pk_bf16_f32 v55, v78, v79
  v_mfma_f32_16x16x32_bf16 v[148:151], a[240:243], v[36:39], v[148:151]
  v_exp_f32 v56, v56
  v_mfma_f32_16x16x32_bf16 v[144:147], a[240:243], v[32:35], v[144:147]
  ds_read_b64_tr_b16 a[238:239], v5 offset:22528
  v_mul_f32 v57, s30, v57
  v_mfma_f32_16x16x32_bf16 v[140:143], a[240:243], v[28:31], v[140:143]
  v_add_f32 v17, v17, v56
  v_mfma_f32_16x16x32_bf16 v[136:139], a[240:243], v[24:27], v[136:139]
  s_waitcnt lgkmcnt(2)
  v_exp_f32 v57, v57
  v_mfma_f32_16x16x32_bf16 v[160:163], a[244:247], v[24:27], v[160:163]
  ds_read_b64_tr_b16 a[240:241], v6 offset:20480
  v_mul_f32 v58, s30, v58
  v_mfma_f32_16x16x32_bf16 v[164:167], a[244:247], v[28:31], v[164:167]
  v_add_f32 v17, v17, v57
  v_cvt_pk_bf16_f32 v56, v56, v57
  v_mfma_f32_16x16x32_bf16 v[168:171], a[244:247], v[32:35], v[168:171]
  v_exp_f32 v58, v58
  v_mfma_f32_16x16x32_bf16 v[172:175], a[244:247], v[36:39], v[172:175]
  ds_read_b64_tr_b16 a[242:243], v6 offset:22528
  v_mul_f32 v59, s30, v59
  v_mfma_f32_16x16x32_bf16 v[176:179], a[244:247], v[40:43], v[176:179]
  v_add_f32 v17, v17, v58
  v_mfma_f32_16x16x32_bf16 v[180:183], a[244:247], v[44:47], v[180:183]
  s_waitcnt lgkmcnt(2)
  v_exp_f32 v59, v59
  v_mfma_f32_16x16x32_bf16 v[204:207], a[236:239], v[44:47], v[204:207]
  ds_read_b64_tr_b16 a[244:245], v7 offset:20480
  v_mul_f32 v80, s30, v80
  v_mfma_f32_16x16x32_bf16 v[200:203], a[236:239], v[40:43], v[200:203]
  v_add_f32 v17, v17, v59
  v_cvt_pk_bf16_f32 v57, v58, v59
  v_mfma_f32_16x16x32_bf16 v[196:199], a[236:239], v[36:39], v[196:199]
  v_exp_f32 v80, v80
  v_mfma_f32_16x16x32_bf16 v[192:195], a[236:239], v[32:35], v[192:195]
  ds_read_b64_tr_b16 a[246:247], v7 offset:22528
  v_mul_f32 v81, s30, v81
  v_mfma_f32_16x16x32_bf16 v[188:191], a[236:239], v[28:31], v[188:191]
  v_add_f32 v17, v17, v80
  v_mfma_f32_16x16x32_bf16 v[184:187], a[236:239], v[24:27], v[184:187]
  s_waitcnt lgkmcnt(2)
  v_exp_f32 v81, v81
  v_mfma_f32_16x16x32_bf16 v[208:211], a[240:243], v[24:27], v[208:211]
  v_mul_f32 v82, s30, v82
  v_mul_f32 v83, s30, v83
  v_mfma_f32_16x16x32_bf16 v[212:215], a[240:243], v[28:31], v[212:215]
  v_add_f32 v17, v17, v81
  v_cvt_pk_bf16_f32 v58, v80, v81
  v_mfma_f32_16x16x32_bf16 v[216:219], a[240:243], v[32:35], v[216:219]
  s_waitcnt vmcnt(12) lgkmcnt(0)
  v_exp_f32 v82, v82
  v_mfma_f32_16x16x32_bf16 v[220:223], a[240:243], v[36:39], v[220:223]
  s_barrier
  v_mfma_f32_16x16x32_bf16 v[224:227], a[240:243], v[40:43], v[224:227]
  ds_read_b128 a[236:239], v0 offset:24576
  v_add_f32 v17, v17, v82
  v_mfma_f32_16x16x32_bf16 v[228:231], a[240:243], v[44:47], v[228:231]
  v_exp_f32 v83, v83
  v_mfma_f32_16x16x32_bf16 v[252:255], a[244:247], v[44:47], v[252:255]
  ds_read_b128 a[248:251], v2 offset:0
  v_mul_f32 v60, s30, v60
  v_mfma_f32_16x16x32_bf16 v[248:251], a[244:247], v[40:43], v[248:251]
  v_add_f32 v17, v17, v83
  v_cvt_pk_bf16_f32 v59, v82, v83
  v_mfma_f32_16x16x32_bf16 v[244:247], a[244:247], v[36:39], v[244:247]
  v_exp_f32 v60, v60
  v_mfma_f32_16x16x32_bf16 v[240:243], a[244:247], v[32:35], v[240:243]
  ds_read_b128 a[252:255], v2 offset:2048
  v_mul_f32 v61, s30, v61
  v_mfma_f32_16x16x32_bf16 v[236:239], a[244:247], v[28:31], v[236:239]
  ds_read_b128 a[240:243], v0 offset:26624
  v_add_f32 v18, v18, v60
  v_mfma_f32_16x16x32_bf16 v[232:235], a[244:247], v[24:27], v[232:235]
  s_waitcnt lgkmcnt(3)
  v_exp_f32 v61, v61
L_b1q:
  v_mfma_f32_16x16x32_bf16 v[24:27], a[236:239], a[140:143], v[10:13]
  ds_read_b128 a[244:247], v1 offset:24576
  v_mul_f32 v62, s30, v62
  v_mfma_f32_16x16x32_bf16 v[28:31], a[236:239], a[164:167], v[10:13]
  v_add_f32 v18, v18, v61
  v_cvt_pk_bf16_f32 v60, v60, v61
  v_mfma_f32_16x16x32_bf16 v[32:35], a[236:239], a[188:191], v[10:13]
  s_add_u32 m0, s25, 12288
  v_exp_f32 v62, v62
  v_mfma_f32_16x16x32_bf16 v[36:39], a[236:239], a[212:215], v[10:13]
  s_waitcnt lgkmcnt(2)
  v_mul_f32 v63, s30, v63
  v_add_f32 v18, v18, v62
  v_mfma_f32_16x16x32_bf16 v[40:43], a[236:239], a[248:251], v[10:13]
  buffer_load_dwordx4 v8, s[12:15], s26 offen offset:0 nt lds
  v_mfma_f32_16x16x32_bf16 v[44:47], a[236:239], a[252:255], v[10:13]
  s_waitcnt lgkmcnt(1)
  v_exp_f32 v63, v63
  v_mfma_f32_16x16x32_bf16 v[92:95], a[240:243], a[252:255], v[10:13]
  ds_read_b128 a[252:255], v3 offset:2048
  v_mul_f32 v96, s30, v96
  v_mfma_f32_16x16x32_bf16 v[88:91], a[240:243], a[248:251], v[10:13]
  v_add_f32 v18, v18, v63
  v_cvt_pk_bf16_f32 v61, v62, v63
  v_mfma_f32_16x16x32_bf16 v[84:87], a[240:243], a[212:215], v[10:13]
  v_exp_f32 v96, v96
  v_mfma_f32_16x16x32_bf16 v[80:83], a[240:243], a[188:191], v[10:13]
  ds_read_b128 a[248:251], v3 offset:0
  v_mul_f32 v97, s30, v97
  v_mfma_f32_16x16x32_bf16 v[76:79], a[240:243], a[164:167], v[10:13]
  ds_read_b128 a[236:239], v1 offset:26624
  v_add_f32 v18, v18, v96
  v_mfma_f32_16x16x32_bf16 v[72:75], a[240:243], a[140:143], v[10:13]
  s_waitcnt lgkmcnt(3)
  v_exp_f32 v97, v97
  v_mfma_f32_16x16x32_bf16 v[24:27], a[244:247], a[144:147], v[24:27]
  ds_read_b128 a[240:243], v0 offset:28672
  v_mul_f32 v98, s30, v98
  v_mfma_f32_16x16x32_bf16 v[28:31], a[244:247], a[168:171], v[28:31]
  v_add_f32 v18, v18, v97
  v_cvt_pk_bf16_f32 v62, v96, v97
  v_mfma_f32_16x16x32_bf16 v[32:35], a[244:247], a[192:195], v[32:35]
  s_add_u32 m0, s25, 16256
  v_exp_f32 v98, v98
  v_mfma_f32_16x16x32_bf16 v[36:39], a[244:247], a[216:219], v[36:39]
  s_waitcnt lgkmcnt(2)
  v_mul_f32 v99, s30, v99
  v_add_f32 v18, v18, v98
  v_mfma_f32_16x16x32_bf16 v[40:43], a[244:247], a[248:251], v[40:43]
  buffer_load_dwordx4 v8, s[12:15], s26 offen offset:128 nt lds
  v_mfma_f32_16x16x32_bf16 v[44:47], a[244:247], a[252:255], v[44:47]
  s_waitcnt lgkmcnt(1)
  v_exp_f32 v99, v99
  v_mfma_f32_16x16x32_bf16 v[92:95], a[236:239], a[252:255], v[92:95]
  ds_read_b128 a[252:255], v2 offset:6144
  v_mul_f32 v64, s30, v64
  v_mfma_f32_16x16x32_bf16 v[88:91], a[236:239], a[248:251], v[88:91]
  v_add_f32 v18, v18, v99
  v_cvt_pk_bf16_f32 v63, v98, v99
  v_mfma_f32_16x16x32_bf16 v[84:87], a[236:239], a[216:219], v[84:87]
  v_exp_f32 v64, v64
  v_mfma_f32_16x16x32_bf16 v[80:83], a[236:239], a[192:195], v[80:83]
  ds_read_b128 a[248:251], v2 offset:4096
  v_mul_f32 v65, s30, v65
  v_mfma_f32_16x16x32_bf16 v[76:79], a[236:239], a[168:171], v[76:79]
  ds_read_b128 a[244:247], v0 offset:30720
  v_add_f32 v19, v19, v64
  v_mfma_f32_16x16x32_bf16 v[72:75], a[236:239], a[144:147], v[72:75]
  s_waitcnt lgkmcnt(3)
  v_exp_f32 v65, v65
  v_mfma_f32_16x16x32_bf16 v[24:27], a[240:243], a[148:151], v[24:27]
  ds_read_b128 a[236:239], v1 offset:28672
  v_mul_f32 v66, s30, v66
  v_mfma_f32_16x16x32_bf16 v[28:31], a[240:243], a[172:175], v[28:31]
  v_add_f32 v19, v19, v65
  v_cvt_pk_bf16_f32 v64, v64, v65
  v_mfma_f32_16x16x32_bf16 v[32:35], a[240:243], a[196:199], v[32:35]
  s_add_u32 m0, s25, 20224
  v_exp_f32 v66, v66
  v_mfma_f32_16x16x32_bf16 v[36:39], a[240:243], a[220:223], v[36:39]
  s_waitcnt lgkmcnt(2)
  v_mul_f32 v67, s30, v67
  v_add_f32 v19, v19, v66
  v_mfma_f32_16x16x32_bf16 v[40:43], a[240:243], a[248:251], v[40:43]
  buffer_load_dwordx4 v8, s[12:15], s26 offen offset:256 nt lds
  v_mfma_f32_16x16x32_bf16 v[44:47], a[240:243], a[252:255], v[44:47]
  s_waitcnt lgkmcnt(1)
  v_exp_f32 v67, v67
  v_mfma_f32_16x16x32_bf16 v[92:95], a[244:247], a[252:255], v[92:95]
  ds_read_b128 a[252:255], v3 offset:6144
  v_mul_f32 v100, s30, v100
  v_mfma_f32_16x16x32_bf16 v[88:91], a[244:247], a[248:251], v[88:91]
  v_add_f32 v19, v19, v67
  v_cvt_pk_bf16_f32 v65, v66, v67
  v_mfma_f32_16x16x32_bf16 v[84:87], a[244:247], a[220:223], v[84:87]
  s_add_u32 s26, s26, 12288
  v_exp_f32 v100, v100
  v_mfma_f32_16x16x32_bf16 v[80:83], a[244:247], a[196:199], v[80:83]
  ds_read_b128 a[248:251], v3 offset:4096
  s_cmp_eq_u32 s26, s57
  v_mul_f32 v101, s30, v101
  v_mfma_f32_16x16x32_bf16 v[76:79], a[244:247], a[172:175], v[76:79]
  ds_read_b128 a[240:243], v1 offset:30720
  s_cselect_b32 s26, s56, s26
  v_add_f32 v19, v19, v100
  v_mfma_f32_16x16x32_bf16 v[72:75], a[244:247], a[148:151], v[72:75]
  s_waitcnt lgkmcnt(3)
  v_exp_f32 v101, v101
  v_mfma_f32_16x16x32_bf16 v[24:27], a[236:239], a[152:155], v[24:27]
  ds_read_b128 a[244:247], v0 offset:32768
  v_mul_f32 v102, s30, v102
  v_mfma_f32_16x16x32_bf16 v[28:31], a[236:239], a[176:179], v[28:31]
  v_add_f32 v19, v19, v101
  v_cvt_pk_bf16_f32 v66, v100, v101
  v_mfma_f32_16x16x32_bf16 v[32:35], a[236:239], a[200:203], v[32:35]
  s_add_u32 m0, s25, 61440
  v_exp_f32 v102, v102
  v_mfma_f32_16x16x32_bf16 v[36:39], a[236:239], a[224:227], v[36:39]
  s_waitcnt lgkmcnt(2)
  v_mul_f32 v103, s30, v103
  v_add_f32 v19, v19, v102
  v_mfma_f32_16x16x32_bf16 v[40:43], a[236:239], a[248:251], v[40:43]
  buffer_load_dwordx4 v8, s[16:19], s27 offen offset:0 nt lds
  v_mfma_f32_16x16x32_bf16 v[44:47], a[236:239], a[252:255], v[44:47]
  s_waitcnt lgkmcnt(1)
  v_exp_f32 v103, v103
  v_mfma_f32_16x16x32_bf16 v[92:95], a[240:243], a[252:255], v[92:95]
  ds_read_b128 a[252:255], v2 offset:10240
  v_mul_f32 v68, s30, v68
  v_mfma_f32_16x16x32_bf16 v[88:91], a[240:243], a[248:251], v[88:91]
  v_add_f32 v19, v19, v103
  v_cvt_pk_bf16_f32 v67, v102, v103
  v_mfma_f32_16x16x32_bf16 v[84:87], a[240:243], a[224:227], v[84:87]
  v_exp_f32 v68, v68
  v_mfma_f32_16x16x32_bf16 v[80:83], a[240:243], a[200:203], v[80:83]
  ds_read_b128 a[248:251], v2 offset:8192
  v_mul_f32 v69, s30, v69
  v_mfma_f32_16x16x32_bf16 v[76:79], a[240:243], a[176:179], v[76:79]
  ds_read_b128 a[236:239], v0 offset:34816
  v_add_f32 v20, v20, v68
  v_mfma_f32_16x16x32_bf16 v[72:75], a[240:243], a[152:155], v[72:75]
  s_waitcnt lgkmcnt(3)
  v_exp_f32 v69, v69
  v_mfma_f32_16x16x32_bf16 v[24:27], a[244:247], a[156:159], v[24:27]
  ds_read_b128 a[240:243], v1 offset:32768
  v_mul_f32 v70, s30, v70
  v_mfma_f32_16x16x32_bf16 v[28:31], a[244:247], a[180:183], v[28:31]
  v_add_f32 v20, v20, v69
  v_cvt_pk_bf16_f32 v68, v68, v69
  v_mfma_f32_16x16x32_bf16 v[32:35], a[244:247], a[204:207], v[32:35]
  s_add_u32 m0, s25, 65408
  v_exp_f32 v70, v70
  v_mfma_f32_16x16x32_bf16 v[36:39], a[244:247], a[228:231], v[36:39]
  s_waitcnt lgkmcnt(2)
  v_mul_f32 v71, s30, v71
  v_add_f32 v20, v20, v70
  v_mfma_f32_16x16x32_bf16 v[40:43], a[244:247], a[248:251], v[40:43]
  buffer_load_dwordx4 v8, s[16:19], s27 offen offset:128 nt lds
  v_mfma_f32_16x16x32_bf16 v[44:47], a[244:247], a[252:255], v[44:47]
  s_waitcnt lgkmcnt(1)
  v_exp_f32 v71, v71
  v_mfma_f32_16x16x32_bf16 v[92:95], a[236:239], a[252:255], v[92:95]
  ds_read_b128 a[252:255], v3 offset:10240
  v_mul_f32 v104, s30, v104
  v_mfma_f32_16x16x32_bf16 v[88:91], a[236:239], a[248:251], v[88:91]
  v_add_f32 v20, v20, v71
  v_cvt_pk_bf16_f32 v69, v70, v71
  v_mfma_f32_16x16x32_bf16 v[84:87], a[236:239], a[228:231], v[84:87]
  v_exp_f32 v104, v104
  v_mfma_f32_16x16x32_bf16 v[80:83], a[236:239], a[204:207], v[80:83]
  ds_read_b128 a[248:251], v3 offset:8192
  v_mul_f32 v105, s30, v105
  v_mfma_f32_16x16x32_bf16 v[76:79], a[236:239], a[180:183], v[76:79]
  ds_read_b128 a[244:247], v1 offset:34816
  v_add_f32 v20, v20, v104
  v_mfma_f32_16x16x32_bf16 v[72:75], a[236:239], a[156:159], v[72:75]
  s_waitcnt lgkmcnt(3)
  v_exp_f32 v105, v105
  v_mfma_f32_16x16x32_bf16 v[24:27], a[240:243], a[160:163], v[24:27]
  ds_read_b64_tr_b16 a[236:237], v4 offset:24576
  v_mul_f32 v106, s30, v106
  v_mfma_f32_16x16x32_bf16 v[28:31], a[240:243], a[184:187], v[28:31]
  v_add_f32 v20, v20, v105
  v_cvt_pk_bf16_f32 v70, v104, v105
  v_mfma_f32_16x16x32_bf16 v[32:35], a[240:243], a[208:211], v[32:35]
  s_add_u32 m0, s25, 69376
  v_exp_f32 v106, v106
  v_mfma_f32_16x16x32_bf16 v[36:39], a[240:243], a[232:235], v[36:39]
  ds_read_b64_tr_b16 a[238:239], v4 offset:26624
  s_waitcnt lgkmcnt(3)
  v_mul_f32 v107, s30, v107
  v_mfma_f32_16x16x32_bf16 v[40:43], a[240:243], a[248:251], v[40:43]
  buffer_load_dwordx4 v8, s[16:19], s27 offen offset:256 nt lds
  v_add_f32 v20, v20, v106
  v_mfma_f32_16x16x32_bf16 v[44:47], a[240:243], a[252:255], v[44:47]
  s_waitcnt lgkmcnt(2)
  v_exp_f32 v107, v107
  v_mfma_f32_16x16x32_bf16 v[92:95], a[244:247], a[252:255], v[92:95]
  ds_read_b64_tr_b16 a[240:241], v5 offset:24576
  v_mul_f32 v24, s30, v24
  v_mfma_f32_16x16x32_bf16 v[88:91], a[244:247], a[248:251], v[88:91]
  v_add_f32 v20, v20, v107
  v_cvt_pk_bf16_f32 v71, v106, v107
  v_mfma_f32_16x16x32_bf16 v[84:87], a[244:247], a[232:235], v[84:87]
  s_add_u32 s27, s27, 12288
  v_exp_f32 v24, v24
  v_mfma_f32_16x16x32_bf16 v[80:83], a[244:247], a[208:211], v[80:83]
  ds_read_b64_tr_b16 a[242:243], v5 offset:26624
  s_cmp_eq_u32 s27, s59
  v_mul_f32 v25, s30, v25
  v_mfma_f32_16x16x32_bf16 v[76:79], a[244:247], a[184:187], v[76:79]
  s_cselect_b32 s27, s58, s27
  v_add_f32 v15, v15, v24
  v_mfma_f32_16x16x32_bf16 v[72:75], a[244:247], a[160:163], v[72:75]
  s_waitcnt lgkmcnt(2)
  v_exp_f32 v25, v25
  v_mfma_f32_16x16x32_bf16 a[0:3], a[236:239], v[48:51], a[0:3]
  ds_read_b64_tr_b16 a[244:245], v6 offset:24576
  v_mul_f32 v26, s30, v26
  v_mfma_f32_16x16x32_bf16 a[4:7], a[236:239], v[52:55], a[4:7]
  v_add_f32 v15, v15, v25
  v_cvt_pk_bf16_f32 v24, v24, v25
  v_mfma_f32_16x16x32_bf16 a[8:11], a[236:239], v[56:59], a[8:11]
  v_exp_f32 v26, v26
  v_mfma_f32_16x16x32_bf16 a[12:15], a[236:239], v[60:63], a[12:15]
  ds_read_b64_tr_b16 a[246:247], v6 offset:26624
  v_mul_f32 v27, s30, v27
  v_mfma_f32_16x16x32_bf16 a[16:19], a[236:239], v[64:67], a[16:19]
  v_add_f32 v15, v15, v26
  v_mfma_f32_16x16x32_bf16 a[20:23], a[236:239], v[68:71], a[20:23]
  s_waitcnt lgkmcnt(2)
  v_exp_f32 v27, v27
  v_mfma_f32_16x16x32_bf16 a[44:47], a[240:243], v[68:71], a[44:47]
  ds_read_b64_tr_b16 a[236:237], v7 offset:24576
  v_mul_f32 v72, s30, v72
  v_mfma_f32_16x16x32_bf16 a[40:43], a[240:243], v[64:67], a[40:43]
  v_add_f32 v15, v15, v27
  v_cvt_pk_bf16_f32 v25, v26, v27
  v_mfma_f32_16x16x32_bf16 a[36:39], a[240:243], v[60:63], a[36:39]
  v_exp_f32 v72, v72
  v_mfma_f32_16x16x32_bf16 a[32:35], a[240:243], v[56:59], a[32:35]
  ds_read_b64_tr_b16 a[238:239], v7 offset:26624
  v_mul_f32 v73, s30, v73
  v_mfma_f32_16x16x32_bf16 a[28:31], a[240:243], v[52:55], a[28:31]
  v_add_f32 v15, v15, v72
  v_mfma_f32_16x16x32_bf16 a[24:27], a[240:243], v[48:51], a[24:27]
  s_waitcnt lgkmcnt(2)
  v_exp_f32 v73, v73
  v_mfma_f32_16x16x32_bf16 a[48:51], a[244:247], v[48:51], a[48:51]
  ds_read_b64_tr_b16 a[240:241], v4 offset:28672
  v_mul_f32 v74, s30, v74
  v_mfma_f32_16x16x32_bf16 a[52:55], a[244:247], v[52:55], a[52:55]
  v_add_f32 v15, v15, v73
  v_cvt_pk_bf16_f32 v26, v72, v73
  v_mfma_f32_16x16x32_bf16 a[56:59], a[244:247], v[56:59], a[56:59]
  v_exp_f32 v74, v74
  v_mfma_f32_16x16x32_bf16 a[60:63], a[244:247], v[60:63], a[60:63]
  ds_read_b64_tr_b16 a[242:243], v4 offset:30720
  v_mul_f32 v75, s30, v75
  v_mfma_f32_16x16x32_bf16 a[64:67], a[244:247], v[64:67], a[64:67]
  v_add_f32 v15, v15, v74
  v_mfma_f32_16x16x32_bf16 a[68:71], a[244:247], v[68:71], a[68:71]
  s_waitcnt lgkmcnt(2)
  v_exp_f32 v75, v75
  v_mfma_f32_16x16x32_bf16 a[92:95], a[236:239], v[68:71], a[92:95]
  ds_read_b64_tr_b16 a[244:245], v5 offset:28672
  v_mul_f32 v28, s30, v28
  v_mfma_f32_16x16x32_bf16 a[88:91], a[236:239], v[64:67], a[88:91]
  v_add_f32 v15, v15, v75
  v_cvt_pk_bf16_f32 v27, v74, v75
  v_mfma_f32_16x16x32_bf16 a[84:87], a[236:239], v[60:63], a[84:87]
  v_exp_f32 v28, v28
  v_mfma_f32_16x16x32_bf16 a[80:83], a[236:239], v[56:59], a[80:83]
  ds_read_b64_tr_b16 a[246:247], v5 offset:30720
  v_mul_f32 v29, s30, v29
  v_mfma_f32_16x16x32_bf16 a[76:79], a[236:239], v[52:55], a[76:79]
  v_add_f32 v16, v16, v28
  v_mfma_f32_16x16x32_bf16 a[72:75], a[236:239], v[48:51], a[72:75]
  s_waitcnt lgkmcnt(2)
  v_exp_f32 v29, v29
  v_mfma_f32_16x16x32_bf16 a[96:99], a[240:243], v[48:51], a[96:99]
  ds_read_b64_tr_b16 a[236:237], v6 offset:28672
  v_mul_f32 v30, s30, v30
  v_mfma_f32_16x16x32_bf16 a[100:103], a[240:243], v[52:55], a[100:103]
  v_add_f32 v16, v16, v29
  v_cvt_pk_bf16_f32 v28, v28, v29
  v_mfma_f32_16x16x32_bf16 a[104:107], a[240:243], v[56:59], a[104:107]
  v_exp_f32 v30, v30
  v_mfma_f32_16x16x32_bf16 a[108:111], a[240:243], v[60:63], a[108:111]
  ds_read_b64_tr_b16 a[238:239], v6 offset:30720
  v_mul_f32 v31, s30, v31
  v_mfma_f32_16x16x32_bf16 a[112:115], a[240:243], v[64:67], a[112:115]
  v_add_f32 v16, v16, v30
  v_mfma_f32_16x16x32_bf16 a[116:119], a[240:243], v[68:71], a[116:119]
  s_waitcnt lgkmcnt(2)
  v_exp_f32 v31, v31
  v_mfma_f32_16x16x32_bf16 v[108:111], a[244:247], v[68:71], v[108:111]
  ds_read_b64_tr_b16 a[240:241], v7 offset:28672
  v_mul_f32 v76, s30, v76
  v_mfma_f32_16x16x32_bf16 a[136:139], a[244:247], v[64:67], a[136:139]
  v_add_f32 v16, v16, v31
  v_cvt_pk_bf16_f32 v29, v30, v31
  v_mfma_f32_16x16x32_bf16 a[132:135], a[244:247], v[60:63], a[132:135]
  v_exp_f32 v76, v76
  v_mfma_f32_16x16x32_bf16 a[128:131], a[244:247], v[56:59], a[128:131]
  ds_read_b64_tr_b16 a[242:243], v7 offset:30720
  v_mul_f32 v77, s30, v77
  v_mfma_f32_16x16x32_bf16 a[124:127], a[244:247], v[52:55], a[124:127]
  v_add_f32 v16, v16, v76
  v_mfma_f32_16x16x32_bf16 a[120:123], a[244:247], v[48:51], a[120:123]
  s_waitcnt lgkmcnt(2)
  v_exp_f32 v77, v77
  v_mfma_f32_16x16x32_bf16 v[112:115], a[236:239], v[48:51], v[112:115]
  ds_read_b64_tr_b16 a[244:245], v4 offset:32768
  v_mul_f32 v78, s30, v78
  v_mfma_f32_16x16x32_bf16 v[116:119], a[236:239], v[52:55], v[116:119]
  v_add_f32 v16, v16, v77
  v_cvt_pk_bf16_f32 v30, v76, v77
  v_mfma_f32_16x16x32_bf16 v[120:123], a[236:239], v[56:59], v[120:123]
  v_exp_f32 v78, v78
  v_mfma_f32_16x16x32_bf16 v[124:127], a[236:239], v[60:63], v[124:127]
  ds_read_b64_tr_b16 a[246:247], v4 offset:34816
  v_mul_f32 v79, s30, v79
  v_mfma_f32_16x16x32_bf16 v[128:131], a[236:239], v[64:67], v[128:131]
  v_add_f32 v16, v16, v78
  v_mfma_f32_16x16x32_bf16 v[132:135], a[236:239], v[68:71], v[132:135]
  s_waitcnt lgkmcnt(2)
  v_exp_f32 v79, v79
  v_mfma_f32_16x16x32_bf16 v[156:159], a[240:243], v[68:71], v[156:159]
  ds_read_b64_tr_b16 a[236:237], v5 offset:32768
  v_mul_f32 v32, s30, v32
  v_mfma_f32_16x16x32_bf16 v[152:155], a[240:243], v[64:67], v[152:155]
  v_add_f32 v16, v16, v79
  v_cvt_pk_bf16_f32 v31, v78, v79
  v_mfma_f32_16x16x32_bf16 v[148:151], a[240:243], v[60:63], v[148:151]
  v_exp_f32 v32, v32
  v_mfma_f32_16x16x32_bf16 v[144:147], a[240:243], v[56:59], v[144:147]
  ds_read_b64_tr_b16 a[238:239], v5 offset:34816
  v_mul_f32 v33, s30, v33
  v_mfma_f32_16x16x32_bf16 v[140:143], a[240:243], v[52:55], v[140:143]
  v_add_f32 v17, v17, v32
  v_mfma_f32_16x16x32_bf16 v[136:139], a[240:243], v[48:51], v[136:139]
  s_waitcnt lgkmcnt(2)
  v_exp_f32 v33, v33
  v_mfma_f32_16x16x32_bf16 v[160:163], a[244:247], v[48:51], v[160:163]
  ds_read_b64_tr_b16 a[240:241], v6 offset:32768
  v_mul_f32 v34, s30, v34
  v_mfma_f32_16x16x32_bf16 v[164:167], a[244:247], v[52:55], v[164:167]
  v_add_f32 v17, v17, v33
  v_cvt_pk_bf16_f32 v32, v32, v33
  v_mfma_f32_16x16x32_bf16 v[168:171], a[244:247], v[56:59], v[168:171]
  v_exp_f32 v34, v34
  v_mfma_f32_16x16x32_bf16 v[172:175], a[244:247], v[60:63], v[172:175]
  ds_read_b64_tr_b16 a[242:243], v6 offset:34816
  v_mul_f32 v35, s30, v35
  v_mfma_f32_16x16x32_bf16 v[176:179], a[244:247], v[64:67], v[176:179]
  v_add_f32 v17, v17, v34
  v_mfma_f32_16x16x32_bf16 v[180:183], a[244:247], v[68:71], v[180:183]
  s_waitcnt lgkmcnt(2)
  v_exp_f32 v35, v35
  v_mfma_f32_16x16x32_bf16 v[204:207], a[236:239], v[68:71], v[204:207]
  ds_read_b64_tr_b16 a[244:245], v7 offset:32768
  v_mul_f32 v80, s30, v80
  v_mfma_f32_16x16x32_bf16 v[200:203], a[236:239], v[64:67], v[200:203]
  v_add_f32 v17, v17, v35
  v_cvt_pk_bf16_f32 v33, v34, v35
  v_mfma_f32_16x16x32_bf16 v[196:199], a[236:239], v[60:63], v[196:199]
  v_exp_f32 v80, v80
  v_mfma_f32_16x16x32_bf16 v[192:195], a[236:239], v[56:59], v[192:195]
  ds_read_b64_tr_b16 a[246:247], v7 offset:34816
  v_mul_f32 v81, s30, v81
  v_mfma_f32_16x16x32_bf16 v[188:191], a[236:239], v[52:55], v[188:191]
  v_add_f32 v17, v17, v80
  v_mfma_f32_16x16x32_bf16 v[184:187], a[236:239], v[48:51], v[184:187]
  s_waitcnt lgkmcnt(2)
  v_exp_f32 v81, v81
  v_mfma_f32_16x16x32_bf16 v[208:211], a[240:243], v[48:51], v[208:211]
  v_mul_f32 v82, s30, v82
  v_mul_f32 v83, s30, v83
  v_mfma_f32_16x16x32_bf16 v[212:215], a[240:243], v[52:55], v[212:215]
  v_add_f32 v17, v17, v81
  v_cvt_pk_bf16_f32 v34, v80, v81
  v_mfma_f32_16x16x32_bf16 v[216:219], a[240:243], v[56:59], v[216:219]
  s_waitcnt vmcnt(12) lgkmcnt(0)
  v_exp_f32 v82, v82
  v_mfma_f32_16x16x32_bf16 v[220:223], a[240:243], v[60:63], v[220:223]
  s_barrier
  v_mfma_f32_16x16x32_bf16 v[224:227], a[240:243], v[64:67], v[224:227]
  ds_read_b128 a[236:239], v0 offset:36864
  v_add_f32 v17, v17, v82
  v_mfma_f32_16x16x32_bf16 v[228:231], a[240:243], v[68:71], v[228:231]
  v_exp_f32 v83, v83
  v_mfma_f32_16x16x32_bf16 v[252:255], a[244:247], v[68:71], v[252:255]
  ds_read_b128 a[248:251], v2 offset:0
  v_mul_f32 v36, s30, v36
  v_mfma_f32_16x16x32_bf16 v[248:251], a[244:247], v[64:67], v[248:251]
  v_add_f32 v17, v17, v83
  v_cvt_pk_bf16_f32 v35, v82, v83
  v_mfma_f32_16x16x32_bf16 v[244:247], a[244:247], v[60:63], v[244:247]
  v_exp_f32 v36, v36
  v_mfma_f32_16x16x32_bf16 v[240:243], a[244:247], v[56:59], v[240:243]
  ds_read_b128 a[252:255], v2 offset:2048
  v_mul_f32 v37, s30, v37
  v_mfma_f32_16x16x32_bf16 v[236:239], a[244:247], v[52:55], v[236:239]
  ds_read_b128 a[240:243], v0 offset:38912
  v_add_f32 v18, v18, v36
  v_mfma_f32_16x16x32_bf16 v[232:235], a[244:247], v[48:51], v[232:235]
  s_waitcnt lgkmcnt(3)
  v_exp_f32 v37, v37
  v_mfma_f32_16x16x32_bf16 v[48:51], a[236:239], a[140:143], v[10:13]
  ds_read_b128 a[244:247], v1 offset:36864
  v_mul_f32 v38, s30, v38
  v_mfma_f32_16x16x32_bf16 v[52:55], a[236:239], a[164:167], v[10:13]
  v_add_f32 v18, v18, v37
  v_cvt_pk_bf16_f32 v36, v36, v37
  v_mfma_f32_16x16x32_bf16 v[56:59], a[236:239], a[188:191], v[10:13]
  s_add_u32 m0, s25, 24576
  v_exp_f32 v38, v38
  v_mfma_f32_16x16x32_bf16 v[60:63], a[236:239], a[212:215], v[10:13]
  s_waitcnt lgkmcnt(2)
  v_mul_f32 v39, s30, v39
  v_add_f32 v18, v18, v38
  v_mfma_f32_16x16x32_bf16 v[64:67], a[236:239], a[248:251], v[10:13]
  buffer_load_dwordx4 v8, s[12:15], s26 offen offset:0 nt lds
  v_mfma_f32_16x16x32_bf16 v[68:71], a[236:239], a[252:255], v[10:13]
  s_waitcnt lgkmcnt(1)
  v_exp_f32 v39, v39
  v_mfma_f32_16x16x32_bf16 v[104:107], a[240:243], a[252:255], v[10:13]
  ds_read_b128 a[252:255], v3 offset:2048
  v_mul_f32 v84, s30, v84
  v_mfma_f32_16x16x32_bf16 v[100:103], a[240:243], a[248:251], v[10:13]
  v_add_f32 v18, v18, v39
  v_cvt_pk_bf16_f32 v37, v38, v39
  v_mfma_f32_16x16x32_bf16 v[96:99], a[240:243], a[212:215], v[10:13]
  v_exp_f32 v84, v84
  v_mfma_f32_16x16x32_bf16 v[80:83], a[240:243], a[188:191], v[10:13]
  ds_read_b128 a[248:251], v3 offset:0
  v_mul_f32 v85, s30, v85
  v_mfma_f32_16x16x32_bf16 v[76:79], a[240:243], a[164:167], v[10:13]
  ds_read_b128 a[236:239], v1 offset:38912
  v_add_f32 v18, v18, v84
  v_mfma_f32_16x16x32_bf16 v[72:75], a[240:243], a[140:143], v[10:13]
  s_waitcnt lgkmcnt(3)
  v_exp_f32 v85, v85
  v_mfma_f32_16x16x32_bf16 v[48:51], a[244:247], a[144:147], v[48:51]
  ds_read_b128 a[240:243], v0 offset:40960
  v_mul_f32 v86, s30, v86
  v_mfma_f32_16x16x32_bf16 v[52:55], a[244:247], a[168:171], v[52:55]
  v_add_f32 v18, v18, v85
  v_cvt_pk_bf16_f32 v38, v84, v85
  v_mfma_f32_16x16x32_bf16 v[56:59], a[244:247], a[192:195], v[56:59]
  s_add_u32 m0, s25, 28544
  v_exp_f32 v86, v86
  v_mfma_f32_16x16x32_bf16 v[60:63], a[244:247], a[216:219], v[60:63]
  s_waitcnt lgkmcnt(2)
  v_mul_f32 v87, s30, v87
  v_add_f32 v18, v18, v86
  v_mfma_f32_16x16x32_bf16 v[64:67], a[244:247], a[248:251], v[64:67]
  buffer_load_dwordx4 v8, s[12:15], s26 offen offset:128 nt lds
  v_mfma_f32_16x16x32_bf16 v[68:71], a[244:247], a[252:255], v[68:71]
  s_waitcnt lgkmcnt(1)
  v_exp_f32 v87, v87
  v_mfma_f32_16x16x32_bf16 v[104:107], a[236:239], a[252:255], v[104:107]
  ds_read_b128 a[252:255], v2 offset:6144
  v_mul_f32 v40, s30, v40
  v_mfma_f32_16x16x32_bf16 v[100:103], a[236:239], a[248:251], v[100:103]
  v_add_f32 v18, v18, v87
  v_cvt_pk_bf16_f32 v39, v86, v87
  v_mfma_f32_16x16x32_bf16 v[96:99], a[236:239], a[216:219], v[96:99]
  v_exp_f32 v40, v40
  v_mfma_f32_16x16x32_bf16 v[80:83], a[236:239], a[192:195], v[80:83]
  ds_read_b128 a[248:251], v2 offset:4096
  v_mul_f32 v41, s30, v41
  v_mfma_f32_16x16x32_bf16 v[76:79], a[236:239], a[168:171], v[76:79]
  ds_read_b128 a[244:247], v0 offset:43008
  v_add_f32 v19, v19, v40
  v_mfma_f32_16x16x32_bf16 v[72:75], a[236:239], a[144:147], v[72:75]
  s_waitcnt lgkmcnt(3)
  v_exp_f32 v41, v41
  v_mfma_f32_16x16x32_bf16 v[48:51], a[240:243], a[148:151], v[48:51]
  ds_read_b128 a[236:239], v1 offset:40960
  v_mul_f32 v42, s30, v42
  v_mfma_f32_16x16x32_bf16 v[52:55], a[240:243], a[172:175], v[52:55]
  v_add_f32 v19, v19, v41
  v_cvt_pk_bf16_f32 v40, v40, v41
  v_mfma_f32_16x16x32_bf16 v[56:59], a[240:243], a[196:199], v[56:59]
  s_add_u32 m0, s25, 32512
  v_exp_f32 v42, v42
  v_mfma_f32_16x16x32_bf16 v[60:63], a[240:243], a[220:223], v[60:63]
  s_waitcnt lgkmcnt(2)
  v_mul_f32 v43, s30, v43
  v_add_f32 v19, v19, v42
  v_mfma_f32_16x16x32_bf16 v[64:67], a[240:243], a[248:251], v[64:67]
  buffer_load_dwordx4 v8, s[12:15], s26 offen offset:256 nt lds
  v_mfma_f32_16x16x32_bf16 v[68:71], a[240:243], a[252:255], v[68:71]
  s_waitcnt lgkmcnt(1)
  v_exp_f32 v43, v43
  v_mfma_f32_16x16x32_bf16 v[104:107], a[244:247], a[252:255], v[104:107]
  ds_read_b128 a[252:255], v3 offset:6144
  v_mul_f32 v88, s30, v88
  v_mfma_f32_16x16x32_bf16 v[100:103], a[244:247], a[248:251], v[100:103]
  v_add_f32 v19, v19, v43
  v_cvt_pk_bf16_f32 v41, v42, v43
  v_mfma_f32_16x16x32_bf16 v[96:99], a[244:247], a[220:223], v[96:99]
  s_add_u32 s26, s26, 12288
  v_exp_f32 v88, v88
  v_mfma_f32_16x16x32_bf16 v[80:83], a[244:247], a[196:199], v[80:83]
  ds_read_b128 a[248:251], v3 offset:4096
  s_cmp_eq_u32 s26, s57
  v_mul_f32 v89, s30, v89
  v_mfma_f32_16x16x32_bf16 v[76:79], a[244:247], a[172:175], v[76:79]
  ds_read_b128 a[240:243], v1 offset:43008
  s_cselect_b32 s26, s56, s26
  v_add_f32 v19, v19, v88
  v_mfma_f32_16x16x32_bf16 v[72:75], a[244:247], a[148:151], v[72:75]
  s_waitcnt lgkmcnt(3)
  v_exp_f32 v89, v89
  v_mfma_f32_16x16x32_bf16 v[48:51], a[236:239], a[152:155], v[48:51]
  ds_read_b128 a[244:247], v0 offset:45056
  v_mul_f32 v90, s30, v90
  v_mfma_f32_16x16x32_bf16 v[52:55], a[236:239], a[176:179], v[52:55]
  v_add_f32 v19, v19, v89
  v_cvt_pk_bf16_f32 v42, v88, v89
  v_mfma_f32_16x16x32_bf16 v[56:59], a[236:239], a[200:203], v[56:59]
  s_add_u32 m0, s25, 73728
  v_exp_f32 v90, v90
  v_mfma_f32_16x16x32_bf16 v[60:63], a[236:239], a[224:227], v[60:63]
  s_waitcnt lgkmcnt(2)
  v_mul_f32 v91, s30, v91
  v_add_f32 v19, v19, v90
  v_mfma_f32_16x16x32_bf16 v[64:67], a[236:239], a[248:251], v[64:67]
  buffer_load_dwordx4 v8, s[16:19], s27 offen offset:0 nt lds
  v_mfma_f32_16x16x32_bf16 v[68:71], a[236:239], a[252:255], v[68:71]
  s_waitcnt lgkmcnt(1)
  v_exp_f32 v91, v91
  v_mfma_f32_16x16x32_bf16 v[104:107], a[240:243], a[252:255], v[104:107]
  ds_read_b128 a[252:255], v2 offset:10240
  v_mul_f32 v44, s30, v44
  v_mfma_f32_16x16x32_bf16 v[100:103], a[240:243], a[248:251], v[100:103]
  v_add_f32 v19, v19, v91
  v_cvt_pk_bf16_f32 v43, v90, v91
  v_mfma_f32_16x16x32_bf16 v[96:99], a[240:243], a[224:227], v[96:99]
  v_exp_f32 v44, v44
  v_mfma_f32_16x16x32_bf16 v[80:83], a[240:243], a[200:203], v[80:83]
  ds_read_b128 a[248:251], v2 offset:8192
  v_mul_f32 v45, s30, v45
  v_mfma_f32_16x16x32_bf16 v[76:79], a[240:243], a[176:179], v[76:79]
  ds_read_b128 a[236:239], v0 offset:47104
  v_add_f32 v20, v20, v44
  v_mfma_f32_16x16x32_bf16 v[72:75], a[240:243], a[152:155], v[72:75]
  s_waitcnt lgkmcnt(3)
  v_exp_f32 v45, v45
  v_mfma_f32_16x16x32_bf16 v[48:51], a[244:247], a[156:159], v[48:51]
  ds_read_b128 a[240:243], v1 offset:45056
  v_mul_f32 v46, s30, v46
  v_mfma_f32_16x16x32_bf16 v[52:55], a[244:247], a[180:183], v[52:55]
  v_add_f32 v20, v20, v45
  v_cvt_pk_bf16_f32 v44, v44, v45
  v_mfma_f32_16x16x32_bf16 v[56:59], a[244:247], a[204:207], v[56:59]
  s_add_u32 m0, s25, 77696
  v_exp_f32 v46, v46
  v_mfma_f32_16x16x32_bf16 v[60:63], a[244:247], a[228:231], v[60:63]
  s_waitcnt lgkmcnt(2)
  v_mul_f32 v47, s30, v47
  v_add_f32 v20, v20, v46
  v_mfma_f32_16x16x32_bf16 v[64:67], a[244:247], a[248:251], v[64:67]
  buffer_load_dwordx4 v8, s[16:19], s27 offen offset:128 nt lds
  v_mfma_f32_16x16x32_bf16 v[68:71], a[244:247], a[252:255], v[68:71]
  s_waitcnt lgkmcnt(1)
  v_exp_f32 v47, v47
  v_mfma_f32_16x16x32_bf16 v[104:107], a[236:239], a[252:255], v[104:107]
  ds_read_b128 a[252:255], v3 offset:10240
  v_mul_f32 v92, s30, v92
  v_mfma_f32_16x16x32_bf16 v[100:103], a[236:239], a[248:251], v[100:103]
  v_add_f32 v20, v20, v47
  v_cvt_pk_bf16_f32 v45, v46, v47
  v_mfma_f32_16x16x32_bf16 v[96:99], a[236:239], a[228:231], v[96:99]
  v_exp_f32 v92, v92
  v_mfma_f32_16x16x32_bf16 v[80:83], a[236:239], a[204:207], v[80:83]
  ds_read_b128 a[248:251], v3 offset:8192
  v_mul_f32 v93, s30, v93
  v_mfma_f32_16x16x32_bf16 v[76:79], a[236:239], a[180:183], v[76:79]
  ds_read_b128 a[244:247], v1 offset:47104
  v_add_f32 v20, v20, v92
  v_mfma_f32_16x16x32_bf16 v[72:75], a[236:239], a[156:159], v[72:75]
  s_waitcnt lgkmcnt(3)
  v_exp_f32 v93, v93
  v_mfma_f32_16x16x32_bf16 v[48:51], a[240:243], a[160:163], v[48:51]
  ds_read_b64_tr_b16 a[236:237], v4 offset:36864
  v_mul_f32 v94, s30, v94
  v_mfma_f32_16x16x32_bf16 v[52:55], a[240:243], a[184:187], v[52:55]
  v_add_f32 v20, v20, v93
  v_cvt_pk_bf16_f32 v46, v92, v93
  v_mfma_f32_16x16x32_bf16 v[56:59], a[240:243], a[208:211], v[56:59]
  s_add_u32 m0, s25, 81664
  v_exp_f32 v94, v94
  v_mfma_f32_16x16x32_bf16 v[60:63], a[240:243], a[232:235], v[60:63]
  ds_read_b64_tr_b16 a[238:239], v4 offset:38912
  s_waitcnt lgkmcnt(3)
  v_mul_f32 v95, s30, v95
  v_mfma_f32_16x16x32_bf16 v[64:67], a[240:243], a[248:251], v[64:67]
  buffer_load_dwordx4 v8, s[16:19], s27 offen offset:256 nt lds
  v_add_f32 v20, v20, v94
  v_mfma_f32_16x16x32_bf16 v[68:71], a[240:243], a[252:255], v[68:71]
  s_waitcnt lgkmcnt(2)
  v_exp_f32 v95, v95
  v_mfma_f32_16x16x32_bf16 v[104:107], a[244:247], a[252:255], v[104:107]
  ds_read_b64_tr_b16 a[240:241], v5 offset:36864
  v_mul_f32 v48, s30, v48
  v_mfma_f32_16x16x32_bf16 v[100:103], a[244:247], a[248:251], v[100:103]
  v_add_f32 v20, v20, v95
  v_cvt_pk_bf16_f32 v47, v94, v95
  v_mfma_f32_16x16x32_bf16 v[96:99], a[244:247], a[232:235], v[96:99]
  s_add_u32 s27, s27, 12288
  v_exp_f32 v48, v48
  v_mfma_f32_16x16x32_bf16 v[80:83], a[244:247], a[208:211], v[80:83]
  ds_read_b64_tr_b16 a[242:243], v5 offset:38912
  s_cmp_eq_u32 s27, s59
  v_mul_f32 v49, s30, v49
  v_mfma_f32_16x16x32_bf16 v[76:79], a[244:247], a[184:187], v[76:79]
  s_cselect_b32 s27, s58, s27
  v_add_f32 v15, v15, v48
  v_mfma_f32_16x16x32_bf16 v[72:75], a[244:247], a[160:163], v[72:75]
  s_waitcnt lgkmcnt(2)
  v_exp_f32 v49, v49
  v_mfma_f32_16x16x32_bf16 a[0:3], a[236:239], v[24:27], a[0:3]
  ds_read_b64_tr_b16 a[244:245], v6 offset:36864
  v_mul_f32 v50, s30, v50
  v_mfma_f32_16x16x32_bf16 a[4:7], a[236:239], v[28:31], a[4:7]
  v_add_f32 v15, v15, v49
  v_cvt_pk_bf16_f32 v48, v48, v49
  v_mfma_f32_16x16x32_bf16 a[8:11], a[236:239], v[32:35], a[8:11]
  v_exp_f32 v50, v50
  v_mfma_f32_16x16x32_bf16 a[12:15], a[236:239], v[36:39], a[12:15]
  ds_read_b64_tr_b16 a[246:247], v6 offset:38912
  v_mul_f32 v51, s30, v51
  v_mfma_f32_16x16x32_bf16 a[16:19], a[236:239], v[40:43], a[16:19]
  v_add_f32 v15, v15, v50
  v_mfma_f32_16x16x32_bf16 a[20:23], a[236:239], v[44:47], a[20:23]
  s_waitcnt lgkmcnt(2)
  v_exp_f32 v51, v51
  v_mfma_f32_16x16x32_bf16 a[44:47], a[240:243], v[44:47], a[44:47]
  ds_read_b64_tr_b16 a[236:237], v7 offset:36864
  v_mul_f32 v72, s30, v72
  v_mfma_f32_16x16x32_bf16 a[40:43], a[240:243], v[40:43], a[40:43]
  v_add_f32 v15, v15, v51
  v_cvt_pk_bf16_f32 v49, v50, v51
  v_mfma_f32_16x16x32_bf16 a[36:39], a[240:243], v[36:39], a[36:39]
  v_exp_f32 v72, v72
  v_mfma_f32_16x16x32_bf16 a[32:35], a[240:243], v[32:35], a[32:35]
  ds_read_b64_tr_b16 a[238:239], v7 offset:38912
  v_mul_f32 v73, s30, v73
  v_mfma_f32_16x16x32_bf16 a[28:31], a[240:243], v[28:31], a[28:31]
  v_add_f32 v15, v15, v72
  v_mfma_f32_16x16x32_bf16 a[24:27], a[240:243], v[24:27], a[24:27]
  s_waitcnt lgkmcnt(2)
  v_exp_f32 v73, v73
  v_mfma_f32_16x16x32_bf16 a[48:51], a[244:247], v[24:27], a[48:51]
  ds_read_b64_tr_b16 a[240:241], v4 offset:40960
  v_mul_f32 v74, s30, v74
  v_mfma_f32_16x16x32_bf16 a[52:55], a[244:247], v[28:31], a[52:55]
  v_add_f32 v15, v15, v73
  v_cvt_pk_bf16_f32 v50, v72, v73
  v_mfma_f32_16x16x32_bf16 a[56:59], a[244:247], v[32:35], a[56:59]
  v_exp_f32 v74, v74
  v_mfma_f32_16x16x32_bf16 a[60:63], a[244:247], v[36:39], a[60:63]
  ds_read_b64_tr_b16 a[242:243], v4 offset:43008
  v_mul_f32 v75, s30, v75
  v_mfma_f32_16x16x32_bf16 a[64:67], a[244:247], v[40:43], a[64:67]
  v_add_f32 v15, v15, v74
  v_mfma_f32_16x16x32_bf16 a[68:71], a[244:247], v[44:47], a[68:71]
  s_waitcnt lgkmcnt(2)
  v_exp_f32 v75, v75
  v_mfma_f32_16x16x32_bf16 a[92:95], a[236:239], v[44:47], a[92:95]
  ds_read_b64_tr_b16 a[244:245], v5 offset:40960
  v_mul_f32 v52, s30, v52
  v_mfma_f32_16x16x32_bf16 a[88:91], a[236:239], v[40:43], a[88:91]
  v_add_f32 v15, v15, v75
  v_cvt_pk_bf16_f32 v51, v74, v75
  v_mfma_f32_16x16x32_bf16 a[84:87], a[236:239], v[36:39], a[84:87]
  v_exp_f32 v52, v52
  v_mfma_f32_16x16x32_bf16 a[80:83], a[236:239], v[32:35], a[80:83]
  ds_read_b64_tr_b16 a[246:247], v5 offset:43008
  v_mul_f32 v53, s30, v53
  v_mfma_f32_16x16x32_bf16 a[76:79], a[236:239], v[28:31], a[76:79]
  v_add_f32 v16, v16, v52
  v_mfma_f32_16x16x32_bf16 a[72:75], a[236:239], v[24:27], a[72:75]
  s_waitcnt lgkmcnt(2)
  v_exp_f32 v53, v53
  v_mfma_f32_16x16x32_bf16 a[96:99], a[240:243], v[24:27], a[96:99]
  ds_read_b64_tr_b16 a[236:237], v6 offset:40960
  v_mul_f32 v54, s30, v54
  v_mfma_f32_16x16x32_bf16 a[100:103], a[240:243], v[28:31], a[100:103]
  v_add_f32 v16, v16, v53
  v_cvt_pk_bf16_f32 v52, v52, v53
  v_mfma_f32_16x16x32_bf16 a[104:107], a[240:243], v[32:35], a[104:107]
  v_exp_f32 v54, v54
  v_mfma_f32_16x16x32_bf16 a[108:111], a[240:243], v[36:39], a[108:111]
  ds_read_b64_tr_b16 a[238:239], v6 offset:43008
  v_mul_f32 v55, s30, v55
  v_mfma_f32_16x16x32_bf16 a[112:115], a[240:243], v[40:43], a[112:115]
  v_add_f32 v16, v16, v54
  v_mfma_f32_16x16x32_bf16 a[116:119], a[240:243], v[44:47], a[116:119]
  s_waitcnt lgkmcnt(2)
  v_exp_f32 v55, v55
  v_mfma_f32_16x16x32_bf16 v[108:111], a[244:247], v[44:47], v[108:111]
  ds_read_b64_tr_b16 a[240:241], v7 offset:40960
  v_mul_f32 v76, s30, v76
  v_mfma_f32_16x16x32_bf16 a[136:139], a[244:247], v[40:43], a[136:139]
  v_add_f32 v16, v16, v55
  v_cvt_pk_bf16_f32 v53, v54, v55
  v_mfma_f32_16x16x32_bf16 a[132:135], a[244:247], v[36:39], a[132:135]
  v_exp_f32 v76, v76
  v_mfma_f32_16x16x32_bf16 a[128:131], a[244:247], v[32:35], a[128:131]
  ds_read_b64_tr_b16 a[242:243], v7 offset:43008
  v_mul_f32 v77, s30, v77
  v_mfma_f32_16x16x32_bf16 a[124:127], a[244:247], v[28:31], a[124:127]
  v_add_f32 v16, v16, v76
  v_mfma_f32_16x16x32_bf16 a[120:123], a[244:247], v[24:27], a[120:123]
  s_waitcnt lgkmcnt(2)
  v_exp_f32 v77, v77
  v_mfma_f32_16x16x32_bf16 v[112:115], a[236:239], v[24:27], v[112:115]
  ds_read_b64_tr_b16 a[244:245], v4 offset:45056
  v_mul_f32 v78, s30, v78
  v_mfma_f32_16x16x32_bf16 v[116:119], a[236:239], v[28:31], v[116:119]
  v_add_f32 v16, v16, v77
  v_cvt_pk_bf16_f32 v54, v76, v77
  v_mfma_f32_16x16x32_bf16 v[120:123], a[236:239], v[32:35], v[120:123]
  v_exp_f32 v78, v78
  v_mfma_f32_16x16x32_bf16 v[124:127], a[236:239], v[36:39], v[124:127]
  ds_read_b64_tr_b16 a[246:247], v4 offset:47104
  v_mul_f32 v79, s30, v79
  v_mfma_f32_16x16x32_bf16 v[128:131], a[236:239], v[40:43], v[128:131]
  v_add_f32 v16, v16, v78
  v_mfma_f32_16x16x32_bf16 v[132:135], a[236:239], v[44:47], v[132:135]
  s_waitcnt lgkmcnt(2)
  v_exp_f32 v79, v79
  v_mfma_f32_16x16x32_bf16 v[156:159], a[240:243], v[44:47], v[156:159]
  ds_read_b64_tr_b16 a[236:237], v5 offset:45056
  v_mul_f32 v56, s30, v56
  v_mfma_f32_16x16x32_bf16 v[152:155], a[240:243], v[40:43], v[152:155]
  v_add_f32 v16, v16, v79
  v_cvt_pk_bf16_f32 v55, v78, v79
  v_mfma_f32_16x16x32_bf16 v[148:151], a[240:243], v[36:39], v[148:151]
  v_exp_f32 v56, v56
  v_mfma_f32_16x16x32_bf16 v[144:147], a[240:243], v[32:35], v[144:147]
  ds_read_b64_tr_b16 a[238:239], v5 offset:47104
  v_mul_f32 v57, s30, v57
  v_mfma_f32_16x16x32_bf16 v[140:143], a[240:243], v[28:31], v[140:143]
  v_add_f32 v17, v17, v56
  v_mfma_f32_16x16x32_bf16 v[136:139], a[240:243], v[24:27], v[136:139]
  s_waitcnt lgkmcnt(2)
  v_exp_f32 v57, v57
  v_mfma_f32_16x16x32_bf16 v[160:163], a[244:247], v[24:27], v[160:163]
  ds_read_b64_tr_b16 a[240:241], v6 offset:45056
  v_mul_f32 v58, s30, v58
  v_mfma_f32_16x16x32_bf16 v[164:167], a[244:247], v[28:31], v[164:167]
  v_add_f32 v17, v17, v57
  v_cvt_pk_bf16_f32 v56, v56, v57
  v_mfma_f32_16x16x32_bf16 v[168:171], a[244:247], v[32:35], v[168:171]
  v_exp_f32 v58, v58
  v_mfma_f32_16x16x32_bf16 v[172:175], a[244:247], v[36:39], v[172:175]
  ds_read_b64_tr_b16 a[242:243], v6 offset:47104
  v_mul_f32 v59, s30, v59
  v_mfma_f32_16x16x32_bf16 v[176:179], a[244:247], v[40:43], v[176:179]
  v_add_f32 v17, v17, v58
  v_mfma_f32_16x16x32_bf16 v[180:183], a[244:247], v[44:47], v[180:183]
  s_waitcnt lgkmcnt(2)
  v_exp_f32 v59, v59
  v_mfma_f32_16x16x32_bf16 v[204:207], a[236:239], v[44:47], v[204:207]
  ds_read_b64_tr_b16 a[244:245], v7 offset:45056
  v_mul_f32 v80, s30, v80
  v_mfma_f32_16x16x32_bf16 v[200:203], a[236:239], v[40:43], v[200:203]
  v_add_f32 v17, v17, v59
  v_cvt_pk_bf16_f32 v57, v58, v59
  v_mfma_f32_16x16x32_bf16 v[196:199], a[236:239], v[36:39], v[196:199]
  v_exp_f32 v80, v80
  v_mfma_f32_16x16x32_bf16 v[192:195], a[236:239], v[32:35], v[192:195]
  ds_read_b64_tr_b16 a[246:247], v7 offset:47104
  v_mul_f32 v81, s30, v81
  v_mfma_f32_16x16x32_bf16 v[188:191], a[236:239], v[28:31], v[188:191]
  v_add_f32 v17, v17, v80
  v_mfma_f32_16x16x32_bf16 v[184:187], a[236:239], v[24:27], v[184:187]
  s_waitcnt lgkmcnt(2)
  v_exp_f32 v81, v81
  v_mfma_f32_16x16x32_bf16 v[208:211], a[240:243], v[24:27], v[208:211]
  v_mul_f32 v82, s30, v82
  v_mul_f32 v83, s30, v83
  v_mfma_f32_16x16x32_bf16 v[212:215], a[240:243], v[28:31], v[212:215]
  v_add_f32 v17, v17, v81
  v_cvt_pk_bf16_f32 v58, v80, v81
  v_mfma_f32_16x16x32_bf16 v[216:219], a[240:243], v[32:35], v[216:219]
  s_waitcnt vmcnt(12) lgkmcnt(0)
  v_exp_f32 v82, v82
  v_mfma_f32_16x16x32_bf16 v[220:223], a[240:243], v[36:39], v[220:223]
  s_barrier
  v_mfma_f32_16x16x32_bf16 v[224:227], a[240:243], v[40:43], v[224:227]
  ds_read_b128 a[236:239], v0 offset:0
  v_add_f32 v17, v17, v82
  v_mfma_f32_16x16x32_bf16 v[228:231], a[240:243], v[44:47], v[228:231]
  v_exp_f32 v83, v83
  v_mfma_f32_16x16x32_bf16 v[252:255], a[244:247], v[44:47], v[252:255]
  ds_read_b128 a[248:251], v2 offset:0
  v_mul_f32 v60, s30, v60
  v_mfma_f32_16x16x32_bf16 v[248:251], a[244:247], v[40:43], v[248:251]
  v_add_f32 v17, v17, v83
  v_cvt_pk_bf16_f32 v59, v82, v83
  v_mfma_f32_16x16x32_bf16 v[244:247], a[244:247], v[36:39], v[244:247]
  v_exp_f32 v60, v60
  v_mfma_f32_16x16x32_bf16 v[240:243], a[244:247], v[32:35], v[240:243]
  ds_read_b128 a[252:255], v2 offset:2048
  v_mul_f32 v61, s30, v61
  v_mfma_f32_16x16x32_bf16 v[236:239], a[244:247], v[28:31], v[236:239]
  ds_read_b128 a[240:243], v0 offset:2048
  v_add_f32 v18, v18, v60
  v_mfma_f32_16x16x32_bf16 v[232:235], a[244:247], v[24:27], v[232:235]
  s_waitcnt lgkmcnt(3)
  v_exp_f32 v61, v61
  v_mfma_f32_16x16x32_bf16 v[24:27], a[236:239], a[140:143], v[10:13]
  ds_read_b128 a[244:247], v1 offset:0
  v_mul_f32 v62, s30, v62
  v_mfma_f32_16x16x32_bf16 v[28:31], a[236:239], a[164:167], v[10:13]
  v_add_f32 v18, v18, v61
  v_cvt_pk_bf16_f32 v60, v60, v61
  v_mfma_f32_16x16x32_bf16 v[32:35], a[236:239], a[188:191], v[10:13]
  s_add_u32 m0, s25, 36864
  v_exp_f32 v62, v62
  v_mfma_f32_16x16x32_bf16 v[36:39], a[236:239], a[212:215], v[10:13]
  s_waitcnt lgkmcnt(2)
  v_mul_f32 v63, s30, v63
  v_add_f32 v18, v18, v62
  v_mfma_f32_16x16x32_bf16 v[40:43], a[236:239], a[248:251], v[10:13]
  buffer_load_dwordx4 v8, s[12:15], s26 offen offset:0 nt lds
  v_mfma_f32_16x16x32_bf16 v[44:47], a[236:239], a[252:255], v[10:13]
  s_waitcnt lgkmcnt(1)
  v_exp_f32 v63, v63
  v_mfma_f32_16x16x32_bf16 v[92:95], a[240:243], a[252:255], v[10:13]
  ds_read_b128 a[252:255], v3 offset:2048
  v_mul_f32 v96, s30, v96
  v_mfma_f32_16x16x32_bf16 v[88:91], a[240:243], a[248:251], v[10:13]
  v_add_f32 v18, v18, v63
  v_cvt_pk_bf16_f32 v61, v62, v63
  v_mfma_f32_16x16x32_bf16 v[84:87], a[240:243], a[212:215], v[10:13]
  v_exp_f32 v96, v96
  v_mfma_f32_16x16x32_bf16 v[80:83], a[240:243], a[188:191], v[10:13]
  ds_read_b128 a[248:251], v3 offset:0
  v_mul_f32 v97, s30, v97
  v_mfma_f32_16x16x32_bf16 v[76:79], a[240:243], a[164:167], v[10:13]
  ds_read_b128 a[236:239], v1 offset:2048
  v_add_f32 v18, v18, v96
  v_mfma_f32_16x16x32_bf16 v[72:75], a[240:243], a[140:143], v[10:13]
  s_waitcnt lgkmcnt(3)
  v_exp_f32 v97, v97
  v_mfma_f32_16x16x32_bf16 v[24:27], a[244:247], a[144:147], v[24:27]
  ds_read_b128 a[240:243], v0 offset:4096
  v_mul_f32 v98, s30, v98
  v_mfma_f32_16x16x32_bf16 v[28:31], a[244:247], a[168:171], v[28:31]
  v_add_f32 v18, v18, v97
  v_cvt_pk_bf16_f32 v62, v96, v97
  v_mfma_f32_16x16x32_bf16 v[32:35], a[244:247], a[192:195], v[32:35]
  s_add_u32 m0, s25, 40832
  v_exp_f32 v98, v98
  v_mfma_f32_16x16x32_bf16 v[36:39], a[244:247], a[216:219], v[36:39]
  s_waitcnt lgkmcnt(2)
  v_mul_f32 v99, s30, v99
  v_add_f32 v18, v18, v98
  v_mfma_f32_16x16x32_bf16 v[40:43], a[244:247], a[248:251], v[40:43]
  buffer_load_dwordx4 v8, s[12:15], s26 offen offset:128 nt lds
  v_mfma_f32_16x16x32_bf16 v[44:47], a[244:247], a[252:255], v[44:47]
  s_waitcnt lgkmcnt(1)
  v_exp_f32 v99, v99
  v_mfma_f32_16x16x32_bf16 v[92:95], a[236:239], a[252:255], v[92:95]
  ds_read_b128 a[252:255], v2 offset:6144
  v_mul_f32 v64, s30, v64
  v_mfma_f32_16x16x32_bf16 v[88:91], a[236:239], a[248:251], v[88:91]
  v_add_f32 v18, v18, v99
  v_cvt_pk_bf16_f32 v63, v98, v99
  v_mfma_f32_16x16x32_bf16 v[84:87], a[236:239], a[216:219], v[84:87]
  v_exp_f32 v64, v64
  v_mfma_f32_16x16x32_bf16 v[80:83], a[236:239], a[192:195], v[80:83]
  ds_read_b128 a[248:251], v2 offset:4096
  v_mul_f32 v65, s30, v65
  v_mfma_f32_16x16x32_bf16 v[76:79], a[236:239], a[168:171], v[76:79]
  ds_read_b128 a[244:247], v0 offset:6144
  v_add_f32 v19, v19, v64
  v_mfma_f32_16x16x32_bf16 v[72:75], a[236:239], a[144:147], v[72:75]
  s_waitcnt lgkmcnt(3)
  v_exp_f32 v65, v65
  v_mfma_f32_16x16x32_bf16 v[24:27], a[240:243], a[148:151], v[24:27]
  ds_read_b128 a[236:239], v1 offset:4096
  v_mul_f32 v66, s30, v66
  v_mfma_f32_16x16x32_bf16 v[28:31], a[240:243], a[172:175], v[28:31]
  v_add_f32 v19, v19, v65
  v_cvt_pk_bf16_f32 v64, v64, v65
  v_mfma_f32_16x16x32_bf16 v[32:35], a[240:243], a[196:199], v[32:35]
  s_add_u32 m0, s25, 44800
  v_exp_f32 v66, v66
  v_mfma_f32_16x16x32_bf16 v[36:39], a[240:243], a[220:223], v[36:39]
  s_waitcnt lgkmcnt(2)
  v_mul_f32 v67, s30, v67
  v_add_f32 v19, v19, v66
  v_mfma_f32_16x16x32_bf16 v[40:43], a[240:243], a[248:251], v[40:43]
  buffer_load_dwordx4 v8, s[12:15], s26 offen offset:256 nt lds
  v_mfma_f32_16x16x32_bf16 v[44:47], a[240:243], a[252:255], v[44:47]
  s_waitcnt lgkmcnt(1)
  v_exp_f32 v67, v67
  v_mfma_f32_16x16x32_bf16 v[92:95], a[244:247], a[252:255], v[92:95]
  ds_read_b128 a[252:255], v3 offset:6144
  v_mul_f32 v100, s30, v100
  v_mfma_f32_16x16x32_bf16 v[88:91], a[244:247], a[248:251], v[88:91]
  v_add_f32 v19, v19, v67
  v_cvt_pk_bf16_f32 v65, v66, v67
  v_mfma_f32_16x16x32_bf16 v[84:87], a[244:247], a[220:223], v[84:87]
  s_add_u32 s26, s26, 12288
  v_exp_f32 v100, v100
  v_mfma_f32_16x16x32_bf16 v[80:83], a[244:247], a[196:199], v[80:83]
  ds_read_b128 a[248:251], v3 offset:4096
  s_cmp_eq_u32 s26, s57
  v_mul_f32 v101, s30, v101
  v_mfma_f32_16x16x32_bf16 v[76:79], a[244:247], a[172:175], v[76:79]
  ds_read_b128 a[240:243], v1 offset:6144
  s_cselect_b32 s26, s56, s26
  v_add_f32 v19, v19, v100
  v_mfma_f32_16x16x32_bf16 v[72:75], a[244:247], a[148:151], v[72:75]
  s_waitcnt lgkmcnt(3)
  v_exp_f32 v101, v101
  v_mfma_f32_16x16x32_bf16 v[24:27], a[236:239], a[152:155], v[24:27]
  ds_read_b128 a[244:247], v0 offset:8192
  v_mul_f32 v102, s30, v102
  v_mfma_f32_16x16x32_bf16 v[28:31], a[236:239], a[176:179], v[28:31]
  v_add_f32 v19, v19, v101
  v_cvt_pk_bf16_f32 v66, v100, v101
  v_mfma_f32_16x16x32_bf16 v[32:35], a[236:239], a[200:203], v[32:35]
  s_add_u32 m0, s25, 86016
  v_exp_f32 v102, v102
  v_mfma_f32_16x16x32_bf16 v[36:39], a[236:239], a[224:227], v[36:39]
  s_waitcnt lgkmcnt(2)
  v_mul_f32 v103, s30, v103
  v_add_f32 v19, v19, v102
  v_mfma_f32_16x16x32_bf16 v[40:43], a[236:239], a[248:251], v[40:43]
  buffer_load_dwordx4 v8, s[16:19], s27 offen offset:0 nt lds
  v_mfma_f32_16x16x32_bf16 v[44:47], a[236:239], a[252:255], v[44:47]
  s_waitcnt lgkmcnt(1)
  v_exp_f32 v103, v103
  v_mfma_f32_16x16x32_bf16 v[92:95], a[240:243], a[252:255], v[92:95]
  ds_read_b128 a[252:255], v2 offset:10240
  v_mul_f32 v68, s30, v68
  v_mfma_f32_16x16x32_bf16 v[88:91], a[240:243], a[248:251], v[88:91]
  v_add_f32 v19, v19, v103
  v_cvt_pk_bf16_f32 v67, v102, v103
  v_mfma_f32_16x16x32_bf16 v[84:87], a[240:243], a[224:227], v[84:87]
  s_cmp_eq_u32 s32, -1
  v_exp_f32 v68, v68
  v_mfma_f32_16x16x32_bf16 v[80:83], a[240:243], a[200:203], v[80:83]
  ds_read_b128 a[248:251], v2 offset:8192
  s_cselect_b32 s26, s34, s26
  v_mul_f32 v69, s30, v69
  v_mfma_f32_16x16x32_bf16 v[76:79], a[240:243], a[176:179], v[76:79]
  ds_read_b128 a[236:239], v0 offset:10240
  s_cselect_b32 s37, 6291456, 0
  v_add_f32 v20, v20, v68
  v_mfma_f32_16x16x32_bf16 v[72:75], a[240:243], a[152:155], v[72:75]
  s_waitcnt lgkmcnt(3)
  v_exp_f32 v69, v69
  v_mfma_f32_16x16x32_bf16 v[24:27], a[244:247], a[156:159], v[24:27]
  ds_read_b128 a[240:243], v1 offset:8192
  s_add_u32 s56, s56, s37
  v_mul_f32 v70, s30, v70
  v_mfma_f32_16x16x32_bf16 v[28:31], a[244:247], a[180:183], v[28:31]
  s_add_u32 s57, s57, s37
  v_add_f32 v20, v20, v69
  v_cvt_pk_bf16_f32 v68, v68, v69
  v_mfma_f32_16x16x32_bf16 v[32:35], a[244:247], a[204:207], v[32:35]
  s_add_u32 m0, s25, 89984
  v_exp_f32 v70, v70
  v_mfma_f32_16x16x32_bf16 v[36:39], a[244:247], a[228:231], v[36:39]
  s_waitcnt lgkmcnt(2)
  v_mul_f32 v71, s30, v71
  v_add_f32 v20, v20, v70
  v_mfma_f32_16x16x32_bf16 v[40:43], a[244:247], a[248:251], v[40:43]
  buffer_load_dwordx4 v8, s[16:19], s27 offen offset:128 nt lds
  v_mfma_f32_16x16x32_bf16 v[44:47], a[244:247], a[252:255], v[44:47]
  s_waitcnt lgkmcnt(1)
  v_exp_f32 v71, v71
  v_mfma_f32_16x16x32_bf16 v[92:95], a[236:239], a[252:255], v[92:95]
  ds_read_b128 a[252:255], v3 offset:10240
  v_mul_f32 v104, s30, v104
  v_mfma_f32_16x16x32_bf16 v[88:91], a[236:239], a[248:251], v[88:91]
  v_add_f32 v20, v20, v71
  v_cvt_pk_bf16_f32 v69, v70, v71
  v_mfma_f32_16x16x32_bf16 v[84:87], a[236:239], a[228:231], v[84:87]
  v_exp_f32 v104, v104
  v_mfma_f32_16x16x32_bf16 v[80:83], a[236:239], a[204:207], v[80:83]
  ds_read_b128 a[248:251], v3 offset:8192
  v_mul_f32 v105, s30, v105
  v_mfma_f32_16x16x32_bf16 v[76:79], a[236:239], a[180:183], v[76:79]
  ds_read_b128 a[244:247], v1 offset:10240
  v_add_f32 v20, v20, v104
  v_mfma_f32_16x16x32_bf16 v[72:75], a[236:239], a[156:159], v[72:75]
  s_waitcnt lgkmcnt(3)
  v_exp_f32 v105, v105
  v_mfma_f32_16x16x32_bf16 v[24:27], a[240:243], a[160:163], v[24:27]
  ds_read_b64_tr_b16 a[236:237], v4 offset:0
  v_mul_f32 v106, s30, v106
  v_mfma_f32_16x16x32_bf16 v[28:31], a[240:243], a[184:187], v[28:31]
  v_add_f32 v20, v20, v105
  v_cvt_pk_bf16_f32 v70, v104, v105
  v_mfma_f32_16x16x32_bf16 v[32:35], a[240:243], a[208:211], v[32:35]
  s_add_u32 m0, s25, 93952
  v_exp_f32 v106, v106
  v_mfma_f32_16x16x32_bf16 v[36:39], a[240:243], a[232:235], v[36:39]
  ds_read_b64_tr_b16 a[238:239], v4 offset:2048
  s_waitcnt lgkmcnt(3)
  v_mul_f32 v107, s30, v107
  v_mfma_f32_16x16x32_bf16 v[40:43], a[240:243], a[248:251], v[40:43]
  buffer_load_dwordx4 v8, s[16:19], s27 offen offset:256 nt lds
  v_add_f32 v20, v20, v106
  v_mfma_f32_16x16x32_bf16 v[44:47], a[240:243], a[252:255], v[44:47]
  s_waitcnt lgkmcnt(2)
  v_exp_f32 v107, v107
  v_mfma_f32_16x16x32_bf16 v[92:95], a[244:247], a[252:255], v[92:95]
  ds_read_b64_tr_b16 a[240:241], v5 offset:0
  v_mul_f32 v24, s30, v24
  v_mfma_f32_16x16x32_bf16 v[88:91], a[244:247], a[248:251], v[88:91]
  v_add_f32 v20, v20, v107
  v_cvt_pk_bf16_f32 v71, v106, v107
  v_mfma_f32_16x16x32_bf16 v[84:87], a[244:247], a[232:235], v[84:87]
  s_add_u32 s27, s27, 12288
  v_exp_f32 v24, v24
  v_mfma_f32_16x16x32_bf16 v[80:83], a[244:247], a[208:211], v[80:83]
  ds_read_b64_tr_b16 a[242:243], v5 offset:2048
  s_cmp_eq_u32 s27, s59
  v_mul_f32 v25, s30, v25
  v_mfma_f32_16x16x32_bf16 v[76:79], a[244:247], a[184:187], v[76:79]
  s_cselect_b32 s27, s58, s27
  v_add_f32 v15, v15, v24
  v_mfma_f32_16x16x32_bf16 v[72:75], a[244:247], a[160:163], v[72:75]
  s_waitcnt lgkmcnt(2)
  v_exp_f32 v25, v25
  v_mfma_f32_16x16x32_bf16 a[0:3], a[236:239], v[48:51], a[0:3]
  ds_read_b64_tr_b16 a[244:245], v6 offset:0
  v_mul_f32 v26, s30, v26
  v_mfma_f32_16x16x32_bf16 a[4:7], a[236:239], v[52:55], a[4:7]
  v_add_f32 v15, v15, v25
  v_cvt_pk_bf16_f32 v24, v24, v25
  v_mfma_f32_16x16x32_bf16 a[8:11], a[236:239], v[56:59], a[8:11]
  v_exp_f32 v26, v26
  v_mfma_f32_16x16x32_bf16 a[12:15], a[236:239], v[60:63], a[12:15]
  ds_read_b64_tr_b16 a[246:247], v6 offset:2048
  v_mul_f32 v27, s30, v27
  v_mfma_f32_16x16x32_bf16 a[16:19], a[236:239], v[64:67], a[16:19]
  v_add_f32 v15, v15, v26
  v_mfma_f32_16x16x32_bf16 a[20:23], a[236:239], v[68:71], a[20:23]
  s_waitcnt lgkmcnt(2)
  v_exp_f32 v27, v27
  v_mfma_f32_16x16x32_bf16 a[44:47], a[240:243], v[68:71], a[44:47]
  ds_read_b64_tr_b16 a[236:237], v7 offset:0
  v_mul_f32 v72, s30, v72
  v_mfma_f32_16x16x32_bf16 a[40:43], a[240:243], v[64:67], a[40:43]
  v_add_f32 v15, v15, v27
  v_cvt_pk_bf16_f32 v25, v26, v27
  v_mfma_f32_16x16x32_bf16 a[36:39], a[240:243], v[60:63], a[36:39]
  v_exp_f32 v72, v72
  v_mfma_f32_16x16x32_bf16 a[32:35], a[240:243], v[56:59], a[32:35]
  ds_read_b64_tr_b16 a[238:239], v7 offset:2048
  v_mul_f32 v73, s30, v73
  v_mfma_f32_16x16x32_bf16 a[28:31], a[240:243], v[52:55], a[28:31]
  v_add_f32 v15, v15, v72
  v_mfma_f32_16x16x32_bf16 a[24:27], a[240:243], v[48:51], a[24:27]
  s_waitcnt lgkmcnt(2)
  v_exp_f32 v73, v73
  v_mfma_f32_16x16x32_bf16 a[48:51], a[244:247], v[48:51], a[48:51]
  ds_read_b64_tr_b16 a[240:241], v4 offset:4096
  v_mul_f32 v74, s30, v74
  v_mfma_f32_16x16x32_bf16 a[52:55], a[244:247], v[52:55], a[52:55]
  v_add_f32 v15, v15, v73
  v_cvt_pk_bf16_f32 v26, v72, v73
  v_mfma_f32_16x16x32_bf16 a[56:59], a[244:247], v[56:59], a[56:59]
  v_exp_f32 v74, v74
  v_mfma_f32_16x16x32_bf16 a[60:63], a[244:247], v[60:63], a[60:63]
  ds_read_b64_tr_b16 a[242:243], v4 offset:6144
  v_mul_f32 v75, s30, v75
  v_mfma_f32_16x16x32_bf16 a[64:67], a[244:247], v[64:67], a[64:67]
  v_add_f32 v15, v15, v74
  v_mfma_f32_16x16x32_bf16 a[68:71], a[244:247], v[68:71], a[68:71]
  s_waitcnt lgkmcnt(2)
  v_exp_f32 v75, v75
  v_mfma_f32_16x16x32_bf16 a[92:95], a[236:239], v[68:71], a[92:95]
  ds_read_b64_tr_b16 a[244:245], v5 offset:4096
  v_mul_f32 v28, s30, v28
  v_mfma_f32_16x16x32_bf16 a[88:91], a[236:239], v[64:67], a[88:91]
  v_add_f32 v15, v15, v75
  v_cvt_pk_bf16_f32 v27, v74, v75
  v_mfma_f32_16x16x32_bf16 a[84:87], a[236:239], v[60:63], a[84:87]
  v_exp_f32 v28, v28
  v_mfma_f32_16x16x32_bf16 a[80:83], a[236:239], v[56:59], a[80:83]
  ds_read_b64_tr_b16 a[246:247], v5 offset:6144
  v_mul_f32 v29, s30, v29
  v_mfma_f32_16x16x32_bf16 a[76:79], a[236:239], v[52:55], a[76:79]
  v_add_f32 v16, v16, v28
  v_mfma_f32_16x16x32_bf16 a[72:75], a[236:239], v[48:51], a[72:75]
  s_waitcnt lgkmcnt(2)
  v_exp_f32 v29, v29
  v_mfma_f32_16x16x32_bf16 a[96:99], a[240:243], v[48:51], a[96:99]
  ds_read_b64_tr_b16 a[236:237], v6 offset:4096
  v_mul_f32 v30, s30, v30
  v_mfma_f32_16x16x32_bf16 a[100:103], a[240:243], v[52:55], a[100:103]
  v_add_f32 v16, v16, v29
  v_cvt_pk_bf16_f32 v28, v28, v29
  v_mfma_f32_16x16x32_bf16 a[104:107], a[240:243], v[56:59], a[104:107]
  v_exp_f32 v30, v30
  v_mfma_f32_16x16x32_bf16 a[108:111], a[240:243], v[60:63], a[108:111]
  ds_read_b64_tr_b16 a[238:239], v6 offset:6144
  v_mul_f32 v31, s30, v31
  v_mfma_f32_16x16x32_bf16 a[112:115], a[240:243], v[64:67], a[112:115]
  v_add_f32 v16, v16, v30
  v_mfma_f32_16x16x32_bf16 a[116:119], a[240:243], v[68:71], a[116:119]
  s_waitcnt lgkmcnt(2)
  v_exp_f32 v31, v31
  v_mfma_f32_16x16x32_bf16 v[108:111], a[244:247], v[68:71], v[108:111]
  ds_read_b64_tr_b16 a[240:241], v7 offset:4096
  v_mul_f32 v76, s30, v76
  v_mfma_f32_16x16x32_bf16 a[136:139], a[244:247], v[64:67], a[136:139]
  v_add_f32 v16, v16, v31
  v_cvt_pk_bf16_f32 v29, v30, v31
  v_mfma_f32_16x16x32_bf16 a[132:135], a[244:247], v[60:63], a[132:135]
  v_exp_f32 v76, v76
  v_mfma_f32_16x16x32_bf16 a[128:131], a[244:247], v[56:59], a[128:131]
  ds_read_b64_tr_b16 a[242:243], v7 offset:6144
  v_mul_f32 v77, s30, v77
  v_mfma_f32_16x16x32_bf16 a[124:127], a[244:247], v[52:55], a[124:127]
  v_add_f32 v16, v16, v76
  v_mfma_f32_16x16x32_bf16 a[120:123], a[244:247], v[48:51], a[120:123]
  s_waitcnt lgkmcnt(2)
  v_exp_f32 v77, v77
  v_mfma_f32_16x16x32_bf16 v[112:115], a[236:239], v[48:51], v[112:115]
  ds_read_b64_tr_b16 a[244:245], v4 offset:8192
  v_mul_f32 v78, s30, v78
  v_mfma_f32_16x16x32_bf16 v[116:119], a[236:239], v[52:55], v[116:119]
  v_add_f32 v16, v16, v77
  v_cvt_pk_bf16_f32 v30, v76, v77
  v_mfma_f32_16x16x32_bf16 v[120:123], a[236:239], v[56:59], v[120:123]
  v_exp_f32 v78, v78
  v_mfma_f32_16x16x32_bf16 v[124:127], a[236:239], v[60:63], v[124:127]
  ds_read_b64_tr_b16 a[246:247], v4 offset:10240
  v_mul_f32 v79, s30, v79
  v_mfma_f32_16x16x32_bf16 v[128:131], a[236:239], v[64:67], v[128:131]
  v_add_f32 v16, v16, v78
  v_mfma_f32_16x16x32_bf16 v[132:135], a[236:239], v[68:71], v[132:135]
  s_waitcnt lgkmcnt(2)
  v_exp_f32 v79, v79
  v_mfma_f32_16x16x32_bf16 v[156:159], a[240:243], v[68:71], v[156:159]
  ds_read_b64_tr_b16 a[236:237], v5 offset:8192
  v_mul_f32 v32, s30, v32
  v_mfma_f32_16x16x32_bf16 v[152:155], a[240:243], v[64:67], v[152:155]
  v_add_f32 v16, v16, v79
  v_cvt_pk_bf16_f32 v31, v78, v79
  v_mfma_f32_16x16x32_bf16 v[148:151], a[240:243], v[60:63], v[148:151]
  v_exp_f32 v32, v32
  v_mfma_f32_16x16x32_bf16 v[144:147], a[240:243], v[56:59], v[144:147]
  ds_read_b64_tr_b16 a[238:239], v5 offset:10240
  v_mul_f32 v33, s30, v33
  v_mfma_f32_16x16x32_bf16 v[140:143], a[240:243], v[52:55], v[140:143]
  v_add_f32 v17, v17, v32
  v_mfma_f32_16x16x32_bf16 v[136:139], a[240:243], v[48:51], v[136:139]
  s_waitcnt lgkmcnt(2)
  v_exp_f32 v33, v33
  v_mfma_f32_16x16x32_bf16 v[160:163], a[244:247], v[48:51], v[160:163]
  ds_read_b64_tr_b16 a[240:241], v6 offset:8192
  v_mul_f32 v34, s30, v34
  v_mfma_f32_16x16x32_bf16 v[164:167], a[244:247], v[52:55], v[164:167]
  v_add_f32 v17, v17, v33
  v_cvt_pk_bf16_f32 v32, v32, v33
  v_mfma_f32_16x16x32_bf16 v[168:171], a[244:247], v[56:59], v[168:171]
  v_exp_f32 v34, v34
  v_mfma_f32_16x16x32_bf16 v[172:175], a[244:247], v[60:63], v[172:175]
  ds_read_b64_tr_b16 a[242:243], v6 offset:10240
  v_mul_f32 v35, s30, v35
  v_mfma_f32_16x16x32_bf16 v[176:179], a[244:247], v[64:67], v[176:179]
  v_add_f32 v17, v17, v34
  v_mfma_f32_16x16x32_bf16 v[180:183], a[244:247], v[68:71], v[180:183]
  s_waitcnt lgkmcnt(2)
  v_exp_f32 v35, v35
  v_mfma_f32_16x16x32_bf16 v[204:207], a[236:239], v[68:71], v[204:207]
  ds_read_b64_tr_b16 a[244:245], v7 offset:8192
  v_mul_f32 v80, s30, v80
  v_mfma_f32_16x16x32_bf16 v[200:203], a[236:239], v[64:67], v[200:203]
  v_add_f32 v17, v17, v35
  v_cvt_pk_bf16_f32 v33, v34, v35
  v_mfma_f32_16x16x32_bf16 v[196:199], a[236:239], v[60:63], v[196:199]
  v_exp_f32 v80, v80
  v_mfma_f32_16x16x32_bf16 v[192:195], a[236:239], v[56:59], v[192:195]
  ds_read_b64_tr_b16 a[246:247], v7 offset:10240
  v_mul_f32 v81, s30, v81
  v_mfma_f32_16x16x32_bf16 v[188:191], a[236:239], v[52:55], v[188:191]
  v_add_f32 v17, v17, v80
  v_mfma_f32_16x16x32_bf16 v[184:187], a[236:239], v[48:51], v[184:187]
  s_waitcnt lgkmcnt(2)
  v_exp_f32 v81, v81
  v_mfma_f32_16x16x32_bf16 v[208:211], a[240:243], v[48:51], v[208:211]
  v_mul_f32 v82, s30, v82
  v_mul_f32 v83, s30, v83
  v_mfma_f32_16x16x32_bf16 v[212:215], a[240:243], v[52:55], v[212:215]
  v_add_f32 v17, v17, v81
  v_cvt_pk_bf16_f32 v34, v80, v81
  v_mfma_f32_16x16x32_bf16 v[216:219], a[240:243], v[56:59], v[216:219]
  s_waitcnt vmcnt(12) lgkmcnt(0)
  v_exp_f32 v82, v82
  v_mfma_f32_16x16x32_bf16 v[220:223], a[240:243], v[60:63], v[220:223]
  s_barrier
  v_mfma_f32_16x16x32_bf16 v[224:227], a[240:243], v[64:67], v[224:227]
  ds_read_b128 a[236:239], v0 offset:12288
  v_add_f32 v17, v17, v82
  v_mfma_f32_16x16x32_bf16 v[228:231], a[240:243], v[68:71], v[228:231]
  v_exp_f32 v83, v83
  v_mfma_f32_16x16x32_bf16 v[252:255], a[244:247], v[68:71], v[252:255]
  ds_read_b128 a[248:251], v2 offset:0
  v_mul_f32 v36, s30, v36
  v_mfma_f32_16x16x32_bf16 v[248:251], a[244:247], v[64:67], v[248:251]
  v_add_f32 v17, v17, v83
  v_cvt_pk_bf16_f32 v35, v82, v83
  v_mfma_f32_16x16x32_bf16 v[244:247], a[244:247], v[60:63], v[244:247]
  v_exp_f32 v36, v36
  v_mfma_f32_16x16x32_bf16 v[240:243], a[244:247], v[56:59], v[240:243]
  ds_read_b128 a[252:255], v2 offset:2048
  v_mul_f32 v37, s30, v37
  v_mfma_f32_16x16x32_bf16 v[236:239], a[244:247], v[52:55], v[236:239]
  ds_read_b128 a[240:243], v0 offset:14336
  v_add_f32 v18, v18, v36
  v_mfma_f32_16x16x32_bf16 v[232:235], a[244:247], v[48:51], v[232:235]
  s_waitcnt lgkmcnt(3)
  v_exp_f32 v37, v37
  v_mfma_f32_16x16x32_bf16 v[48:51], a[236:239], a[140:143], v[10:13]
  ds_read_b128 a[244:247], v1 offset:12288
  v_mul_f32 v38, s30, v38
  v_mfma_f32_16x16x32_bf16 v[52:55], a[236:239], a[164:167], v[10:13]
  v_add_f32 v18, v18, v37
  v_cvt_pk_bf16_f32 v36, v36, v37
  v_mfma_f32_16x16x32_bf16 v[56:59], a[236:239], a[188:191], v[10:13]
  s_add_u32 m0, s25, 0
  v_exp_f32 v38, v38
  v_mfma_f32_16x16x32_bf16 v[60:63], a[236:239], a[212:215], v[10:13]
  s_waitcnt lgkmcnt(2)
  v_mul_f32 v39, s30, v39
  v_add_f32 v18, v18, v38
  v_mfma_f32_16x16x32_bf16 v[64:67], a[236:239], a[248:251], v[10:13]
  buffer_load_dwordx4 v8, s[12:15], s26 offen offset:0 nt lds
  v_mfma_f32_16x16x32_bf16 v[68:71], a[236:239], a[252:255], v[10:13]
  s_waitcnt lgkmcnt(1)
  v_exp_f32 v39, v39
  v_mfma_f32_16x16x32_bf16 v[104:107], a[240:243], a[252:255], v[10:13]
  ds_read_b128 a[252:255], v3 offset:2048
  v_mul_f32 v84, s30, v84
  v_mfma_f32_16x16x32_bf16 v[100:103], a[240:243], a[248:251], v[10:13]
  v_add_f32 v18, v18, v39
  v_cvt_pk_bf16_f32 v37, v38, v39
  v_mfma_f32_16x16x32_bf16 v[96:99], a[240:243], a[212:215], v[10:13]
  v_exp_f32 v84, v84
  v_mfma_f32_16x16x32_bf16 v[80:83], a[240:243], a[188:191], v[10:13]
  ds_read_b128 a[248:251], v3 offset:0
  v_mul_f32 v85, s30, v85
  v_mfma_f32_16x16x32_bf16 v[76:79], a[240:243], a[164:167], v[10:13]
  ds_read_b128 a[236:239], v1 offset:14336
  v_add_f32 v18, v18, v84
  v_mfma_f32_16x16x32_bf16 v[72:75], a[240:243], a[140:143], v[10:13]
  s_waitcnt lgkmcnt(3)
  v_exp_f32 v85, v85
  v_mfma_f32_16x16x32_bf16 v[48:51], a[244:247], a[144:147], v[48:51]
  ds_read_b128 a[240:243], v0 offset:16384
  v_mul_f32 v86, s30, v86
  v_mfma_f32_16x16x32_bf16 v[52:55], a[244:247], a[168:171], v[52:55]
  v_add_f32 v18, v18, v85
  v_cvt_pk_bf16_f32 v38, v84, v85
  v_mfma_f32_16x16x32_bf16 v[56:59], a[244:247], a[192:195], v[56:59]
  s_add_u32 m0, s25, 3968
  v_exp_f32 v86, v86
  v_mfma_f32_16x16x32_bf16 v[60:63], a[244:247], a[216:219], v[60:63]
  s_waitcnt lgkmcnt(2)
  v_mul_f32 v87, s30, v87
  v_add_f32 v18, v18, v86
  v_mfma_f32_16x16x32_bf16 v[64:67], a[244:247], a[248:251], v[64:67]
  buffer_load_dwordx4 v8, s[12:15], s26 offen offset:128 nt lds
  v_mfma_f32_16x16x32_bf16 v[68:71], a[244:247], a[252:255], v[68:71]
  s_waitcnt lgkmcnt(1)
  v_exp_f32 v87, v87
  v_mfma_f32_16x16x32_bf16 v[104:107], a[236:239], a[252:255], v[104:107]
  ds_read_b128 a[252:255], v2 offset:6144
  v_mul_f32 v40, s30, v40
  v_mfma_f32_16x16x32_bf16 v[100:103], a[236:239], a[248:251], v[100:103]
  v_add_f32 v18, v18, v87
  v_cvt_pk_bf16_f32 v39, v86, v87
  v_mfma_f32_16x16x32_bf16 v[96:99], a[236:239], a[216:219], v[96:99]
  v_exp_f32 v40, v40
  v_mfma_f32_16x16x32_bf16 v[80:83], a[236:239], a[192:195], v[80:83]
  ds_read_b128 a[248:251], v2 offset:4096
  v_mul_f32 v41, s30, v41
  v_mfma_f32_16x16x32_bf16 v[76:79], a[236:239], a[168:171], v[76:79]
  ds_read_b128 a[244:247], v0 offset:18432
  v_add_f32 v19, v19, v40
  v_mfma_f32_16x16x32_bf16 v[72:75], a[236:239], a[144:147], v[72:75]
  s_waitcnt lgkmcnt(3)
  v_exp_f32 v41, v41
  v_mfma_f32_16x16x32_bf16 v[48:51], a[240:243], a[148:151], v[48:51]
  ds_read_b128 a[236:239], v1 offset:16384
  v_mul_f32 v42, s30, v42
  v_mfma_f32_16x16x32_bf16 v[52:55], a[240:243], a[172:175], v[52:55]
  v_add_f32 v19, v19, v41
  v_cvt_pk_bf16_f32 v40, v40, v41
  v_mfma_f32_16x16x32_bf16 v[56:59], a[240:243], a[196:199], v[56:59]
  s_add_u32 m0, s25, 7936
  v_exp_f32 v42, v42
  v_mfma_f32_16x16x32_bf16 v[60:63], a[240:243], a[220:223], v[60:63]
  s_waitcnt lgkmcnt(2)
  v_mul_f32 v43, s30, v43
  v_add_f32 v19, v19, v42
  v_mfma_f32_16x16x32_bf16 v[64:67], a[240:243], a[248:251], v[64:67]
  buffer_load_dwordx4 v8, s[12:15], s26 offen offset:256 nt lds
  v_mfma_f32_16x16x32_bf16 v[68:71], a[240:243], a[252:255], v[68:71]
  s_waitcnt lgkmcnt(1)
  v_exp_f32 v43, v43
  v_mfma_f32_16x16x32_bf16 v[104:107], a[244:247], a[252:255], v[104:107]
  ds_read_b128 a[252:255], v3 offset:6144
  v_mul_f32 v88, s30, v88
  v_mfma_f32_16x16x32_bf16 v[100:103], a[244:247], a[248:251], v[100:103]
  v_add_f32 v19, v19, v43
  v_cvt_pk_bf16_f32 v41, v42, v43
  v_mfma_f32_16x16x32_bf16 v[96:99], a[244:247], a[220:223], v[96:99]
  s_add_u32 s26, s26, 12288
  v_exp_f32 v88, v88
  v_mfma_f32_16x16x32_bf16 v[80:83], a[244:247], a[196:199], v[80:83]
  ds_read_b128 a[248:251], v3 offset:4096
  s_cmp_eq_u32 s26, s57
  v_mul_f32 v89, s30, v89
  v_mfma_f32_16x16x32_bf16 v[76:79], a[244:247], a[172:175], v[76:79]
  ds_read_b128 a[240:243], v1 offset:18432
  s_cselect_b32 s26, s56, s26
  v_add_f32 v19, v19, v88
  v_mfma_f32_16x16x32_bf16 v[72:75], a[244:247], a[148:151], v[72:75]
  s_waitcnt lgkmcnt(3)
  v_exp_f32 v89, v89
  v_mfma_f32_16x16x32_bf16 v[48:51], a[236:239], a[152:155], v[48:51]
  ds_read_b128 a[244:247], v0 offset:20480
  v_mul_f32 v90, s30, v90
  v_mfma_f32_16x16x32_bf16 v[52:55], a[236:239], a[176:179], v[52:55]
  v_add_f32 v19, v19, v89
  v_cvt_pk_bf16_f32 v42, v88, v89
  v_mfma_f32_16x16x32_bf16 v[56:59], a[236:239], a[200:203], v[56:59]
  s_add_u32 m0, s25, 49152
  v_exp_f32 v90, v90
  v_mfma_f32_16x16x32_bf16 v[60:63], a[236:239], a[224:227], v[60:63]
  s_waitcnt lgkmcnt(2)
  v_mul_f32 v91, s30, v91
  v_add_f32 v19, v19, v90
  v_mfma_f32_16x16x32_bf16 v[64:67], a[236:239], a[248:251], v[64:67]
  buffer_load_dwordx4 v8, s[16:19], s27 offen offset:0 nt lds
  v_mfma_f32_16x16x32_bf16 v[68:71], a[236:239], a[252:255], v[68:71]
  s_waitcnt lgkmcnt(1)
  v_exp_f32 v91, v91
  v_mfma_f32_16x16x32_bf16 v[104:107], a[240:243], a[252:255], v[104:107]
  ds_read_b128 a[252:255], v2 offset:10240
  v_mul_f32 v44, s30, v44
  v_mfma_f32_16x16x32_bf16 v[100:103], a[240:243], a[248:251], v[100:103]
  v_add_f32 v19, v19, v91
  v_cvt_pk_bf16_f32 v43, v90, v91
  v_mfma_f32_16x16x32_bf16 v[96:99], a[240:243], a[224:227], v[96:99]
  v_exp_f32 v44, v44
  v_mfma_f32_16x16x32_bf16 v[80:83], a[240:243], a[200:203], v[80:83]
  ds_read_b128 a[248:251], v2 offset:8192
  v_mul_f32 v45, s30, v45
  v_mfma_f32_16x16x32_bf16 v[76:79], a[240:243], a[176:179], v[76:79]
  ds_read_b128 a[236:239], v0 offset:22528
  v_add_f32 v20, v20, v44
  v_mfma_f32_16x16x32_bf16 v[72:75], a[240:243], a[152:155], v[72:75]
  s_waitcnt lgkmcnt(3)
  v_exp_f32 v45, v45
  v_mfma_f32_16x16x32_bf16 v[48:51], a[244:247], a[156:159], v[48:51]
  ds_read_b128 a[240:243], v1 offset:20480
  v_mul_f32 v46, s30, v46
  v_mfma_f32_16x16x32_bf16 v[52:55], a[244:247], a[180:183], v[52:55]
  v_add_f32 v20, v20, v45
  v_cvt_pk_bf16_f32 v44, v44, v45
  v_mfma_f32_16x16x32_bf16 v[56:59], a[244:247], a[204:207], v[56:59]
  s_add_u32 m0, s25, 53120
  v_exp_f32 v46, v46
  v_mfma_f32_16x16x32_bf16 v[60:63], a[244:247], a[228:231], v[60:63]
  s_waitcnt lgkmcnt(2)
  v_mul_f32 v47, s30, v47
  v_add_f32 v20, v20, v46
  v_mfma_f32_16x16x32_bf16 v[64:67], a[244:247], a[248:251], v[64:67]
  buffer_load_dwordx4 v8, s[16:19], s27 offen offset:128 nt lds
  v_mfma_f32_16x16x32_bf16 v[68:71], a[244:247], a[252:255], v[68:71]
  s_waitcnt lgkmcnt(1)
  v_exp_f32 v47, v47
  v_mfma_f32_16x16x32_bf16 v[104:107], a[236:239], a[252:255], v[104:107]
  ds_read_b128 a[252:255], v3 offset:10240
  v_mul_f32 v92, s30, v92
  v_mfma_f32_16x16x32_bf16 v[100:103], a[236:239], a[248:251], v[100:103]
  v_add_f32 v20, v20, v47
  v_cvt_pk_bf16_f32 v45, v46, v47
  v_mfma_f32_16x16x32_bf16 v[96:99], a[236:239], a[228:231], v[96:99]
  v_exp_f32 v92, v92
  v_mfma_f32_16x16x32_bf16 v[80:83], a[236:239], a[204:207], v[80:83]
  ds_read_b128 a[248:251], v3 offset:8192
  v_mul_f32 v93, s30, v93
  v_mfma_f32_16x16x32_bf16 v[76:79], a[236:239], a[180:183], v[76:79]
  ds_read_b128 a[244:247], v1 offset:22528
  v_add_f32 v20, v20, v92
  v_mfma_f32_16x16x32_bf16 v[72:75], a[236:239], a[156:159], v[72:75]
  s_waitcnt lgkmcnt(3)
  v_exp_f32 v93, v93
  v_mfma_f32_16x16x32_bf16 v[48:51], a[240:243], a[160:163], v[48:51]
  ds_read_b64_tr_b16 a[236:237], v4 offset:12288
  v_mul_f32 v94, s30, v94
  v_mfma_f32_16x16x32_bf16 v[52:55], a[240:243], a[184:187], v[52:55]
  v_add_f32 v20, v20, v93
  v_cvt_pk_bf16_f32 v46, v92, v93
  v_mfma_f32_16x16x32_bf16 v[56:59], a[240:243], a[208:211], v[56:59]
  s_add_u32 m0, s25, 57088
  v_exp_f32 v94, v94
  v_mfma_f32_16x16x32_bf16 v[60:63], a[240:243], a[232:235], v[60:63]
  ds_read_b64_tr_b16 a[238:239], v4 offset:14336
  s_waitcnt lgkmcnt(3)
  v_mul_f32 v95, s30, v95
  v_mfma_f32_16x16x32_bf16 v[64:67], a[240:243], a[248:251], v[64:67]
  buffer_load_dwordx4 v8, s[16:19], s27 offen offset:256 nt lds
  v_add_f32 v20, v20, v94
  v_mfma_f32_16x16x32_bf16 v[68:71], a[240:243], a[252:255], v[68:71]
  s_waitcnt lgkmcnt(2)
  v_exp_f32 v95, v95
  v_mfma_f32_16x16x32_bf16 v[104:107], a[244:247], a[252:255], v[104:107]
  ds_read_b64_tr_b16 a[240:241], v5 offset:12288
  v_mul_f32 v48, s30, v48
  v_mfma_f32_16x16x32_bf16 v[100:103], a[244:247], a[248:251], v[100:103]
  v_add_f32 v20, v20, v95
  v_cvt_pk_bf16_f32 v47, v94, v95
  v_mfma_f32_16x16x32_bf16 v[96:99], a[244:247], a[232:235], v[96:99]
  s_add_u32 s27, s27, 12288
  v_exp_f32 v48, v48
  v_mfma_f32_16x16x32_bf16 v[80:83], a[244:247], a[208:211], v[80:83]
  ds_read_b64_tr_b16 a[242:243], v5 offset:14336
  s_cmp_eq_u32 s27, s59
  v_mul_f32 v49, s30, v49
  v_mfma_f32_16x16x32_bf16 v[76:79], a[244:247], a[184:187], v[76:79]
  s_cselect_b32 s27, s58, s27
  v_add_f32 v15, v15, v48
  v_mfma_f32_16x16x32_bf16 v[72:75], a[244:247], a[160:163], v[72:75]
  s_waitcnt lgkmcnt(2)
  v_exp_f32 v49, v49
  s_add_u32 s32, s32, 1
  s_cbranch_scc0 L_loop
  s_cmp_eq_u32 s33, 1
  s_cbranch_scc1 L_tail
  v_mfma_f32_16x16x32_bf16 a[0:3], a[236:239], v[24:27], a[0:3]
  ds_read_b64_tr_b16 a[244:245], v6 offset:12288
  v_mul_f32 v50, s30, v50
  v_mfma_f32_16x16x32_bf16 a[4:7], a[236:239], v[28:31], a[4:7]
  v_add_f32 v15, v15, v49
  v_cvt_pk_bf16_f32 v48, v48, v49
  v_mfma_f32_16x16x32_bf16 a[8:11], a[236:239], v[32:35], a[8:11]
  v_exp_f32 v50, v50
  v_mfma_f32_16x16x32_bf16 a[12:15], a[236:239], v[36:39], a[12:15]
  ds_read_b64_tr_b16 a[246:247], v6 offset:14336
  s_add_u32 s35, s28, 12288
  s_add_u32 m0, s25, 147456
  v_mul_f32 v51, s30, v51
  v_mfma_f32_16x16x32_bf16 a[16:19], a[236:239], v[40:43], a[16:19]
  buffer_load_dwordx4 v8, s[8:11], s35 offen offset:0 nt lds
  v_add_f32 v15, v15, v50
  v_mfma_f32_16x16x32_bf16 a[20:23], a[236:239], v[44:47], a[20:23]
  s_waitcnt lgkmcnt(2)
  v_exp_f32 v51, v51
  v_mfma_f32_16x16x32_bf16 a[44:47], a[240:243], v[44:47], a[44:47]
  ds_read_b64_tr_b16 a[236:237], v7 offset:12288
  v_mul_f32 v72, s30, v72
  v_mfma_f32_16x16x32_bf16 a[40:43], a[240:243], v[40:43], a[40:43]
  v_add_f32 v15, v15, v51
  v_cvt_pk_bf16_f32 v49, v50, v51
  v_mfma_f32_16x16x32_bf16 a[36:39], a[240:243], v[36:39], a[36:39]
  v_exp_f32 v72, v72
  v_mfma_f32_16x16x32_bf16 a[32:35], a[240:243], v[32:35], a[32:35]
  ds_read_b64_tr_b16 a[238:239], v7 offset:14336
  v_mul_f32 v73, s30, v73
  v_mfma_f32_16x16x32_bf16 a[28:31], a[240:243], v[28:31], a[28:31]
  v_add_f32 v15, v15, v72
  v_mfma_f32_16x16x32_bf16 a[24:27], a[240:243], v[24:27], a[24:27]
  s_waitcnt lgkmcnt(2)
  v_exp_f32 v73, v73
  v_mfma_f32_16x16x32_bf16 a[48:51], a[244:247], v[24:27], a[48:51]
  ds_read_b64_tr_b16 a[240:241], v4 offset:16384
  v_mul_f32 v74, s30, v74
  v_mfma_f32_16x16x32_bf16 a[52:55], a[244:247], v[28:31], a[52:55]
  v_add_f32 v15, v15, v73
  v_cvt_pk_bf16_f32 v50, v72, v73
  v_mfma_f32_16x16x32_bf16 a[56:59], a[244:247], v[32:35], a[56:59]
  v_exp_f32 v74, v74
  v_mfma_f32_16x16x32_bf16 a[60:63], a[244:247], v[36:39], a[60:63]
  ds_read_b64_tr_b16 a[242:243], v4 offset:18432
  s_add_u32 m0, s25, 155520
  v_mul_f32 v75, s30, v75
  v_mfma_f32_16x16x32_bf16 a[64:67], a[244:247], v[40:43], a[64:67]
  buffer_load_dwordx4 v8, s[8:11], s35 offen offset:128 nt lds
  v_add_f32 v15, v15, v74
  v_mfma_f32_16x16x32_bf16 a[68:71], a[244:247], v[44:47], a[68:71]
  s_waitcnt lgkmcnt(2)
  v_exp_f32 v75, v75
  v_mfma_f32_16x16x32_bf16 a[92:95], a[236:239], v[44:47], a[92:95]
  ds_read_b64_tr_b16 a[244:245], v5 offset:16384
  v_mul_f32 v52, s30, v52
  v_mfma_f32_16x16x32_bf16 a[88:91], a[236:239], v[40:43], a[88:91]
  v_add_f32 v15, v15, v75
  v_cvt_pk_bf16_f32 v51, v74, v75
  v_mfma_f32_16x16x32_bf16 a[84:87], a[236:239], v[36:39], a[84:87]
  v_exp_f32 v52, v52
  v_mfma_f32_16x16x32_bf16 a[80:83], a[236:239], v[32:35], a[80:83]
  ds_read_b64_tr_b16 a[246:247], v5 offset:18432
  v_mul_f32 v53, s30, v53
  v_mfma_f32_16x16x32_bf16 a[76:79], a[236:239], v[28:31], a[76:79]
  v_add_f32 v16, v16, v52
  v_mfma_f32_16x16x32_bf16 a[72:75], a[236:239], v[24:27], a[72:75]
  s_waitcnt lgkmcnt(2)
  v_exp_f32 v53, v53
  v_mfma_f32_16x16x32_bf16 a[96:99], a[240:243], v[24:27], a[96:99]
  ds_read_b64_tr_b16 a[236:237], v6 offset:16384
  v_mul_f32 v54, s30, v54
  v_mfma_f32_16x16x32_bf16 a[100:103], a[240:243], v[28:31], a[100:103]
  v_add_f32 v16, v16, v53
  v_cvt_pk_bf16_f32 v52, v52, v53
  v_mfma_f32_16x16x32_bf16 a[104:107], a[240:243], v[32:35], a[104:107]
  v_exp_f32 v54, v54
  v_mfma_f32_16x16x32_bf16 a[108:111], a[240:243], v[36:39], a[108:111]
  ds_read_b64_tr_b16 a[238:239], v6 offset:18432
  s_add_u32 s35, s28, 15360
  s_add_u32 m0, s25, 151552
  v_mul_f32 v55, s30, v55
  v_mfma_f32_16x16x32_bf16 a[112:115], a[240:243], v[40:43], a[112:115]
  buffer_load_dwordx4 v8, s[8:11], s35 offen offset:0 nt lds
  v_add_f32 v16, v16, v54
  v_mfma_f32_16x16x32_bf16 a[116:119], a[240:243], v[44:47], a[116:119]
  s_waitcnt lgkmcnt(2)
  v_exp_f32 v55, v55
  v_mfma_f32_16x16x32_bf16 v[108:111], a[244:247], v[44:47], v[108:111]
  ds_read_b64_tr_b16 a[240:241], v7 offset:16384
  v_mul_f32 v76, s30, v76
  v_mfma_f32_16x16x32_bf16 a[136:139], a[244:247], v[40:43], a[136:139]
  v_add_f32 v16, v16, v55
  v_cvt_pk_bf16_f32 v53, v54, v55
  v_mfma_f32_16x16x32_bf16 a[132:135], a[244:247], v[36:39], a[132:135]
  v_exp_f32 v76, v76
  v_mfma_f32_16x16x32_bf16 a[128:131], a[244:247], v[32:35], a[128:131]
  ds_read_b64_tr_b16 a[242:243], v7 offset:18432
  v_mul_f32 v77, s30, v77
  v_mfma_f32_16x16x32_bf16 a[124:127], a[244:247], v[28:31], a[124:127]
  v_add_f32 v16, v16, v76
  v_mfma_f32_16x16x32_bf16 a[120:123], a[244:247], v[24:27], a[120:123]
  s_waitcnt lgkmcnt(2)
  v_exp_f32 v77, v77
  v_mfma_f32_16x16x32_bf16 v[112:115], a[236:239], v[24:27], v[112:115]
  ds_read_b64_tr_b16 a[244:245], v4 offset:20480
  v_mul_f32 v78, s30, v78
  v_mfma_f32_16x16x32_bf16 v[116:119], a[236:239], v[28:31], v[116:119]
  v_add_f32 v16, v16, v77
  v_cvt_pk_bf16_f32 v54, v76, v77
  v_mfma_f32_16x16x32_bf16 v[120:123], a[236:239], v[32:35], v[120:123]
  v_exp_f32 v78, v78
  v_mfma_f32_16x16x32_bf16 v[124:127], a[236:239], v[36:39], v[124:127]
  ds_read_b64_tr_b16 a[246:247], v4 offset:22528
  s_add_u32 m0, s25, 159616
  v_mul_f32 v79, s30, v79
  v_mfma_f32_16x16x32_bf16 v[128:131], a[236:239], v[40:43], v[128:131]
  buffer_load_dwordx4 v8, s[8:11], s35 offen offset:128 nt lds
  v_add_f32 v16, v16, v78
  v_mfma_f32_16x16x32_bf16 v[132:135], a[236:239], v[44:47], v[132:135]
  s_waitcnt lgkmcnt(2)
  v_exp_f32 v79, v79
  v_mfma_f32_16x16x32_bf16 v[156:159], a[240:243], v[44:47], v[156:159]
  ds_read_b64_tr_b16 a[236:237], v5 offset:20480
  v_mul_f32 v56, s30, v56
  v_mfma_f32_16x16x32_bf16 v[152:155], a[240:243], v[40:43], v[152:155]
  v_add_f32 v16, v16, v79
  v_cvt_pk_bf16_f32 v55, v78, v79
  v_mfma_f32_16x16x32_bf16 v[148:151], a[240:243], v[36:39], v[148:151]
  v_exp_f32 v56, v56
  v_mfma_f32_16x16x32_bf16 v[144:147], a[240:243], v[32:35], v[144:147]
  ds_read_b64_tr_b16 a[238:239], v5 offset:22528
  v_mul_f32 v57, s30, v57
  v_mfma_f32_16x16x32_bf16 v[140:143], a[240:243], v[28:31], v[140:143]
  v_add_f32 v17, v17, v56
  v_mfma_f32_16x16x32_bf16 v[136:139], a[240:243], v[24:27], v[136:139]
  s_waitcnt lgkmcnt(2)
  v_exp_f32 v57, v57
  v_mfma_f32_16x16x32_bf16 v[160:163], a[244:247], v[24:27], v[160:163]
  ds_read_b64_tr_b16 a[240:241], v6 offset:20480
  v_mul_f32 v58, s30, v58
  v_mfma_f32_16x16x32_bf16 v[164:167], a[244:247], v[28:31], v[164:167]
  v_add_f32 v17, v17, v57
  v_cvt_pk_bf16_f32 v56, v56, v57
  v_mfma_f32_16x16x32_bf16 v[168:171], a[244:247], v[32:35], v[168:171]
  v_exp_f32 v58, v58
  v_mfma_f32_16x16x32_bf16 v[172:175], a[244:247], v[36:39], v[172:175]
  ds_read_b64_tr_b16 a[242:243], v6 offset:22528
  v_mul_f32 v59, s30, v59
  v_mfma_f32_16x16x32_bf16 v[176:179], a[244:247], v[40:43], v[176:179]
  v_add_f32 v17, v17, v58
  v_mfma_f32_16x16x32_bf16 v[180:183], a[244:247], v[44:47], v[180:183]
  s_waitcnt lgkmcnt(2)
  v_exp_f32 v59, v59
  v_mfma_f32_16x16x32_bf16 v[204:207], a[236:239], v[44:47], v[204:207]
  ds_read_b64_tr_b16 a[244:245], v7 offset:20480
  v_mul_f32 v80, s30, v80
  v_mfma_f32_16x16x32_bf16 v[200:203], a[236:239], v[40:43], v[200:203]
  v_add_f32 v17, v17, v59
  v_cvt_pk_bf16_f32 v57, v58, v59
  v_mfma_f32_16x16x32_bf16 v[196:199], a[236:239], v[36:39], v[196:199]
  v_exp_f32 v80, v80
  v_mfma_f32_16x16x32_bf16 v[192:195], a[236:239], v[32:35], v[192:195]
  ds_read_b64_tr_b16 a[246:247], v7 offset:22528
  v_mul_f32 v81, s30, v81
  v_mfma_f32_16x16x32_bf16 v[188:191], a[236:239], v[28:31], v[188:191]
  v_add_f32 v17, v17, v80
  v_mfma_f32_16x16x32_bf16 v[184:187], a[236:239], v[24:27], v[184:187]
  s_waitcnt lgkmcnt(2)
  v_exp_f32 v81, v81
  v_mfma_f32_16x16x32_bf16 v[208:211], a[240:243], v[24:27], v[208:211]
  v_mul_f32 v82, s30, v82
  v_mul_f32 v83, s30, v83
  v_mfma_f32_16x16x32_bf16 v[212:215], a[240:243], v[28:31], v[212:215]
  v_add_f32 v17, v17, v81
  v_cvt_pk_bf16_f32 v58, v80, v81
  v_mfma_f32_16x16x32_bf16 v[216:219], a[240:243], v[32:35], v[216:219]
  s_waitcnt vmcnt(16) lgkmcnt(0)
  v_exp_f32 v82, v82
  v_mfma_f32_16x16x32_bf16 v[220:223], a[240:243], v[36:39], v[220:223]
  s_barrier
  v_mfma_f32_16x16x32_bf16 v[224:227], a[240:243], v[40:43], v[224:227]
  ds_read_b128 a[236:239], v0 offset:24576
  v_add_f32 v17, v17, v82
  v_mfma_f32_16x16x32_bf16 v[228:231], a[240:243], v[44:47], v[228:231]
  v_exp_f32 v83, v83
  v_mfma_f32_16x16x32_bf16 v[252:255], a[244:247], v[44:47], v[252:255]
  ds_read_b128 a[248:251], v2 offset:0
  v_mul_f32 v60, s30, v60
  v_mfma_f32_16x16x32_bf16 v[248:251], a[244:247], v[40:43], v[248:251]
  v_add_f32 v17, v17, v83
  v_cvt_pk_bf16_f32 v59, v82, v83
  v_mfma_f32_16x16x32_bf16 v[244:247], a[244:247], v[36:39], v[244:247]
  v_exp_f32 v60, v60
  v_mfma_f32_16x16x32_bf16 v[240:243], a[244:247], v[32:35], v[240:243]
  ds_read_b128 a[252:255], v2 offset:2048
  v_mul_f32 v61, s30, v61
  v_mfma_f32_16x16x32_bf16 v[236:239], a[244:247], v[28:31], v[236:239]
  ds_read_b128 a[240:243], v0 offset:26624
  v_add_f32 v18, v18, v60
  v_mfma_f32_16x16x32_bf16 v[232:235], a[244:247], v[24:27], v[232:235]
  s_waitcnt lgkmcnt(3)
  v_exp_f32 v61, v61
  v_mfma_f32_16x16x32_bf16 v[24:27], a[236:239], a[140:143], v[10:13]
  ds_read_b128 a[244:247], v1 offset:24576
  v_mul_f32 v62, s30, v62
  v_mfma_f32_16x16x32_bf16 v[28:31], a[236:239], a[164:167], v[10:13]
  v_add_f32 v18, v18, v61
  v_cvt_pk_bf16_f32 v60, v60, v61
  v_mfma_f32_16x16x32_bf16 v[32:35], a[236:239], a[188:191], v[10:13]
  v_exp_f32 v62, v62
  v_mfma_f32_16x16x32_bf16 v[36:39], a[236:239], a[212:215], v[10:13]
  s_waitcnt lgkmcnt(2)
  s_add_u32 s35, s28, 0
  s_add_u32 m0, s25, 12288
  v_mul_f32 v63, s30, v63
  v_mfma_f32_16x16x32_bf16 v[40:43], a[236:239], a[248:251], v[10:13]
  buffer_load_dwordx4 v8, s[8:11], s35 offen offset:0 nt lds
  v_add_f32 v18, v18, v62
  v_mfma_f32_16x16x32_bf16 v[44:47], a[236:239], a[252:255], v[10:13]
  s_waitcnt lgkmcnt(1)
  v_exp_f32 v63, v63
  v_mfma_f32_16x16x32_bf16 v[92:95], a[240:243], a[252:255], v[10:13]
  ds_read_b128 a[252:255], v3 offset:2048
  v_mul_f32 v96, s30, v96
  v_mfma_f32_16x16x32_bf16 v[88:91], a[240:243], a[248:251], v[10:13]
  v_add_f32 v18, v18, v63
  v_cvt_pk_bf16_f32 v61, v62, v63
  v_mfma_f32_16x16x32_bf16 v[84:87], a[240:243], a[212:215], v[10:13]
  v_exp_f32 v96, v96
  v_mfma_f32_16x16x32_bf16 v[80:83], a[240:243], a[188:191], v[10:13]
  ds_read_b128 a[248:251], v3 offset:0
  v_mul_f32 v97, s30, v97
  v_mfma_f32_16x16x32_bf16 v[76:79], a[240:243], a[164:167], v[10:13]
  ds_read_b128 a[236:239], v1 offset:26624
  v_add_f32 v18, v18, v96
  v_mfma_f32_16x16x32_bf16 v[72:75], a[240:243], a[140:143], v[10:13]
  s_waitcnt lgkmcnt(3)
  v_exp_f32 v97, v97
  v_mfma_f32_16x16x32_bf16 v[24:27], a[244:247], a[144:147], v[24:27]
  ds_read_b128 a[240:243], v0 offset:28672
  v_mul_f32 v98, s30, v98
  v_mfma_f32_16x16x32_bf16 v[28:31], a[244:247], a[168:171], v[28:31]
  v_add_f32 v18, v18, v97
  v_cvt_pk_bf16_f32 v62, v96, v97
  v_mfma_f32_16x16x32_bf16 v[32:35], a[244:247], a[192:195], v[32:35]
  v_exp_f32 v98, v98
  v_mfma_f32_16x16x32_bf16 v[36:39], a[244:247], a[216:219], v[36:39]
  s_waitcnt lgkmcnt(2)
  s_add_u32 m0, s25, 16256
  v_mul_f32 v99, s30, v99
  v_mfma_f32_16x16x32_bf16 v[40:43], a[244:247], a[248:251], v[40:43]
  buffer_load_dwordx4 v8, s[8:11], s35 offen offset:128 nt lds
  v_add_f32 v18, v18, v98
  v_mfma_f32_16x16x32_bf16 v[44:47], a[244:247], a[252:255], v[44:47]
  s_waitcnt lgkmcnt(1)
  v_exp_f32 v99, v99
  v_mfma_f32_16x16x32_bf16 v[92:95], a[236:239], a[252:255], v[92:95]
  ds_read_b128 a[252:255], v2 offset:6144
  v_mul_f32 v64, s30, v64
  v_mfma_f32_16x16x32_bf16 v[88:91], a[236:239], a[248:251], v[88:91]
  v_add_f32 v18, v18, v99
  v_cvt_pk_bf16_f32 v63, v98, v99
  v_mfma_f32_16x16x32_bf16 v[84:87], a[236:239], a[216:219], v[84:87]
  v_exp_f32 v64, v64
  v_mfma_f32_16x16x32_bf16 v[80:83], a[236:239], a[192:195], v[80:83]
  ds_read_b128 a[248:251], v2 offset:4096
  v_mul_f32 v65, s30, v65
  v_mfma_f32_16x16x32_bf16 v[76:79], a[236:239], a[168:171], v[76:79]
  ds_read_b128 a[244:247], v0 offset:30720
  v_add_f32 v19, v19, v64
  v_mfma_f32_16x16x32_bf16 v[72:75], a[236:239], a[144:147], v[72:75]
  s_waitcnt lgkmcnt(3)
  v_exp_f32 v65, v65
  v_mfma_f32_16x16x32_bf16 v[24:27], a[240:243], a[148:151], v[24:27]
  ds_read_b128 a[236:239], v1 offset:28672
  v_mul_f32 v66, s30, v66
  v_mfma_f32_16x16x32_bf16 v[28:31], a[240:243], a[172:175], v[28:31]
  v_add_f32 v19, v19, v65
  v_cvt_pk_bf16_f32 v64, v64, v65
  v_mfma_f32_16x16x32_bf16 v[32:35], a[240:243], a[196:199], v[32:35]
  v_exp_f32 v66, v66
  v_mfma_f32_16x16x32_bf16 v[36:39], a[240:243], a[220:223], v[36:39]
  s_waitcnt lgkmcnt(2)
  s_add_u32 m0, s25, 20224
  v_mul_f32 v67, s30, v67
  v_mfma_f32_16x16x32_bf16 v[40:43], a[240:243], a[248:251], v[40:43]
  buffer_load_dwordx4 v8, s[8:11], s35 offen offset:256 nt lds
  v_add_f32 v19, v19, v66
  v_mfma_f32_16x16x32_bf16 v[44:47], a[240:243], a[252:255], v[44:47]
  s_waitcnt lgkmcnt(1)
  v_exp_f32 v67, v67
  v_mfma_f32_16x16x32_bf16 v[92:95], a[244:247], a[252:255], v[92:95]
  ds_read_b128 a[252:255], v3 offset:6144
  v_mul_f32 v100, s30, v100
  v_mfma_f32_16x16x32_bf16 v[88:91], a[244:247], a[248:251], v[88:91]
  v_add_f32 v19, v19, v67
  v_cvt_pk_bf16_f32 v65, v66, v67
  v_mfma_f32_16x16x32_bf16 v[84:87], a[244:247], a[220:223], v[84:87]
  v_exp_f32 v100, v100
  v_mfma_f32_16x16x32_bf16 v[80:83], a[244:247], a[196:199], v[80:83]
  ds_read_b128 a[248:251], v3 offset:4096
  v_mul_f32 v101, s30, v101
  v_mfma_f32_16x16x32_bf16 v[76:79], a[244:247], a[172:175], v[76:79]
  ds_read_b128 a[240:243], v1 offset:30720
  v_add_f32 v19, v19, v100
  v_mfma_f32_16x16x32_bf16 v[72:75], a[244:247], a[148:151], v[72:75]
  s_waitcnt lgkmcnt(3)
  v_exp_f32 v101, v101
  v_mfma_f32_16x16x32_bf16 v[24:27], a[236:239], a[152:155], v[24:27]
  ds_read_b128 a[244:247], v0 offset:32768
  v_mul_f32 v102, s30, v102
  v_mfma_f32_16x16x32_bf16 v[28:31], a[236:239], a[176:179], v[28:31]
  v_add_f32 v19, v19, v101
  v_cvt_pk_bf16_f32 v66, v100, v101
  v_mfma_f32_16x16x32_bf16 v[32:35], a[236:239], a[200:203], v[32:35]
  v_exp_f32 v102, v102
  v_mfma_f32_16x16x32_bf16 v[36:39], a[236:239], a[224:227], v[36:39]
  s_waitcnt lgkmcnt(2)
  s_add_u32 s35, s28, 3072
  s_add_u32 m0, s25, 61440
  v_mul_f32 v103, s30, v103
  v_mfma_f32_16x16x32_bf16 v[40:43], a[236:239], a[248:251], v[40:43]
  buffer_load_dwordx4 v8, s[8:11], s35 offen offset:0 nt lds
  v_add_f32 v19, v19, v102
  v_mfma_f32_16x16x32_bf16 v[44:47], a[236:239], a[252:255], v[44:47]
  s_waitcnt lgkmcnt(1)
  v_exp_f32 v103, v103
  v_mfma_f32_16x16x32_bf16 v[92:95], a[240:243], a[252:255], v[92:95]
  ds_read_b128 a[252:255], v2 offset:10240
  v_mul_f32 v68, s30, v68
  v_mfma_f32_16x16x32_bf16 v[88:91], a[240:243], a[248:251], v[88:91]
  v_add_f32 v19, v19, v103
  v_cvt_pk_bf16_f32 v67, v102, v103
  v_mfma_f32_16x16x32_bf16 v[84:87], a[240:243], a[224:227], v[84:87]
  v_exp_f32 v68, v68
  v_mfma_f32_16x16x32_bf16 v[80:83], a[240:243], a[200:203], v[80:83]
  ds_read_b128 a[248:251], v2 offset:8192
  v_mul_f32 v69, s30, v69
  v_mfma_f32_16x16x32_bf16 v[76:79], a[240:243], a[176:179], v[76:79]
  ds_read_b128 a[236:239], v0 offset:34816
  v_add_f32 v20, v20, v68
  v_mfma_f32_16x16x32_bf16 v[72:75], a[240:243], a[152:155], v[72:75]
  s_waitcnt lgkmcnt(3)
  v_exp_f32 v69, v69
  v_mfma_f32_16x16x32_bf16 v[24:27], a[244:247], a[156:159], v[24:27]
  ds_read_b128 a[240:243], v1 offset:32768
  v_mul_f32 v70, s30, v70
  v_mfma_f32_16x16x32_bf16 v[28:31], a[244:247], a[180:183], v[28:31]
  v_add_f32 v20, v20, v69
  v_cvt_pk_bf16_f32 v68, v68, v69
  v_mfma_f32_16x16x32_bf16 v[32:35], a[244:247], a[204:207], v[32:35]
  v_exp_f32 v70, v70
  v_mfma_f32_16x16x32_bf16 v[36:39], a[244:247], a[228:231], v[36:39]
  s_waitcnt lgkmcnt(2)
  s_add_u32 m0, s25, 65408
  v_mul_f32 v71, s30, v71
  v_mfma_f32_16x16x32_bf16 v[40:43], a[244:247], a[248:251], v[40:43]
  buffer_load_dwordx4 v8, s[8:11], s35 offen offset:128 nt lds
  v_add_f32 v20, v20, v70
  v_mfma_f32_16x16x32_bf16 v[44:47], a[244:247], a[252:255], v[44:47]
  s_waitcnt lgkmcnt(1)
  v_exp_f32 v71, v71
  v_mfma_f32_16x16x32_bf16 v[92:95], a[236:239], a[252:255], v[92:95]
  ds_read_b128 a[252:255], v3 offset:10240
  v_mul_f32 v104, s30, v104
  v_mfma_f32_16x16x32_bf16 v[88:91], a[236:239], a[248:251], v[88:91]
  v_add_f32 v20, v20, v71
  v_cvt_pk_bf16_f32 v69, v70, v71
  v_mfma_f32_16x16x32_bf16 v[84:87], a[236:239], a[228:231], v[84:87]
  v_exp_f32 v104, v104
  v_mfma_f32_16x16x32_bf16 v[80:83], a[236:239], a[204:207], v[80:83]
  ds_read_b128 a[248:251], v3 offset:8192
  v_mul_f32 v105, s30, v105
  v_mfma_f32_16x16x32_bf16 v[76:79], a[236:239], a[180:183], v[76:79]
  ds_read_b128 a[244:247], v1 offset:34816
  v_add_f32 v20, v20, v104
  v_mfma_f32_16x16x32_bf16 v[72:75], a[236:239], a[156:159], v[72:75]
  s_waitcnt lgkmcnt(3)
  v_exp_f32 v105, v105
  v_mfma_f32_16x16x32_bf16 v[24:27], a[240:243], a[160:163], v[24:27]
  ds_read_b64_tr_b16 a[236:237], v4 offset:24576
  v_mul_f32 v106, s30, v106
  v_mfma_f32_16x16x32_bf16 v[28:31], a[240:243], a[184:187], v[28:31]
  v_add_f32 v20, v20, v105
  v_cvt_pk_bf16_f32 v70, v104, v105
  v_mfma_f32_16x16x32_bf16 v[32:35], a[240:243], a[208:211], v[32:35]
  v_exp_f32 v106, v106
  v_mfma_f32_16x16x32_bf16 v[36:39], a[240:243], a[232:235], v[36:39]
  ds_read_b64_tr_b16 a[238:239], v4 offset:26624
  s_waitcnt lgkmcnt(3)
  s_add_u32 m0, s25, 69376
  v_mul_f32 v107, s30, v107
  v_mfma_f32_16x16x32_bf16 v[40:43], a[240:243], a[248:251], v[40:43]
  buffer_load_dwordx4 v8, s[8:11], s35 offen offset:256 nt lds
  v_add_f32 v20, v20, v106
  v_mfma_f32_16x16x32_bf16 v[44:47], a[240:243], a[252:255], v[44:47]
  s_waitcnt lgkmcnt(2)
  v_exp_f32 v107, v107
  v_mfma_f32_16x16x32_bf16 v[92:95], a[244:247], a[252:255], v[92:95]
  ds_read_b64_tr_b16 a[240:241], v5 offset:24576
  v_mul_f32 v24, s30, v24
  v_mfma_f32_16x16x32_bf16 v[88:91], a[244:247], a[248:251], v[88:91]
  v_add_f32 v20, v20, v107
  v_cvt_pk_bf16_f32 v71, v106, v107
  v_mfma_f32_16x16x32_bf16 v[84:87], a[244:247], a[232:235], v[84:87]
  v_exp_f32 v24, v24
  v_mfma_f32_16x16x32_bf16 v[80:83], a[244:247], a[208:211], v[80:83]
  ds_read_b64_tr_b16 a[242:243], v5 offset:26624
  v_mul_f32 v25, s30, v25
  v_mfma_f32_16x16x32_bf16 v[76:79], a[244:247], a[184:187], v[76:79]
  v_add_f32 v15, v15, v24
  v_mfma_f32_16x16x32_bf16 v[72:75], a[244:247], a[160:163], v[72:75]
  s_waitcnt lgkmcnt(2)
  v_exp_f32 v25, v25
  v_mfma_f32_16x16x32_bf16 a[0:3], a[236:239], v[48:51], a[0:3]
  ds_read_b64_tr_b16 a[244:245], v6 offset:24576
  v_mul_f32 v26, s30, v26
  v_mfma_f32_16x16x32_bf16 a[4:7], a[236:239], v[52:55], a[4:7]
  v_add_f32 v15, v15, v25
  v_cvt_pk_bf16_f32 v24, v24, v25
  v_mfma_f32_16x16x32_bf16 a[8:11], a[236:239], v[56:59], a[8:11]
  s_barrier
  v_exp_f32 v26, v26
  v_mfma_f32_16x16x32_bf16 a[12:15], a[236:239], v[60:63], a[12:15]
  ds_read_b64_tr_b16 a[246:247], v6 offset:26624
  s_add_u32 s35, s28, 6144
  s_add_u32 m0, s25, 24576
  v_mul_f32 v27, s30, v27
  s_waitcnt vmcnt(9)
  s_cbranch_vccnz L_aw0
L_ar0:
  v_mfma_f32_16x16x32_bf16 a[16:19], a[236:239], v[64:67], a[16:19]
  buffer_load_dwordx4 v8, s[8:11], s35 offen offset:0 nt lds
  v_add_f32 v15, v15, v26
  v_mfma_f32_16x16x32_bf16 a[20:23], a[236:239], v[68:71], a[20:23]
  s_waitcnt lgkmcnt(2)
  v_exp_f32 v27, v27
  v_mfma_f32_16x16x32_bf16 a[44:47], a[240:243], v[68:71], a[44:47]
  ds_read_b64_tr_b16 a[236:237], v7 offset:24576
  v_mul_f32 v72, s30, v72
  v_mfma_f32_16x16x32_bf16 a[40:43], a[240:243], v[64:67], a[40:43]
  v_add_f32 v15, v15, v27
  v_cvt_pk_bf16_f32 v25, v26, v27
  v_mfma_f32_16x16x32_bf16 a[36:39], a[240:243], v[60:63], a[36:39]
  v_exp_f32 v72, v72
  v_mfma_f32_16x16x32_bf16 a[32:35], a[240:243], v[56:59], a[32:35]
  ds_read_b64_tr_b16 a[238:239], v7 offset:26624
  s_add_u32 m0, s25, 28544
  v_mul_f32 v73, s30, v73
  s_waitcnt vmcnt(9)
  s_cbranch_vccnz L_aw1
L_ar1:
  v_mfma_f32_16x16x32_bf16 a[28:31], a[240:243], v[52:55], a[28:31]
  buffer_load_dwordx4 v8, s[8:11], s35 offen offset:128 nt lds
  v_add_f32 v15, v15, v72
  v_mfma_f32_16x16x32_bf16 a[24:27], a[240:243], v[48:51], a[24:27]
  s_waitcnt lgkmcnt(2)
  v_exp_f32 v73, v73
  v_mfma_f32_16x16x32_bf16 a[48:51], a[244:247], v[48:51], a[48:51]
  ds_read_b64_tr_b16 a[240:241], v4 offset:28672
  v_mul_f32 v74, s30, v74
  v_mfma_f32_16x16x32_bf16 a[52:55], a[244:247], v[52:55], a[52:55]
  v_add_f32 v15, v15, v73
  v_cvt_pk_bf16_f32 v26, v72, v73
  v_mfma_f32_16x16x32_bf16 a[56:59], a[244:247], v[56:59], a[56:59]
  v_exp_f32 v74, v74
  v_mfma_f32_16x16x32_bf16 a[60:63], a[244:247], v[60:63], a[60:63]
  ds_read_b64_tr_b16 a[242:243], v4 offset:30720
  s_add_u32 m0, s25, 32512
  v_mul_f32 v75, s30, v75
  s_waitcnt vmcnt(9)
  s_cbranch_vccnz L_aw2
L_ar2:
  v_mfma_f32_16x16x32_bf16 a[64:67], a[244:247], v[64:67], a[64:67]
  buffer_load_dwordx4 v8, s[8:11], s35 offen offset:256 nt lds
  v_add_f32 v15, v15, v74
  v_mfma_f32_16x16x32_bf16 a[68:71], a[244:247], v[68:71], a[68:71]
  s_waitcnt lgkmcnt(2)
  v_exp_f32 v75, v75
  v_mfma_f32_16x16x32_bf16 a[92:95], a[236:239], v[68:71], a[92:95]
  ds_read_b64_tr_b16 a[244:245], v5 offset:28672
  v_mul_f32 v28, s30, v28
  v_mfma_f32_16x16x32_bf16 a[88:91], a[236:239], v[64:67], a[88:91]
  v_add_f32 v15, v15, v75
  v_cvt_pk_bf16_f32 v27, v74, v75
  v_mfma_f32_16x16x32_bf16 a[84:87], a[236:239], v[60:63], a[84:87]
  v_exp_f32 v28, v28
  v_mfma_f32_16x16x32_bf16 a[80:83], a[236:239], v[56:59], a[80:83]
  ds_read_b64_tr_b16 a[246:247], v5 offset:30720
  v_mul_f32 v29, s30, v29
  v_mfma_f32_16x16x32_bf16 a[76:79], a[236:239], v[52:55], a[76:79]
  v_add_f32 v16, v16, v28
  v_mfma_f32_16x16x32_bf16 a[72:75], a[236:239], v[48:51], a[72:75]
  s_waitcnt lgkmcnt(2)
  v_exp_f32 v29, v29
  v_mfma_f32_16x16x32_bf16 a[96:99], a[240:243], v[48:51], a[96:99]
  ds_read_b64_tr_b16 a[236:237], v6 offset:28672
  v_mul_f32 v30, s30, v30
  v_mfma_f32_16x16x32_bf16 a[100:103], a[240:243], v[52:55], a[100:103]
  v_add_f32 v16, v16, v29
  v_cvt_pk_bf16_f32 v28, v28, v29
  v_mfma_f32_16x16x32_bf16 a[104:107], a[240:243], v[56:59], a[104:107]
  v_exp_f32 v30, v30
  v_mfma_f32_16x16x32_bf16 a[108:111], a[240:243], v[60:63], a[108:111]
  ds_read_b64_tr_b16 a[238:239], v6 offset:30720
  v_mul_f32 v31, s30, v31
  v_mfma_f32_16x16x32_bf16 a[112:115], a[240:243], v[64:67], a[112:115]
  v_add_f32 v16, v16, v30
  v_mfma_f32_16x16x32_bf16 a[116:119], a[240:243], v[68:71], a[116:119]
  s_waitcnt lgkmcnt(2)
  v_exp_f32 v31, v31
  v_mfma_f32_16x16x32_bf16 v[108:111], a[244:247], v[68:71], v[108:111]
  ds_read_b64_tr_b16 a[240:241], v7 offset:28672
  v_mul_f32 v76, s30, v76
  v_mfma_f32_16x16x32_bf16 a[136:139], a[244:247], v[64:67], a[136:139]
  v_add_f32 v16, v16, v31
  v_cvt_pk_bf16_f32 v29, v30, v31
  v_mfma_f32_16x16x32_bf16 a[132:135], a[244:247], v[60:63], a[132:135]
  v_exp_f32 v76, v76
  v_mfma_f32_16x16x32_bf16 a[128:131], a[244:247], v[56:59], a[128:131]
  ds_read_b64_tr_b16 a[242:243], v7 offset:30720
  v_mul_f32 v77, s30, v77
  v_mfma_f32_16x16x32_bf16 a[124:127], a[244:247], v[52:55], a[124:127]
  v_add_f32 v16, v16, v76
  v_mfma_f32_16x16x32_bf16 a[120:123], a[244:247], v[48:51], a[120:123]
  s_waitcnt lgkmcnt(2)
  v_exp_f32 v77, v77
  v_mfma_f32_16x16x32_bf16 v[112:115], a[236:239], v[48:51], v[112:115]
  ds_read_b64_tr_b16 a[244:245], v4 offset:32768
  v_mul_f32 v78, s30, v78
  v_mfma_f32_16x16x32_bf16 v[116:119], a[236:239], v[52:55], v[116:119]
  v_add_f32 v16, v16, v77
  v_cvt_pk_bf16_f32 v30, v76, v77
  v_mfma_f32_16x16x32_bf16 v[120:123], a[236:239], v[56:59], v[120:123]
  v_exp_f32 v78, v78
  v_mfma_f32_16x16x32_bf16 v[124:127], a[236:239], v[60:63], v[124:127]
  ds_read_b64_tr_b16 a[246:247], v4 offset:34816
  v_mul_f32 v79, s30, v79
  v_mfma_f32_16x16x32_bf16 v[128:131], a[236:239], v[64:67], v[128:131]
  v_add_f32 v16, v16, v78
  v_mfma_f32_16x16x32_bf16 v[132:135], a[236:239], v[68:71], v[132:135]
  s_waitcnt lgkmcnt(2)
  v_exp_f32 v79, v79
  v_mfma_f32_16x16x32_bf16 v[156:159], a[240:243], v[68:71], v[156:159]
  ds_read_b64_tr_b16 a[236:237], v5 offset:32768
  v_mul_f32 v32, s30, v32
  v_mfma_f32_16x16x32_bf16 v[152:155], a[240:243], v[64:67], v[152:155]
  v_add_f32 v16, v16, v79
  v_cvt_pk_bf16_f32 v31, v78, v79
  v_mfma_f32_16x16x32_bf16 v[148:151], a[240:243], v[60:63], v[148:151]
  v_exp_f32 v32, v32
  v_mfma_f32_16x16x32_bf16 v[144:147], a[240:243], v[56:59], v[144:147]
  ds_read_b64_tr_b16 a[238:239], v5 offset:34816
  v_mul_f32 v33, s30, v33
  v_mfma_f32_16x16x32_bf16 v[140:143], a[240:243], v[52:55], v[140:143]
  v_add_f32 v17, v17, v32
  v_mfma_f32_16x16x32_bf16 v[136:139], a[240:243], v[48:51], v[136:139]
  s_waitcnt lgkmcnt(2)
  v_exp_f32 v33, v33
  v_mfma_f32_16x16x32_bf16 v[160:163], a[244:247], v[48:51], v[160:163]
  ds_read_b64_tr_b16 a[240:241], v6 offset:32768
  v_mul_f32 v34, s30, v34
  v_mfma_f32_16x16x32_bf16 v[164:167], a[244:247], v[52:55], v[164:167]
  v_add_f32 v17, v17, v33
  v_cvt_pk_bf16_f32 v32, v32, v33
  v_mfma_f32_16x16x32_bf16 v[168:171], a[244:247], v[56:59], v[168:171]
  v_exp_f32 v34, v34
  v_mfma_f32_16x16x32_bf16 v[172:175], a[244:247], v[60:63], v[172:175]
  ds_read_b64_tr_b16 a[242:243], v6 offset:34816
  v_mul_f32 v35, s30, v35
  v_mfma_f32_16x16x32_bf16 v[176:179], a[244:247], v[64:67], v[176:179]
  v_add_f32 v17, v17, v34
  v_mfma_f32_16x16x32_bf16 v[180:183], a[244:247], v[68:71], v[180:183]
  s_waitcnt lgkmcnt(2)
  v_exp_f32 v35, v35
  v_mfma_f32_16x16x32_bf16 v[204:207], a[236:239], v[68:71], v[204:207]
  ds_read_b64_tr_b16 a[244:245], v7 offset:32768
  v_mul_f32 v80, s30, v80
  v_mfma_f32_16x16x32_bf16 v[200:203], a[236:239], v[64:67], v[200:203]
  v_add_f32 v17, v17, v35
  v_cvt_pk_bf16_f32 v33, v34, v35
  v_mfma_f32_16x16x32_bf16 v[196:199], a[236:239], v[60:63], v[196:199]
  v_exp_f32 v80, v80
  v_mfma_f32_16x16x32_bf16 v[192:195], a[236:239], v[56:59], v[192:195]
  ds_read_b64_tr_b16 a[246:247], v7 offset:34816
  v_mul_f32 v81, s30, v81
  v_mfma_f32_16x16x32_bf16 v[188:191], a[236:239], v[52:55], v[188:191]
  v_add_f32 v17, v17, v80
  v_mfma_f32_16x16x32_bf16 v[184:187], a[236:239], v[48:51], v[184:187]
  s_waitcnt lgkmcnt(2)
  v_exp_f32 v81, v81
  v_mfma_f32_16x16x32_bf16 v[208:211], a[240:243], v[48:51], v[208:211]
  v_mul_f32 v82, s30, v82
  v_mul_f32 v83, s30, v83
  v_mfma_f32_16x16x32_bf16 v[212:215], a[240:243], v[52:55], v[212:215]
  v_add_f32 v17, v17, v81
  v_cvt_pk_bf16_f32 v34, v80, v81
  v_mfma_f32_16x16x32_bf16 v[216:219], a[240:243], v[56:59], v[216:219]
  s_waitcnt vmcnt(19) lgkmcnt(0)
  v_exp_f32 v82, v82
  v_mfma_f32_16x16x32_bf16 v[220:223], a[240:243], v[60:63], v[220:223]
  s_barrier
  v_mfma_f32_16x16x32_bf16 v[224:227], a[240:243], v[64:67], v[224:227]
  ds_read_b128 a[236:239], v0 offset:36864
  v_add_f32 v17, v17, v82
  v_mfma_f32_16x16x32_bf16 v[228:231], a[240:243], v[68:71], v[228:231]
  v_exp_f32 v83, v83
  v_mfma_f32_16x16x32_bf16 v[252:255], a[244:247], v[68:71], v[252:255]
  ds_read_b128 a[248:251], v2 offset:0
  v_mul_f32 v36, s30, v36
  v_mfma_f32_16x16x32_bf16 v[248:251], a[244:247], v[64:67], v[248:251]
  v_add_f32 v17, v17, v83
  v_cvt_pk_bf16_f32 v35, v82, v83
  v_mfma_f32_16x16x32_bf16 v[244:247], a[244:247], v[60:63], v[244:247]
  v_exp_f32 v36, v36
  v_mfma_f32_16x16x32_bf16 v[240:243], a[244:247], v[56:59], v[240:243]
  ds_read_b128 a[252:255], v2 offset:2048
  v_mul_f32 v37, s30, v37
  v_mfma_f32_16x16x32_bf16 v[236:239], a[244:247], v[52:55], v[236:239]
  ds_read_b128 a[240:243], v0 offset:38912
  v_add_f32 v18, v18, v36
  v_mfma_f32_16x16x32_bf16 v[232:235], a[244:247], v[48:51], v[232:235]
  s_waitcnt lgkmcnt(3)
  v_exp_f32 v37, v37
  v_mfma_f32_16x16x32_bf16 v[48:51], a[236:239], a[140:143], v[10:13]
  ds_read_b128 a[244:247], v1 offset:36864
  v_mul_f32 v38, s30, v38
  v_mfma_f32_16x16x32_bf16 v[52:55], a[236:239], a[164:167], v[10:13]
  v_add_f32 v18, v18, v37
  v_cvt_pk_bf16_f32 v36, v36, v37
  v_mfma_f32_16x16x32_bf16 v[56:59], a[236:239], a[188:191], v[10:13]
  s_add_u32 s35, s28, 9216
  s_add_u32 m0, s25, 73728
  v_exp_f32 v38, v38
  s_waitcnt vmcnt(9)
  s_cbranch_vccnz L_aw3
L_ar3:
  v_mfma_f32_16x16x32_bf16 v[60:63], a[236:239], a[212:215], v[10:13]
  buffer_load_dwordx4 v8, s[8:11], s35 offen offset:0 nt lds
  s_waitcnt lgkmcnt(2)
  s_add_u32 m0, s25, 77696
  v_mul_f32 v39, s30, v39
  s_waitcnt vmcnt(9)
  s_cbranch_vccnz L_aw4
L_ar4:
  v_mfma_f32_16x16x32_bf16 v[64:67], a[236:239], a[248:251], v[10:13]
  buffer_load_dwordx4 v8, s[8:11], s35 offen offset:128 nt lds
  v_add_f32 v18, v18, v38
  v_mfma_f32_16x16x32_bf16 v[68:71], a[236:239], a[252:255], v[10:13]
  s_waitcnt lgkmcnt(1)
  v_exp_f32 v39, v39
  v_mfma_f32_16x16x32_bf16 v[104:107], a[240:243], a[252:255], v[10:13]
  ds_read_b128 a[252:255], v3 offset:2048
  v_mul_f32 v84, s30, v84
  v_mfma_f32_16x16x32_bf16 v[100:103], a[240:243], a[248:251], v[10:13]
  v_add_f32 v18, v18, v39
  v_cvt_pk_bf16_f32 v37, v38, v39
  v_mfma_f32_16x16x32_bf16 v[96:99], a[240:243], a[212:215], v[10:13]
  v_exp_f32 v84, v84
  v_mfma_f32_16x16x32_bf16 v[80:83], a[240:243], a[188:191], v[10:13]
  ds_read_b128 a[248:251], v3 offset:0
  v_mul_f32 v85, s30, v85
  v_mfma_f32_16x16x32_bf16 v[76:79], a[240:243], a[164:167], v[10:13]
  ds_read_b128 a[236:239], v1 offset:38912
  v_add_f32 v18, v18, v84
  v_mfma_f32_16x16x32_bf16 v[72:75], a[240:243], a[140:143], v[10:13]
  s_waitcnt lgkmcnt(3)
  v_exp_f32 v85, v85
  v_mfma_f32_16x16x32_bf16 v[48:51], a[244:247], a[144:147], v[48:51]
  ds_read_b128 a[240:243], v0 offset:40960
  v_mul_f32 v86, s30, v86
  v_mfma_f32_16x16x32_bf16 v[52:55], a[244:247], a[168:171], v[52:55]
  v_add_f32 v18, v18, v85
  v_cvt_pk_bf16_f32 v38, v84, v85
  v_mfma_f32_16x16x32_bf16 v[56:59], a[244:247], a[192:195], v[56:59]
  s_add_u32 m0, s25, 81664
  v_exp_f32 v86, v86
  s_waitcnt vmcnt(9)
  s_cbranch_vccnz L_aw5
L_ar5:
  v_mfma_f32_16x16x32_bf16 v[60:63], a[244:247], a[216:219], v[60:63]
  buffer_load_dwordx4 v8, s[8:11], s35 offen offset:256 nt lds
  s_waitcnt lgkmcnt(2)
  v_mul_f32 v87, s30, v87
  v_mfma_f32_16x16x32_bf16 v[64:67], a[244:247], a[248:251], v[64:67]
  v_add_f32 v18, v18, v86
  v_mfma_f32_16x16x32_bf16 v[68:71], a[244:247], a[252:255], v[68:71]
  s_waitcnt lgkmcnt(1)
  v_exp_f32 v87, v87
  v_mfma_f32_16x16x32_bf16 v[104:107], a[236:239], a[252:255], v[104:107]
  ds_read_b128 a[252:255], v2 offset:6144
  v_mul_f32 v40, s30, v40
  v_mfma_f32_16x16x32_bf16 v[100:103], a[236:239], a[248:251], v[100:103]
  v_add_f32 v18, v18, v87
  v_cvt_pk_bf16_f32 v39, v86, v87
  v_mfma_f32_16x16x32_bf16 v[96:99], a[236:239], a[216:219], v[96:99]
  v_exp_f32 v40, v40
  v_mfma_f32_16x16x32_bf16 v[80:83], a[236:239], a[192:195], v[80:83]
  ds_read_b128 a[248:251], v2 offset:4096
  v_mul_f32 v41, s30, v41
  v_mfma_f32_16x16x32_bf16 v[76:79], a[236:239], a[168:171], v[76:79]
  ds_read_b128 a[244:247], v0 offset:43008
  v_add_f32 v19, v19, v40
  v_mfma_f32_16x16x32_bf16 v[72:75], a[236:239], a[144:147], v[72:75]
  s_waitcnt lgkmcnt(3)
  v_exp_f32 v41, v41
  v_mfma_f32_16x16x32_bf16 v[48:51], a[240:243], a[148:151], v[48:51]
  ds_read_b128 a[236:239], v1 offset:40960
  v_mul_f32 v42, s30, v42
  v_mfma_f32_16x16x32_bf16 v[52:55], a[240:243], a[172:175], v[52:55]
  v_add_f32 v19, v19, v41
  v_cvt_pk_bf16_f32 v40, v40, v41
  v_mfma_f32_16x16x32_bf16 v[56:59], a[240:243], a[196:199], v[56:59]
  v_exp_f32 v42, v42
  v_mfma_f32_16x16x32_bf16 v[60:63], a[240:243], a[220:223], v[60:63]
  s_waitcnt lgkmcnt(2)
  v_mul_f32 v43, s30, v43
  v_mfma_f32_16x16x32_bf16 v[64:67], a[240:243], a[248:251], v[64:67]
  v_add_f32 v19, v19, v42
  v_mfma_f32_16x16x32_bf16 v[68:71], a[240:243], a[252:255], v[68:71]
  s_waitcnt lgkmcnt(1)
  v_exp_f32 v43, v43
  v_mfma_f32_16x16x32_bf16 v[104:107], a[244:247], a[252:255], v[104:107]
  ds_read_b128 a[252:255], v3 offset:6144
  v_mul_f32 v88, s30, v88
  v_mfma_f32_16x16x32_bf16 v[100:103], a[244:247], a[248:251], v[100:103]
  s_add_u32 s35, s28, 24576
  s_add_u32 m0, s36, 0
  v_add_f32 v19, v19, v43
  v_cvt_pk_bf16_f32 v41, v42, v43
  s_waitcnt vmcnt(9)
  s_cbranch_vccnz L_aw6
L_ar6:
  v_mfma_f32_16x16x32_bf16 v[96:99], a[244:247], a[220:223], v[96:99]
  buffer_load_dwordx4 v8, s[8:11], s35 offen offset:0 nt lds
  v_exp_f32 v88, v88
  v_mfma_f32_16x16x32_bf16 v[80:83], a[244:247], a[196:199], v[80:83]
  ds_read_b128 a[248:251], v3 offset:4096
  v_mul_f32 v89, s30, v89
  v_mfma_f32_16x16x32_bf16 v[76:79], a[244:247], a[172:175], v[76:79]
  ds_read_b128 a[240:243], v1 offset:43008
  v_add_f32 v19, v19, v88
  v_mfma_f32_16x16x32_bf16 v[72:75], a[244:247], a[148:151], v[72:75]
  s_waitcnt lgkmcnt(3)
  v_exp_f32 v89, v89
  v_mfma_f32_16x16x32_bf16 v[48:51], a[236:239], a[152:155], v[48:51]
  ds_read_b128 a[244:247], v0 offset:45056
  v_mul_f32 v90, s30, v90
  v_mfma_f32_16x16x32_bf16 v[52:55], a[236:239], a[176:179], v[52:55]
  v_add_f32 v19, v19, v89
  v_cvt_pk_bf16_f32 v42, v88, v89
  v_mfma_f32_16x16x32_bf16 v[56:59], a[236:239], a[200:203], v[56:59]
  s_add_u32 s35, s28, 27648
  s_add_u32 m0, s36, 1024
  v_exp_f32 v90, v90
  s_waitcnt vmcnt(9)
  s_cbranch_vccnz L_aw7
L_ar7:
  v_mfma_f32_16x16x32_bf16 v[60:63], a[236:239], a[224:227], v[60:63]
  buffer_load_dwordx4 v23, s[8:11], s35 offen offset:0 nt lds
  s_waitcnt lgkmcnt(2)
  s_add_u32 s35, s28, 30720
  s_add_u32 m0, s36, 2048
  v_mul_f32 v91, s30, v91
  s_waitcnt vmcnt(9)
  s_cbranch_vccnz L_aw8
L_ar8:
  v_mfma_f32_16x16x32_bf16 v[64:67], a[236:239], a[248:251], v[64:67]
  buffer_load_dwordx4 v8, s[8:11], s35 offen offset:0 nt lds
  v_add_f32 v19, v19, v90
  v_mfma_f32_16x16x32_bf16 v[68:71], a[236:239], a[252:255], v[68:71]
  s_waitcnt lgkmcnt(1)
  v_exp_f32 v91, v91
  v_mfma_f32_16x16x32_bf16 v[104:107], a[240:243], a[252:255], v[104:107]
  ds_read_b128 a[252:255], v2 offset:10240
  v_mul_f32 v44, s30, v44
  v_mfma_f32_16x16x32_bf16 v[100:103], a[240:243], a[248:251], v[100:103]
  s_add_u32 s35, s28, 33792
  s_add_u32 m0, s36, 3072
  v_add_f32 v19, v19, v91
  v_cvt_pk_bf16_f32 v43, v90, v91
  s_waitcnt vmcnt(9)
  s_cbranch_vccnz L_aw9
L_ar9:
  v_mfma_f32_16x16x32_bf16 v[96:99], a[240:243], a[224:227], v[96:99]
  buffer_load_dwordx4 v23, s[8:11], s35 offen offset:0 nt lds
  v_exp_f32 v44, v44
  v_mfma_f32_16x16x32_bf16 v[80:83], a[240:243], a[200:203], v[80:83]
  ds_read_b128 a[248:251], v2 offset:8192
  v_mul_f32 v45, s30, v45
  v_mfma_f32_16x16x32_bf16 v[76:79], a[240:243], a[176:179], v[76:79]
  ds_read_b128 a[236:239], v0 offset:47104
  v_add_f32 v20, v20, v44
  v_mfma_f32_16x16x32_bf16 v[72:75], a[240:243], a[152:155], v[72:75]
  s_waitcnt lgkmcnt(3)
  v_exp_f32 v45, v45
  v_mfma_f32_16x16x32_bf16 v[48:51], a[244:247], a[156:159], v[48:51]
  ds_read_b128 a[240:243], v1 offset:45056
  v_mul_f32 v46, s30, v46
  v_mfma_f32_16x16x32_bf16 v[52:55], a[244:247], a[180:183], v[52:55]
  v_add_f32 v20, v20, v45
  v_cvt_pk_bf16_f32 v44, v44, v45
  v_mfma_f32_16x16x32_bf16 v[56:59], a[244:247], a[204:207], v[56:59]
  s_add_u32 s35, s28, 24576
  s_add_u32 m0, s36, 3968
  v_exp_f32 v46, v46
  s_waitcnt vmcnt(9)
  s_cbranch_vccnz L_aw10
L_ar10:
  v_mfma_f32_16x16x32_bf16 v[60:63], a[244:247], a[228:231], v[60:63]
  buffer_load_dwordx4 v8, s[8:11], s35 offen offset:128 nt lds
  s_waitcnt lgkmcnt(2)
  s_add_u32 s35, s28, 27648
  s_add_u32 m0, s36, 4992
  v_mul_f32 v47, s30, v47
  s_waitcnt vmcnt(9)
  s_cbranch_vccnz L_aw11
L_ar11:
  v_mfma_f32_16x16x32_bf16 v[64:67], a[244:247], a[248:251], v[64:67]
  buffer_load_dwordx4 v23, s[8:11], s35 offen offset:128 nt lds
  v_add_f32 v20, v20, v46
  v_mfma_f32_16x16x32_bf16 v[68:71], a[244:247], a[252:255], v[68:71]
  s_waitcnt lgkmcnt(1)
  v_exp_f32 v47, v47
  v_mfma_f32_16x16x32_bf16 v[104:107], a[236:239], a[252:255], v[104:107]
  ds_read_b128 a[252:255], v3 offset:10240
  v_mul_f32 v92, s30, v92
  v_mfma_f32_16x16x32_bf16 v[100:103], a[236:239], a[248:251], v[100:103]
  s_add_u32 s35, s28, 30720
  s_add_u32 m0, s36, 6016
  v_add_f32 v20, v20, v47
  v_cvt_pk_bf16_f32 v45, v46, v47
  s_waitcnt vmcnt(9)
  s_cbranch_vccnz L_aw12
L_ar12:
  v_mfma_f32_16x16x32_bf16 v[96:99], a[236:239], a[228:231], v[96:99]
  buffer_load_dwordx4 v8, s[8:11], s35 offen offset:128 nt lds
  v_exp_f32 v92, v92
  v_mfma_f32_16x16x32_bf16 v[80:83], a[236:239], a[204:207], v[80:83]
  ds_read_b128 a[248:251], v3 offset:8192
  v_mul_f32 v93, s30, v93
  v_mfma_f32_16x16x32_bf16 v[76:79], a[236:239], a[180:183], v[76:79]
  ds_read_b128 a[244:247], v1 offset:47104
  v_add_f32 v20, v20, v92
  v_mfma_f32_16x16x32_bf16 v[72:75], a[236:239], a[156:159], v[72:75]
  s_waitcnt lgkmcnt(3)
  v_exp_f32 v93, v93
  v_mfma_f32_16x16x32_bf16 v[48:51], a[240:243], a[160:163], v[48:51]
  ds_read_b64_tr_b16 a[236:237], v4 offset:36864
  v_mul_f32 v94, s30, v94
  v_mfma_f32_16x16x32_bf16 v[52:55], a[240:243], a[184:187], v[52:55]
  v_add_f32 v20, v20, v93
  v_cvt_pk_bf16_f32 v46, v92, v93
  v_mfma_f32_16x16x32_bf16 v[56:59], a[240:243], a[208:211], v[56:59]
  v_exp_f32 v94, v94
  v_mfma_f32_16x16x32_bf16 v[60:63], a[240:243], a[232:235], v[60:63]
  ds_read_b64_tr_b16 a[238:239], v4 offset:38912
  s_waitcnt lgkmcnt(3)
  s_add_u32 s35, s28, 33792
  s_add_u32 m0, s36, 7040
  v_mul_f32 v95, s30, v95
  s_waitcnt vmcnt(9)
  s_cbranch_vccnz L_aw13
L_ar13:
  v_mfma_f32_16x16x32_bf16 v[64:67], a[240:243], a[248:251], v[64:67]
  buffer_load_dwordx4 v23, s[8:11], s35 offen offset:128 nt lds
  v_add_f32 v20, v20, v94
  v_mfma_f32_16x16x32_bf16 v[68:71], a[240:243], a[252:255], v[68:71]
  s_waitcnt lgkmcnt(2)
  v_exp_f32 v95, v95
  v_mfma_f32_16x16x32_bf16 v[104:107], a[244:247], a[252:255], v[104:107]
  ds_read_b64_tr_b16 a[240:241], v5 offset:36864
  v_mul_f32 v48, s30, v48
  v_mfma_f32_16x16x32_bf16 v[100:103], a[244:247], a[248:251], v[100:103]
  v_add_f32 v20, v20, v95
  v_cvt_pk_bf16_f32 v47, v94, v95
  v_mfma_f32_16x16x32_bf16 v[96:99], a[244:247], a[232:235], v[96:99]
  v_exp_f32 v48, v48
  v_mfma_f32_16x16x32_bf16 v[80:83], a[244:247], a[208:211], v[80:83]
  ds_read_b64_tr_b16 a[242:243], v5 offset:38912
  v_mul_f32 v49, s30, v49
  v_mfma_f32_16x16x32_bf16 v[76:79], a[244:247], a[184:187], v[76:79]
  v_add_f32 v15, v15, v48
  v_mfma_f32_16x16x32_bf16 v[72:75], a[244:247], a[160:163], v[72:75]
  s_waitcnt lgkmcnt(2)
  v_exp_f32 v49, v49
  v_mfma_f32_16x16x32_bf16 a[0:3], a[236:239], v[24:27], a[0:3]
  ds_read_b64_tr_b16 a[244:245], v6 offset:36864
  s_add_u32 s35, s28, 24576
  s_add_u32 m0, s36, 7936
  v_mul_f32 v50, s30, v50
  v_mbcnt_lo_u32_b32 v86, -1, 0
  s_waitcnt vmcnt(9)
  s_cbranch_vccnz L_aw14
L_ar14:
  v_mfma_f32_16x16x32_bf16 a[4:7], a[236:239], v[28:31], a[4:7]
  buffer_load_dwordx4 v8, s[8:11], s35 offen offset:256 nt lds
  s_add_u32 s35, s28, 27648
  s_add_u32 m0, s36, 8960
  v_add_f32 v15, v15, v49
  v_cvt_pk_bf16_f32 v48, v48, v49
  s_waitcnt vmcnt(9)
  s_cbranch_vccnz L_aw15
L_ar15:
  v_mfma_f32_16x16x32_bf16 a[8:11], a[236:239], v[32:35], a[8:11]
  buffer_load_dwordx4 v23, s[8:11], s35 offen offset:256 nt lds
  v_exp_f32 v50, v50
  v_mfma_f32_16x16x32_bf16 a[12:15], a[236:239], v[36:39], a[12:15]
  ds_read_b64_tr_b16 a[246:247], v6 offset:38912
  s_add_u32 s35, s28, 30720
  s_add_u32 m0, s36, 9984
  v_mul_f32 v51, s30, v51
  v_mbcnt_hi_u32_b32 v86, -1, v86
  s_waitcnt vmcnt(9)
  s_cbranch_vccnz L_aw16
L_ar16:
  v_mfma_f32_16x16x32_bf16 a[16:19], a[236:239], v[40:43], a[16:19]
  buffer_load_dwordx4 v8, s[8:11], s35 offen offset:256 nt lds
  s_add_u32 s35, s28, 33792
  s_add_u32 m0, s36, 11008
  v_add_f32 v15, v15, v50
  v_bfe_u32 v86, v86, 3, 1
  s_waitcnt vmcnt(9)
  s_cbranch_vccnz L_aw17
L_ar17:
  v_mfma_f32_16x16x32_bf16 a[20:23], a[236:239], v[44:47], a[20:23]
  buffer_load_dwordx4 v23, s[8:11], s35 offen offset:256 nt lds
  s_waitcnt lgkmcnt(2)
  v_exp_f32 v51, v51
  v_mfma_f32_16x16x32_bf16 a[44:47], a[240:243], v[44:47], a[44:47]
  ds_read_b64_tr_b16 a[236:237], v7 offset:36864
  s_waitcnt vmcnt(18)
  v_mul_f32 v72, s30, v72
  v_mul_u32_u24 v86, 45056, v86
  v_mfma_f32_16x16x32_bf16 a[40:43], a[240:243], v[40:43], a[40:43]
  ds_read_b128 a[140:143], v21 offset:12288
  v_add_f32 v15, v15, v51
  v_cvt_pk_bf16_f32 v49, v50, v51
  v_mfma_f32_16x16x32_bf16 a[36:39], a[240:243], v[36:39], a[36:39]
  ds_read_b128 a[144:147], v22 offset:12288
  v_exp_f32 v72, v72
  v_mfma_f32_16x16x32_bf16 a[32:35], a[240:243], v[32:35], a[32:35]
  ds_read_b64_tr_b16 a[238:239], v7 offset:38912
  v_mul_f32 v73, s30, v73
  v_sub_u32 v86, v21, v86
  v_mfma_f32_16x16x32_bf16 a[28:31], a[240:243], v[28:31], a[28:31]
  ds_read_b128 a[148:151], v21 offset:16384
  v_add_f32 v15, v15, v72
  v_add_u32 v84, 147456, v86
  v_mfma_f32_16x16x32_bf16 a[24:27], a[240:243], v[24:27], a[24:27]
  ds_read_b128 a[152:155], v22 offset:16384
  s_waitcnt lgkmcnt(6)
  v_exp_f32 v73, v73
  v_mfma_f32_16x16x32_bf16 a[48:51], a[244:247], v[24:27], a[48:51]
  ds_read_b64_tr_b16 a[240:241], v4 offset:40960
  v_mul_f32 v74, s30, v74
  v_xor_b32 v85, 64, v84
  v_mfma_f32_16x16x32_bf16 a[52:55], a[244:247], v[28:31], a[52:55]
  ds_read_b128 a[156:159], v21 offset:20480
  v_add_f32 v15, v15, v73
  v_cvt_pk_bf16_f32 v50, v72, v73
  v_mfma_f32_16x16x32_bf16 a[56:59], a[244:247], v[32:35], a[56:59]
  ds_read_b128 a[160:163], v22 offset:20480
  v_exp_f32 v74, v74
  v_mfma_f32_16x16x32_bf16 a[60:63], a[244:247], v[36:39], a[60:63]
  ds_read_b64_tr_b16 a[242:243], v4 offset:43008
  v_mul_f32 v75, s30, v75
  v_mfma_f32_16x16x32_bf16 a[64:67], a[244:247], v[40:43], a[64:67]
  ds_read_b128 a[188:191], v84 offset:0
  v_add_f32 v15, v15, v74
  v_mfma_f32_16x16x32_bf16 a[68:71], a[244:247], v[44:47], a[68:71]
  ds_read_b128 a[192:195], v85 offset:0
  s_waitcnt lgkmcnt(8)
  v_exp_f32 v75, v75
  v_mfma_f32_16x16x32_bf16 a[92:95], a[236:239], v[44:47], a[92:95]
  ds_read_b64_tr_b16 a[244:245], v5 offset:40960
  v_mul_f32 v52, s30, v52
  v_mfma_f32_16x16x32_bf16 a[88:91], a[236:239], v[40:43], a[88:91]
  ds_read_b128 a[196:199], v84 offset:8192
  v_add_f32 v15, v15, v75
  v_cvt_pk_bf16_f32 v51, v74, v75
  v_mfma_f32_16x16x32_bf16 a[84:87], a[236:239], v[36:39], a[84:87]
  ds_read_b128 a[200:203], v85 offset:8192
  v_exp_f32 v52, v52
  v_mfma_f32_16x16x32_bf16 a[80:83], a[236:239], v[32:35], a[80:83]
  ds_read_b64_tr_b16 a[246:247], v5 offset:43008
  v_mul_f32 v53, s30, v53
  v_mfma_f32_16x16x32_bf16 a[76:79], a[236:239], v[28:31], a[76:79]
  v_add_f32 v16, v16, v52
  v_subrev_u32 v84, 86016, v84
  v_mfma_f32_16x16x32_bf16 a[72:75], a[236:239], v[24:27], a[72:75]
  s_waitcnt lgkmcnt(4)
  v_exp_f32 v53, v53
  v_mfma_f32_16x16x32_bf16 a[96:99], a[240:243], v[24:27], a[96:99]
  ds_read_b64_tr_b16 a[236:237], v6 offset:40960
  s_add_u32 s35, s28, 12288
  s_add_u32 m0, s25, 61184
  v_mul_f32 v54, s30, v54
  s_waitcnt vmcnt(9)
  s_cbranch_vccnz L_aw18
L_ar18:
  v_mfma_f32_16x16x32_bf16 a[100:103], a[240:243], v[28:31], a[100:103]
  buffer_load_dwordx4 v8, s[8:11], s35 offen offset:256 nt lds
  v_add_f32 v16, v16, v53
  v_cvt_pk_bf16_f32 v52, v52, v53
  v_mfma_f32_16x16x32_bf16 a[104:107], a[240:243], v[32:35], a[104:107]
  v_exp_f32 v54, v54
  v_mfma_f32_16x16x32_bf16 a[108:111], a[240:243], v[36:39], a[108:111]
  ds_read_b64_tr_b16 a[238:239], v6 offset:43008
  s_add_u32 s35, s28, 15360
  s_add_u32 m0, s25, 65280
  v_mul_f32 v55, s30, v55
  s_waitcnt vmcnt(9)
  s_cbranch_vccnz L_aw19
L_ar19:
  v_mfma_f32_16x16x32_bf16 a[112:115], a[240:243], v[40:43], a[112:115]
  buffer_load_dwordx4 v8, s[8:11], s35 offen offset:256 nt lds
  v_add_f32 v16, v16, v54
  v_xor_b32 v85, 64, v84
  v_mfma_f32_16x16x32_bf16 a[116:119], a[240:243], v[44:47], a[116:119]
  s_waitcnt lgkmcnt(2)
  v_exp_f32 v55, v55
  v_mfma_f32_16x16x32_bf16 v[108:111], a[244:247], v[44:47], v[108:111]
  ds_read_b64_tr_b16 a[240:241], v7 offset:40960
  s_add_u32 m0, s25, 12288
  v_mul_f32 v76, s30, v76
  s_waitcnt vmcnt(9)
  s_cbranch_vccnz L_aw20
L_ar20:
  v_mfma_f32_16x16x32_bf16 a[136:139], a[244:247], v[40:43], a[136:139]
  buffer_load_dwordx4 v8, s[12:15], s26 offen offset:0 nt lds
  v_add_f32 v16, v16, v55
  v_cvt_pk_bf16_f32 v53, v54, v55
  v_mfma_f32_16x16x32_bf16 a[132:135], a[244:247], v[36:39], a[132:135]
  v_exp_f32 v76, v76
  v_mfma_f32_16x16x32_bf16 a[128:131], a[244:247], v[32:35], a[128:131]
  ds_read_b64_tr_b16 a[242:243], v7 offset:43008
  s_add_u32 m0, s25, 16256
  v_mul_f32 v77, s30, v77
  s_waitcnt vmcnt(9)
  s_cbranch_vccnz L_aw21
L_ar21:
  v_mfma_f32_16x16x32_bf16 a[124:127], a[244:247], v[28:31], a[124:127]
  buffer_load_dwordx4 v8, s[12:15], s26 offen offset:128 nt lds
  v_add_f32 v16, v16, v76
  v_mfma_f32_16x16x32_bf16 a[120:123], a[244:247], v[24:27], a[120:123]
  s_waitcnt lgkmcnt(2)
  v_exp_f32 v77, v77
  v_mfma_f32_16x16x32_bf16 v[112:115], a[236:239], v[24:27], v[112:115]
  ds_read_b64_tr_b16 a[244:245], v4 offset:45056
  v_mul_f32 v78, s30, v78
  v_mfma_f32_16x16x32_bf16 v[116:119], a[236:239], v[28:31], v[116:119]
  v_add_f32 v16, v16, v77
  v_cvt_pk_bf16_f32 v54, v76, v77
  v_mfma_f32_16x16x32_bf16 v[120:123], a[236:239], v[32:35], v[120:123]
  v_exp_f32 v78, v78
  v_mfma_f32_16x16x32_bf16 v[124:127], a[236:239], v[36:39], v[124:127]
  ds_read_b64_tr_b16 a[246:247], v4 offset:47104
  s_add_u32 m0, s25, 20224
  v_mul_f32 v79, s30, v79
  s_waitcnt vmcnt(9)
  s_cbranch_vccnz L_aw22
L_ar22:
  v_mfma_f32_16x16x32_bf16 v[128:131], a[236:239], v[40:43], v[128:131]
  buffer_load_dwordx4 v8, s[12:15], s26 offen offset:256 nt lds
  v_add_f32 v16, v16, v78
  v_mfma_f32_16x16x32_bf16 v[132:135], a[236:239], v[44:47], v[132:135]
  s_waitcnt lgkmcnt(2)
  v_exp_f32 v79, v79
  v_mfma_f32_16x16x32_bf16 v[156:159], a[240:243], v[44:47], v[156:159]
  ds_read_b64_tr_b16 a[236:237], v5 offset:45056
  v_mul_f32 v56, s30, v56
  v_mfma_f32_16x16x32_bf16 v[152:155], a[240:243], v[40:43], v[152:155]
  v_add_f32 v16, v16, v79
  v_cvt_pk_bf16_f32 v55, v78, v79
  v_mfma_f32_16x16x32_bf16 v[148:151], a[240:243], v[36:39], v[148:151]
  s_mov_b32 s27, s34
  v_exp_f32 v56, v56
  v_mfma_f32_16x16x32_bf16 v[144:147], a[240:243], v[32:35], v[144:147]
  ds_read_b64_tr_b16 a[238:239], v5 offset:47104
  s_add_u32 s26, s26, 12288
  v_mul_f32 v57, s30, v57
  v_mfma_f32_16x16x32_bf16 v[140:143], a[240:243], v[28:31], v[140:143]
  s_cmp_eq_u32 s26, s57
  v_add_f32 v17, v17, v56
  v_mfma_f32_16x16x32_bf16 v[136:139], a[240:243], v[24:27], v[136:139]
  s_cselect_b32 s26, s56, s26
  s_waitcnt lgkmcnt(2)
  v_exp_f32 v57, v57
  v_mfma_f32_16x16x32_bf16 v[160:163], a[244:247], v[24:27], v[160:163]
  ds_read_b64_tr_b16 a[240:241], v6 offset:45056
  v_mul_f32 v58, s30, v58
  v_mfma_f32_16x16x32_bf16 v[164:167], a[244:247], v[28:31], v[164:167]
  s_mov_b32 s58, s56
  v_add_f32 v17, v17, v57
  v_cvt_pk_bf16_f32 v56, v56, v57
  v_mfma_f32_16x16x32_bf16 v[168:171], a[244:247], v[32:35], v[168:171]
  s_mov_b32 s59, s57
  v_exp_f32 v58, v58
  v_mfma_f32_16x16x32_bf16 v[172:175], a[244:247], v[36:39], v[172:175]
  ds_read_b64_tr_b16 a[242:243], v6 offset:47104
  v_mul_f32 v59, s30, v59
  v_mfma_f32_16x16x32_bf16 v[176:179], a[244:247], v[40:43], v[176:179]
  v_add_f32 v17, v17, v58
  v_mfma_f32_16x16x32_bf16 v[180:183], a[244:247], v[44:47], v[180:183]
  s_waitcnt lgkmcnt(2)
  v_exp_f32 v59, v59
  v_mfma_f32_16x16x32_bf16 v[204:207], a[236:239], v[44:47], v[204:207]
  ds_read_b64_tr_b16 a[244:245], v7 offset:45056
  v_mul_f32 v80, s30, v80
  v_mfma_f32_16x16x32_bf16 v[200:203], a[236:239], v[40:43], v[200:203]
  v_add_f32 v17, v17, v59
  v_cvt_pk_bf16_f32 v57, v58, v59
  v_mfma_f32_16x16x32_bf16 v[196:199], a[236:239], v[36:39], v[196:199]
  v_exp_f32 v80, v80
  v_mfma_f32_16x16x32_bf16 v[192:195], a[236:239], v[32:35], v[192:195]
  ds_read_b64_tr_b16 a[246:247], v7 offset:47104
  v_mul_f32 v81, s30, v81
  v_mfma_f32_16x16x32_bf16 v[188:191], a[236:239], v[28:31], v[188:191]
  v_add_f32 v17, v17, v80
  v_mfma_f32_16x16x32_bf16 v[184:187], a[236:239], v[24:27], v[184:187]
  s_waitcnt lgkmcnt(2)
  v_exp_f32 v81, v81
  v_mfma_f32_16x16x32_bf16 v[208:211], a[240:243], v[24:27], v[208:211]
  v_mul_f32 v82, s30, v82
  v_mul_f32 v83, s30, v83
  v_mfma_f32_16x16x32_bf16 v[212:215], a[240:243], v[28:31], v[212:215]
  v_add_f32 v17, v17, v81
  v_cvt_pk_bf16_f32 v58, v80, v81
  v_mfma_f32_16x16x32_bf16 v[216:219], a[240:243], v[32:35], v[216:219]
  s_waitcnt vmcnt(33) lgkmcnt(0)
  v_exp_f32 v82, v82
  v_mfma_f32_16x16x32_bf16 v[220:223], a[240:243], v[36:39], v[220:223]
  s_barrier
  v_mfma_f32_16x16x32_bf16 v[224:227], a[240:243], v[40:43], v[224:227]
  ds_read_b64_tr_b16 a[236:237], v4 offset:0
  v_add_f32 v17, v17, v82
  v_mfma_f32_16x16x32_bf16 v[228:231], a[240:243], v[44:47], v[228:231]
  v_exp_f32 v83, v83
  v_mfma_f32_16x16x32_bf16 v[252:255], a[244:247], v[44:47], v[252:255]
  ds_read_b64_tr_b16 a[238:239], v4 offset:2048
  v_mul_f32 v60, s30, v60
  v_mfma_f32_16x16x32_bf16 v[248:251], a[244:247], v[40:43], v[248:251]
  v_add_f32 v17, v17, v83
  v_cvt_pk_bf16_f32 v59, v82, v83
  v_mfma_f32_16x16x32_bf16 v[244:247], a[244:247], v[36:39], v[244:247]
  v_exp_f32 v60, v60
  v_mfma_f32_16x16x32_bf16 v[240:243], a[244:247], v[32:35], v[240:243]
  ds_read_b64_tr_b16 a[240:241], v5 offset:0
  v_mul_f32 v61, s30, v61
  v_mfma_f32_16x16x32_bf16 v[236:239], a[244:247], v[28:31], v[236:239]
  ds_read_b64_tr_b16 a[242:243], v5 offset:2048
  v_add_f32 v18, v18, v60
  v_mfma_f32_16x16x32_bf16 v[232:235], a[244:247], v[24:27], v[232:235]
  v_exp_f32 v61, v61
  v_mul_f32 v62, s30, v62
  v_add_f32 v18, v18, v61
  v_cvt_pk_bf16_f32 v60, v60, v61
  v_exp_f32 v62, v62
  v_mul_f32 v63, s30, v63
  v_add_f32 v18, v18, v62
  v_exp_f32 v63, v63
  v_mul_f32 v96, s30, v96
  v_add_f32 v18, v18, v63
  v_cvt_pk_bf16_f32 v61, v62, v63
  v_exp_f32 v96, v96
  v_mul_f32 v97, s30, v97
  v_add_f32 v18, v18, v96
  v_exp_f32 v97, v97
  v_mul_f32 v98, s30, v98
  v_add_f32 v18, v18, v97
  v_cvt_pk_bf16_f32 v62, v96, v97
  v_exp_f32 v98, v98
  v_mul_f32 v99, s30, v99
  v_add_f32 v18, v18, v98
  v_exp_f32 v99, v99
  s_waitcnt vmcnt(17) lgkmcnt(0)
  ds_read_b128 a[164:167], v21 offset:24576
  ds_read_b128 a[168:171], v22 offset:24576
  ds_read_b128 a[172:175], v21 offset:28672
  ds_read_b128 a[176:179], v22 offset:28672
  ds_read_b128 a[180:183], v21 offset:32768
  ds_read_b128 a[184:187], v22 offset:32768
  v_mul_f32 v64, s30, v64
  v_add_f32 v18, v18, v99
  v_cvt_pk_bf16_f32 v63, v98, v99
  v_exp_f32 v64, v64
  v_mul_f32 v65, s30, v65
  v_add_f32 v19, v19, v64
  v_exp_f32 v65, v65
  v_mul_f32 v66, s30, v66
  v_add_f32 v19, v19, v65
  v_cvt_pk_bf16_f32 v64, v64, v65
  v_exp_f32 v66, v66
  v_mul_f32 v67, s30, v67
  v_add_f32 v19, v19, v66
  v_exp_f32 v67, v67
  v_mul_f32 v100, s30, v100
  v_add_f32 v19, v19, v67
  v_cvt_pk_bf16_f32 v65, v66, v67
  v_exp_f32 v100, v100
  v_mul_f32 v101, s30, v101
  v_add_f32 v19, v19, v100
  v_exp_f32 v101, v101
  s_waitcnt lgkmcnt(0)
  s_add_u32 s35, s28, 18432
  s_add_u32 m0, s25, 24576
  s_nop 0
  s_waitcnt vmcnt(9)
  s_cbranch_vccnz L_aw23
L_ar23:
  buffer_load_dwordx4 v8, s[8:11], s35 offen offset:0 nt lds
  s_add_u32 m0, s25, 28544
  s_nop 0
  s_waitcnt vmcnt(9)
  s_cbranch_vccnz L_aw24
L_ar24:
  buffer_load_dwordx4 v8, s[8:11], s35 offen offset:128 nt lds
  s_add_u32 m0, s25, 32512
  s_nop 0
  s_waitcnt vmcnt(9)
  s_cbranch_vccnz L_aw25
L_ar25:
  buffer_load_dwordx4 v8, s[8:11], s35 offen offset:256 nt lds
  s_add_u32 s35, s28, 21504
  s_add_u32 m0, s25, 73728
  s_nop 0
  s_waitcnt vmcnt(9)
  s_cbranch_vccnz L_aw26
L_ar26:
  buffer_load_dwordx4 v8, s[8:11], s35 offen offset:0 nt lds
  s_add_u32 m0, s25, 77696
  s_nop 0
  s_waitcnt vmcnt(9)
  s_cbranch_vccnz L_aw27
L_ar27:
  buffer_load_dwordx4 v8, s[8:11], s35 offen offset:128 nt lds
  s_add_u32 m0, s25, 81664
  s_nop 0
  s_waitcnt vmcnt(9)
  s_cbranch_vccnz L_aw28
L_ar28:
  buffer_load_dwordx4 v8, s[8:11], s35 offen offset:256 nt lds
  v_mul_f32 v102, s30, v102
  v_add_f32 v19, v19, v101
  v_cvt_pk_bf16_f32 v66, v100, v101
  v_exp_f32 v102, v102
  v_mul_f32 v103, s30, v103
  v_add_f32 v19, v19, v102
  v_exp_f32 v103, v103
  v_mul_f32 v68, s30, v68
  v_add_f32 v19, v19, v103
  v_cvt_pk_bf16_f32 v67, v102, v103
  v_exp_f32 v68, v68
  v_mul_f32 v69, s30, v69
  v_add_f32 v20, v20, v68
  v_exp_f32 v69, v69
  v_mul_f32 v70, s30, v70
  v_add_f32 v20, v20, v69
  v_cvt_pk_bf16_f32 v68, v68, v69
  v_exp_f32 v70, v70
  v_mul_f32 v71, s30, v71
  v_add_f32 v20, v20, v70
  v_exp_f32 v71, v71
  v_mul_f32 v104, s30, v104
  v_add_f32 v20, v20, v71
  v_cvt_pk_bf16_f32 v69, v70, v71
  v_exp_f32 v104, v104
  v_mul_f32 v105, s30, v105
  v_add_f32 v20, v20, v104
  v_exp_f32 v105, v105
  v_mul_f32 v106, s30, v106
  v_add_f32 v20, v20, v105
  v_cvt_pk_bf16_f32 v70, v104, v105
  v_exp_f32 v106, v106
  v_mul_f32 v107, s30, v107
  v_add_f32 v20, v20, v106
  v_exp_f32 v107, v107
  s_nop 0
  v_add_f32 v20, v20, v107
  v_cvt_pk_bf16_f32 v71, v106, v107
  v_mfma_f32_16x16x32_bf16 a[0:3], a[236:239], v[48:51], a[0:3]
  ds_read_b64_tr_b16 a[244:245], v6 offset:0
  v_mov_b32 v72, v15
  v_mfma_f32_16x16x32_bf16 a[4:7], a[236:239], v[52:55], a[4:7]
  s_mov_b32 s51, s29
  v_mov_b32 v73, v16
  v_mov_b32 v74, v17
  v_mfma_f32_16x16x32_bf16 a[8:11], a[236:239], v[56:59], a[8:11]
  v_mov_b32 v75, v18
  v_mov_b32 v76, v19
  v_mfma_f32_16x16x32_bf16 a[12:15], a[236:239], v[60:63], a[12:15]
  ds_read_b64_tr_b16 a[246:247], v6 offset:2048
  v_mov_b32 v77, v20
  v_mfma_f32_16x16x32_bf16 a[16:19], a[236:239], v[64:67], a[16:19]
  v_permlane32_swap_b32 v72, v15
  v_permlane32_swap_b32 v73, v16
  v_mfma_f32_16x16x32_bf16 a[20:23], a[236:239], v[68:71], a[20:23]
  v_permlane32_swap_b32 v74, v17
  v_permlane32_swap_b32 v75, v18
  v_mfma_f32_16x16x32_bf16 a[44:47], a[240:243], v[68:71], a[44:47]
  ds_read_b64_tr_b16 a[236:237], v7 offset:0
  v_permlane32_swap_b32 v76, v19
  v_mfma_f32_16x16x32_bf16 a[40:43], a[240:243], v[64:67], a[40:43]
  v_permlane32_swap_b32 v77, v20
  v_add_f32 v15, v15, v72
  v_mfma_f32_16x16x32_bf16 a[36:39], a[240:243], v[60:63], a[36:39]
  v_add_f32 v16, v16, v73
  v_add_f32 v17, v17, v74
  v_mfma_f32_16x16x32_bf16 a[32:35], a[240:243], v[56:59], a[32:35]
  ds_read_b64_tr_b16 a[238:239], v7 offset:2048
  v_add_f32 v18, v18, v75
  v_mfma_f32_16x16x32_bf16 a[28:31], a[240:243], v[52:55], a[28:31]
  v_add_f32 v19, v19, v76
  v_add_f32 v20, v20, v77
  v_mfma_f32_16x16x32_bf16 a[24:27], a[240:243], v[48:51], a[24:27]
  s_waitcnt lgkmcnt(2)
  v_mov_b32 v72, v15
  v_mov_b32 v73, v16
  v_mfma_f32_16x16x32_bf16 a[48:51], a[244:247], v[48:51], a[48:51]
  ds_read_b64_tr_b16 a[240:241], v4 offset:4096
  v_mov_b32 v74, v17
  v_mfma_f32_16x16x32_bf16 a[52:55], a[244:247], v[52:55], a[52:55]
  v_mov_b32 v75, v18
  v_mov_b32 v76, v19
  v_mfma_f32_16x16x32_bf16 a[56:59], a[244:247], v[56:59], a[56:59]
  v_mov_b32 v77, v20
  v_permlane16_swap_b32 v72, v15
  v_mfma_f32_16x16x32_bf16 a[60:63], a[244:247], v[60:63], a[60:63]
  ds_read_b64_tr_b16 a[242:243], v4 offset:6144
  v_permlane16_swap_b32 v73, v16
  v_mfma_f32_16x16x32_bf16 a[64:67], a[244:247], v[64:67], a[64:67]
  v_permlane16_swap_b32 v74, v17
  v_permlane16_swap_b32 v75, v18
  v_mfma_f32_16x16x32_bf16 a[68:71], a[244:247], v[68:71], a[68:71]
  s_waitcnt lgkmcnt(2)
  v_permlane16_swap_b32 v76, v19
  v_permlane16_swap_b32 v77, v20
  v_mfma_f32_16x16x32_bf16 a[92:95], a[236:239], v[68:71], a[92:95]
  ds_read_b64_tr_b16 a[244:245], v5 offset:4096
  v_add_f32 v15, v15, v72
  v_mfma_f32_16x16x32_bf16 a[88:91], a[236:239], v[64:67], a[88:91]
  v_add_f32 v16, v16, v73
  v_add_f32 v17, v17, v74
  v_mfma_f32_16x16x32_bf16 a[84:87], a[236:239], v[60:63], a[84:87]
  v_add_f32 v18, v18, v75
  v_add_f32 v19, v19, v76
  v_mfma_f32_16x16x32_bf16 a[80:83], a[236:239], v[56:59], a[80:83]
  ds_read_b64_tr_b16 a[246:247], v5 offset:6144
  v_add_f32 v20, v20, v77
  v_mfma_f32_16x16x32_bf16 a[76:79], a[236:239], v[52:55], a[76:79]
  v_rcp_f32 v96, v15
  v_mfma_f32_16x16x32_bf16 a[72:75], a[236:239], v[48:51], a[72:75]
  s_waitcnt lgkmcnt(2)
  v_rcp_f32 v97, v16
  v_mfma_f32_16x16x32_bf16 a[96:99], a[240:243], v[48:51], a[96:99]
  ds_read_b64_tr_b16 a[236:237], v6 offset:4096
  v_rcp_f32 v98, v17
  v_mfma_f32_16x16x32_bf16 a[100:103], a[240:243], v[52:55], a[100:103]
  v_rcp_f32 v99, v18
  v_mfma_f32_16x16x32_bf16 a[104:107], a[240:243], v[56:59], a[104:107]
  v_rcp_f32 v100, v19
  v_mfma_f32_16x16x32_bf16 a[108:111], a[240:243], v[60:63], a[108:111]
  ds_read_b64_tr_b16 a[238:239], v6 offset:6144
  v_rcp_f32 v101, v20
  v_mfma_f32_16x16x32_bf16 a[112:115], a[240:243], v[64:67], a[112:115]
  v_max3_f32 v72, v15, v16, v17
  v_max3_f32 v73, v18, v19, v20
  v_mfma_f32_16x16x32_bf16 a[116:119], a[240:243], v[68:71], a[116:119]
  s_waitcnt lgkmcnt(2)
  v_max_f32 v72, v72, v73
  v_max3_f32 v73, v96, v97, v98
  v_mfma_f32_16x16x32_bf16 v[108:111], a[244:247], v[68:71], v[108:111]
  ds_read_b64_tr_b16 a[240:241], v7 offset:4096
  v_max3_f32 v74, v99, v100, v101
  v_mfma_f32_16x16x32_bf16 a[136:139], a[244:247], v[64:67], a[136:139]
  v_max_f32 v73, v73, v74
  v_mul_f32 v73, 0x49800000, v73
  v_mfma_f32_16x16x32_bf16 a[132:135], a[244:247], v[60:63], a[132:135]
  v_max_f32 v72, v72, v73
  v_cmp_ngt_f32 vcc, 0x5d800000, v72
  v_mfma_f32_16x16x32_bf16 a[128:131], a[244:247], v[56:59], a[128:131]
  ds_read_b64_tr_b16 a[242:243], v7 offset:6144
  v_mbcnt_lo_u32_b32 v30, -1, 0
  v_mfma_f32_16x16x32_bf16 a[124:127], a[244:247], v[52:55], a[124:127]
  v_mbcnt_hi_u32_b32 v30, -1, v30
  v_and_b32 v31, 15, v30
  v_mfma_f32_16x16x32_bf16 a[120:123], a[244:247], v[48:51], a[120:123]
  s_waitcnt lgkmcnt(2)
  v_lshrrev_b32 v32, 4, v30
  v_mul_u32_u24 v31, 144, v31
  v_mfma_f32_16x16x32_bf16 v[112:115], a[236:239], v[48:51], v[112:115]
  ds_read_b64_tr_b16 a[244:245], v4 offset:8192
  v_lshlrev_b32 v32, 3, v32
  v_mfma_f32_16x16x32_bf16 v[116:119], a[236:239], v[52:55], v[116:119]
  v_add3_u32 v102, v31, v32, s50
  v_lshrrev_b32 v31, 3, v30
  v_mfma_f32_16x16x32_bf16 v[120:123], a[236:239], v[56:59], v[120:123]
  v_and_b32 v33, 7, v30
  v_lshlrev_b32 v33, 4, v33
  v_mfma_f32_16x16x32_bf16 v[124:127], a[236:239], v[60:63], v[124:127]
  ds_read_b64_tr_b16 a[246:247], v4 offset:10240
  v_mul_u32_u24 v32, 144, v31
  v_mfma_f32_16x16x32_bf16 v[128:131], a[236:239], v[64:67], v[128:131]
  v_add3_u32 v103, v32, v33, s50
  v_mul_u32_u24 v31, 384, v31
  v_mfma_f32_16x16x32_bf16 v[132:135], a[236:239], v[68:71], v[132:135]
  s_waitcnt lgkmcnt(2)
  v_add_u32 v104, v33, v31
  v_mfma_f32_16x16x32_bf16 v[156:159], a[240:243], v[68:71], v[156:159]
  ds_read_b64_tr_b16 a[236:237], v5 offset:8192
  v_mfma_f32_16x16x32_bf16 v[152:155], a[240:243], v[64:67], v[152:155]
  v_mfma_f32_16x16x32_bf16 v[148:151], a[240:243], v[60:63], v[148:151]
  v_mfma_f32_16x16x32_bf16 v[144:147], a[240:243], v[56:59], v[144:147]
  ds_read_b64_tr_b16 a[238:239], v5 offset:10240
  v_mfma_f32_16x16x32_bf16 v[140:143], a[240:243], v[52:55], v[140:143]
  v_mfma_f32_16x16x32_bf16 v[136:139], a[240:243], v[48:51], v[136:139]
  s_waitcnt lgkmcnt(2)
  v_mfma_f32_16x16x32_bf16 v[160:163], a[244:247], v[48:51], v[160:163]
  ds_read_b64_tr_b16 a[240:241], v6 offset:8192
  v_mfma_f32_16x16x32_bf16 v[164:167], a[244:247], v[52:55], v[164:167]
  v_mfma_f32_16x16x32_bf16 v[168:171], a[244:247], v[56:59], v[168:171]
  v_mfma_f32_16x16x32_bf16 v[172:175], a[244:247], v[60:63], v[172:175]
  ds_read_b64_tr_b16 a[242:243], v6 offset:10240
  v_mfma_f32_16x16x32_bf16 v[176:179], a[244:247], v[64:67], v[176:179]
  v_mfma_f32_16x16x32_bf16 v[180:183], a[244:247], v[68:71], v[180:183]
  s_waitcnt lgkmcnt(2)
  v_mfma_f32_16x16x32_bf16 v[204:207], a[236:239], v[68:71], v[204:207]
  ds_read_b64_tr_b16 a[244:245], v7 offset:8192
  v_mfma_f32_16x16x32_bf16 v[200:203], a[236:239], v[64:67], v[200:203]
  v_mfma_f32_16x16x32_bf16 v[196:199], a[236:239], v[60:63], v[196:199]
  v_mfma_f32_16x16x32_bf16 v[192:195], a[236:239], v[56:59], v[192:195]
  ds_read_b64_tr_b16 a[246:247], v7 offset:10240
  v_mfma_f32_16x16x32_bf16 v[188:191], a[236:239], v[52:55], v[188:191]
  v_mfma_f32_16x16x32_bf16 v[184:187], a[236:239], v[48:51], v[184:187]
  s_waitcnt lgkmcnt(2)
  v_mfma_f32_16x16x32_bf16 v[208:211], a[240:243], v[48:51], v[208:211]
  v_mfma_f32_16x16x32_bf16 v[212:215], a[240:243], v[52:55], v[212:215]
  v_mfma_f32_16x16x32_bf16 v[216:219], a[240:243], v[56:59], v[216:219]
  v_mfma_f32_16x16x32_bf16 v[220:223], a[240:243], v[60:63], v[220:223]
  v_mfma_f32_16x16x32_bf16 v[224:227], a[240:243], v[64:67], v[224:227]
  s_cmp_lg_u64 vcc, 0
  v_mfma_f32_16x16x32_bf16 v[228:231], a[240:243], v[68:71], v[228:231]
  s_cselect_b32 s37, 1, 0
  s_waitcnt lgkmcnt(0)
  v_mfma_f32_16x16x32_bf16 v[252:255], a[244:247], v[68:71], v[252:255]
  s_lshl_b32 s37, s37, s33
  v_mfma_f32_16x16x32_bf16 v[248:251], a[244:247], v[64:67], v[248:251]
  s_or_b32 s38, s38, s37
  v_mfma_f32_16x16x32_bf16 v[244:247], a[244:247], v[60:63], v[244:247]
  s_add_u32 s33, s33, 1
  v_mfma_f32_16x16x32_bf16 v[240:243], a[244:247], v[56:59], v[240:243]
  v_mfma_f32_16x16x32_bf16 v[236:239], a[244:247], v[52:55], v[236:239]
  v_mfma_f32_16x16x32_bf16 v[232:235], a[244:247], v[48:51], v[232:235]
  v_mul_f32 v160, v96, v160
  v_mul_f32 v161, v96, v161
  v_mul_f32 v162, v96, v162
  v_mul_f32 v163, v96, v163
  v_mul_f32 v184, v96, v184
  v_mul_f32 v185, v96, v185
  v_mul_f32 v186, v96, v186
  v_mul_f32 v187, v96, v187
  v_mul_f32 v208, v96, v208
  v_mul_f32 v209, v96, v209
  v_mul_f32 v210, v96, v210
  v_mul_f32 v211, v96, v211
  v_mul_f32 v232, v96, v232
  v_mul_f32 v233, v96, v233
  v_mul_f32 v234, v96, v234
  v_mul_f32 v235, v96, v235
  v_cvt_pk_bf16_f32 v160, v160, v161
  v_cvt_pk_bf16_f32 v161, v162, v163
  v_cvt_pk_bf16_f32 v184, v184, v185
  v_cvt_pk_bf16_f32 v185, v186, v187
  v_cvt_pk_bf16_f32 v208, v208, v209
  v_cvt_pk_bf16_f32 v209, v210, v211
  v_cvt_pk_bf16_f32 v232, v232, v233
  v_cvt_pk_bf16_f32 v233, v234, v235
  ds_write2_b64 v102, v[160:161], v[184:185] offset0:0 offset1:4
  ds_write2_b64 v102, v[208:209], v[232:233] offset0:8 offset1:12
  ds_read_b128 v[64:67], v103 offset:0
  ds_read_b128 v[68:71], v103 offset:1152
  v_accvgpr_read_b32 v48, a96
  v_accvgpr_read_b32 v49, a97
  v_accvgpr_read_b32 v50, a98
  v_accvgpr_read_b32 v51, a99
  v_accvgpr_read_b32 v52, a120
  v_accvgpr_read_b32 v53, a121
  v_accvgpr_read_b32 v54, a122
  v_accvgpr_read_b32 v55, a123
  v_mul_f32 v48, v96, v48
  v_mul_f32 v49, v96, v49
  v_mul_f32 v50, v96, v50
  v_mul_f32 v51, v96, v51
  v_mul_f32 v52, v96, v52
  v_mul_f32 v53, v96, v53
  v_mul_f32 v54, v96, v54
  v_mul_f32 v55, v96, v55
  v_mul_f32 v112, v96, v112
  v_mul_f32 v113, v96, v113
  v_mul_f32 v114, v96, v114
  v_mul_f32 v115, v96, v115
  v_mul_f32 v136, v96, v136
  v_mul_f32 v137, v96, v137
  v_mul_f32 v138, v96, v138
  v_mul_f32 v139, v96, v139
  v_cvt_pk_bf16_f32 v48, v48, v49
  v_cvt_pk_bf16_f32 v49, v50, v51
  v_cvt_pk_bf16_f32 v52, v52, v53
  v_cvt_pk_bf16_f32 v53, v54, v55
  v_cvt_pk_bf16_f32 v112, v112, v113
  v_cvt_pk_bf16_f32 v113, v114, v115
  v_cvt_pk_bf16_f32 v136, v136, v137
  v_cvt_pk_bf16_f32 v137, v138, v139
  s_waitcnt lgkmcnt(0)
  s_add_u32 s35, s51, 0
  buffer_store_dwordx4 v[64:67], v104, s[20:23], s35 offen offset:256 sc1
  buffer_store_dwordx4 v[68:71], v104, s[20:23], s35 offen offset:3328 sc1
  ds_write2_b64 v102, v[48:49], v[52:53] offset0:0 offset1:4
  ds_write2_b64 v102, v[112:113], v[136:137] offset0:8 offset1:12
  ds_read_b128 v[64:67], v103 offset:0
  ds_read_b128 v[68:71], v103 offset:1152
  v_accvgpr_read_b32 v48, a0
  v_accvgpr_read_b32 v49, a1
  v_accvgpr_read_b32 v50, a2
  v_accvgpr_read_b32 v51, a3
  v_accvgpr_read_b32 v52, a24
  v_accvgpr_read_b32 v53, a25
  v_accvgpr_read_b32 v54, a26
  v_accvgpr_read_b32 v55, a27
  v_accvgpr_read_b32 v56, a48
  v_accvgpr_read_b32 v57, a49
  v_accvgpr_read_b32 v58, a50
  v_accvgpr_read_b32 v59, a51
  v_accvgpr_read_b32 v60, a72
  v_accvgpr_read_b32 v61, a73
  v_accvgpr_read_b32 v62, a74
  v_accvgpr_read_b32 v63, a75
  v_mul_f32 v48, v96, v48
  v_mul_f32 v49, v96, v49
  v_mul_f32 v50, v96, v50
  v_mul_f32 v51, v96, v51
  v_mul_f32 v52, v96, v52
  v_mul_f32 v53, v96, v53
  v_mul_f32 v54, v96, v54
  v_mul_f32 v55, v96, v55
  v_mul_f32 v56, v96, v56
  v_mul_f32 v57, v96, v57
  v_mul_f32 v58, v96, v58
  v_mul_f32 v59, v96, v59
  v_mul_f32 v60, v96, v60
  v_mul_f32 v61, v96, v61
  v_mul_f32 v62, v96, v62
  v_mul_f32 v63, v96, v63
  v_cvt_pk_bf16_f32 v48, v48, v49
  v_cvt_pk_bf16_f32 v49, v50, v51
  v_cvt_pk_bf16_f32 v52, v52, v53
  v_cvt_pk_bf16_f32 v53, v54, v55
  v_cvt_pk_bf16_f32 v56, v56, v57
  v_cvt_pk_bf16_f32 v57, v58, v59
  v_cvt_pk_bf16_f32 v60, v60, v61
  v_cvt_pk_bf16_f32 v61, v62, v63
  s_waitcnt lgkmcnt(0)
  s_add_u32 s35, s51, 0
  buffer_store_dwordx4 v[64:67], v104, s[20:23], s35 offen offset:128 sc1
  buffer_store_dwordx4 v[68:71], v104, s[20:23], s35 offen offset:3200 sc1
  ds_write2_b64 v102, v[48:49], v[52:53] offset0:0 offset1:4
  ds_write2_b64 v102, v[56:57], v[60:61] offset0:8 offset1:12
  ds_read_b128 v[64:67], v103 offset:0
  ds_read_b128 v[68:71], v103 offset:1152
  v_mul_f32 v164, v97, v164
  v_mul_f32 v165, v97, v165
  v_mul_f32 v166, v97, v166
  v_mul_f32 v167, v97, v167
  v_mul_f32 v188, v97, v188
  v_mul_f32 v189, v97, v189
  v_mul_f32 v190, v97, v190
  v_mul_f32 v191, v97, v191
  v_mul_f32 v212, v97, v212
  v_mul_f32 v213, v97, v213
  v_mul_f32 v214, v97, v214
  v_mul_f32 v215, v97, v215
  v_mul_f32 v236, v97, v236
  v_mul_f32 v237, v97, v237
  v_mul_f32 v238, v97, v238
  v_mul_f32 v239, v97, v239
  v_cvt_pk_bf16_f32 v164, v164, v165
  v_cvt_pk_bf16_f32 v165, v166, v167
  v_cvt_pk_bf16_f32 v188, v188, v189
  v_cvt_pk_bf16_f32 v189, v190, v191
  v_cvt_pk_bf16_f32 v212, v212, v213
  v_cvt_pk_bf16_f32 v213, v214, v215
  v_cvt_pk_bf16_f32 v236, v236, v237
  v_cvt_pk_bf16_f32 v237, v238, v239
  s_waitcnt lgkmcnt(0)
  s_add_u32 s35, s51, 0
  buffer_store_dwordx4 v[64:67], v104, s[20:23], s35 offen offset:0 sc1
  buffer_store_dwordx4 v[68:71], v104, s[20:23], s35 offen offset:3072 sc1
  ds_write2_b64 v102, v[164:165], v[188:189] offset0:0 offset1:4
  ds_write2_b64 v102, v[212:213], v[236:237] offset0:8 offset1:12
  ds_read_b128 v[64:67], v103 offset:0
  ds_read_b128 v[68:71], v103 offset:1152
  s_waitcnt vmcnt(6) lgkmcnt(0)
  ds_read_b128 a[204:207], v84 offset:0
  ds_read_b128 a[208:211], v85 offset:0
  ds_read_b128 a[212:215], v21 offset:24576
  ds_read_b128 a[216:219], v22 offset:24576
  ds_read_b128 a[220:223], v21 offset:28672
  ds_read_b128 a[224:227], v22 offset:28672
  ds_read_b128 a[228:231], v21 offset:32768
  ds_read_b128 a[232:235], v22 offset:32768
  ds_read_b128 a[236:239], v0 offset:0
  ds_read_b128 a[240:243], v0 offset:2048
  ds_read_b128 a[248:251], v2 offset:0
  ds_read_b128 a[252:255], v2 offset:2048
  s_mov_b32 s29, s28
  s_cmp_eq_u32 s33, 0
  s_mov_b32 s35, 1879048192
  s_cselect_b32 s34, 6291456, s35
  s_cselect_b32 s35, 4718592, s35
  s_add_u32 s28, s28, s35
  s_add_u32 s34, s34, s55
  s_mov_b32 s32, -3
  v_mov_b32 v15, 0
  v_mov_b32 v16, 0
  v_mov_b32 v17, 0
  v_mov_b32 v18, 0
  v_mov_b32 v19, 0
  v_mov_b32 v20, 0
  s_waitcnt lgkmcnt(2)
  v_mfma_f32_16x16x32_bf16 v[24:27], a[236:239], a[140:143], 0
  ds_read_b128 a[244:247], v1 offset:0
  v_accvgpr_read_b32 v48, a100
  v_accvgpr_read_b32 v49, a101
  v_accvgpr_read_b32 v50, a102
  v_accvgpr_read_b32 v51, a103
  v_mfma_f32_16x16x32_bf16 v[28:31], a[236:239], a[164:167], 0
  v_accvgpr_read_b32 v52, a124
  v_accvgpr_read_b32 v53, a125
  v_accvgpr_read_b32 v54, a126
  v_accvgpr_read_b32 v55, a127
  v_mfma_f32_16x16x32_bf16 v[32:35], a[236:239], a[188:191], 0
  v_mul_f32 v48, v97, v48
  v_mul_f32 v49, v97, v49
  v_mul_f32 v50, v97, v50
  v_mul_f32 v51, v97, v51
  v_mfma_f32_16x16x32_bf16 v[36:39], a[236:239], a[212:215], 0
  s_waitcnt lgkmcnt(1)
  v_mul_f32 v52, v97, v52
  v_mul_f32 v53, v97, v53
  v_mul_f32 v54, v97, v54
  v_mul_f32 v55, v97, v55
  v_mfma_f32_16x16x32_bf16 v[40:43], a[236:239], a[248:251], 0
  v_mul_f32 v116, v97, v116
  v_mul_f32 v117, v97, v117
  v_mul_f32 v118, v97, v118
  v_mul_f32 v119, v97, v119
  v_mfma_f32_16x16x32_bf16 v[44:47], a[236:239], a[252:255], 0
  v_mul_f32 v140, v97, v140
  v_mul_f32 v141, v97, v141
  v_mul_f32 v142, v97, v142
  v_mul_f32 v143, v97, v143
  v_mfma_f32_16x16x32_bf16 v[92:95], a[240:243], a[252:255], 0
  ds_read_b128 a[252:255], v3 offset:2048
  v_cvt_pk_bf16_f32 v48, v48, v49
  v_cvt_pk_bf16_f32 v49, v50, v51
  v_cvt_pk_bf16_f32 v52, v52, v53
  v_cvt_pk_bf16_f32 v53, v54, v55
  v_mfma_f32_16x16x32_bf16 v[88:91], a[240:243], a[248:251], 0
  v_cvt_pk_bf16_f32 v116, v116, v117
  v_cvt_pk_bf16_f32 v117, v118, v119
  v_cvt_pk_bf16_f32 v140, v140, v141
  v_cvt_pk_bf16_f32 v141, v142, v143
  s_add_u32 s35, s51, 6144
  v_mfma_f32_16x16x32_bf16 v[84:87], a[240:243], a[212:215], 0
  buffer_store_dwordx4 v[64:67], v104, s[20:23], s35 offen offset:256 sc1
  buffer_store_dwordx4 v[68:71], v104, s[20:23], s35 offen offset:3328 sc1
  ds_write2_b64 v102, v[48:49], v[52:53] offset0:0 offset1:4
  ds_write2_b64 v102, v[116:117], v[140:141] offset0:8 offset1:12
  ds_read_b128 v[64:67], v103 offset:0
  ds_read_b128 v[68:71], v103 offset:1152
  v_mfma_f32_16x16x32_bf16 v[80:83], a[240:243], a[188:191], 0
  ds_read_b128 a[248:251], v3 offset:0
  v_accvgpr_read_b32 v48, a4
  v_accvgpr_read_b32 v49, a5
  v_accvgpr_read_b32 v50, a6
  v_accvgpr_read_b32 v51, a7
  v_accvgpr_read_b32 v52, a28
  v_mfma_f32_16x16x32_bf16 v[76:79], a[240:243], a[164:167], 0
  ds_read_b128 a[236:239], v1 offset:2048
  v_accvgpr_read_b32 v53, a29
  v_accvgpr_read_b32 v54, a30
  v_accvgpr_read_b32 v55, a31
  v_accvgpr_read_b32 v56, a52
  v_accvgpr_read_b32 v57, a53
  v_mfma_f32_16x16x32_bf16 v[72:75], a[240:243], a[140:143], 0
  s_waitcnt lgkmcnt(7)
  v_accvgpr_read_b32 v58, a54
  v_accvgpr_read_b32 v59, a55
  v_accvgpr_read_b32 v60, a76
  v_accvgpr_read_b32 v61, a77
  v_accvgpr_read_b32 v62, a78
  v_mfma_f32_16x16x32_bf16 v[24:27], a[244:247], a[144:147], v[24:27]
  ds_read_b128 a[240:243], v0 offset:4096
  v_accvgpr_read_b32 v63, a79
  v_mul_f32 v48, v97, v48
  v_mul_f32 v49, v97, v49
  v_mul_f32 v50, v97, v50
  v_mul_f32 v51, v97, v51
  v_mfma_f32_16x16x32_bf16 v[28:31], a[244:247], a[168:171], v[28:31]
  v_mul_f32 v52, v97, v52
  v_mul_f32 v53, v97, v53
  v_mul_f32 v54, v97, v54
  v_mul_f32 v55, v97, v55
  v_mul_f32 v56, v97, v56
  v_mfma_f32_16x16x32_bf16 v[32:35], a[244:247], a[192:195], v[32:35]
  v_mul_f32 v57, v97, v57
  v_mul_f32 v58, v97, v58
  v_mul_f32 v59, v97, v59
  v_mul_f32 v60, v97, v60
  v_mul_f32 v61, v97, v61
  v_mfma_f32_16x16x32_bf16 v[36:39], a[244:247], a[216:219], v[36:39]
  s_waitcnt lgkmcnt(2)
  v_mul_f32 v62, v97, v62
  v_mul_f32 v63, v97, v63
  v_cvt_pk_bf16_f32 v48, v48, v49
  v_cvt_pk_bf16_f32 v49, v50, v51
  v_cvt_pk_bf16_f32 v52, v52, v53
  v_mfma_f32_16x16x32_bf16 v[40:43], a[244:247], a[248:251], v[40:43]
  v_cvt_pk_bf16_f32 v53, v54, v55
  v_cvt_pk_bf16_f32 v56, v56, v57
  v_cvt_pk_bf16_f32 v57, v58, v59
  v_cvt_pk_bf16_f32 v60, v60, v61
  v_cvt_pk_bf16_f32 v61, v62, v63
  s_add_u32 s35, s51, 6144
  v_mfma_f32_16x16x32_bf16 v[44:47], a[244:247], a[252:255], v[44:47]
  buffer_store_dwordx4 v[64:67], v104, s[20:23], s35 offen offset:128 sc1
  buffer_store_dwordx4 v[68:71], v104, s[20:23], s35 offen offset:3200 sc1
  ds_write2_b64 v102, v[48:49], v[52:53] offset0:0 offset1:4
  ds_write2_b64 v102, v[56:57], v[60:61] offset0:8 offset1:12
  ds_read_b128 v[64:67], v103 offset:0
  ds_read_b128 v[68:71], v103 offset:1152
  s_waitcnt lgkmcnt(5)
  v_mfma_f32_16x16x32_bf16 v[92:95], a[236:239], a[252:255], v[92:95]
  ds_read_b128 a[252:255], v2 offset:6144
  v_mul_f32 v168, v98, v168
  v_mul_f32 v169, v98, v169
  v_mul_f32 v170, v98, v170
  v_mfma_f32_16x16x32_bf16 v[88:91], a[236:239], a[248:251], v[88:91]
  v_mul_f32 v171, v98, v171
  v_mul_f32 v192, v98, v192
  v_mul_f32 v193, v98, v193
  v_mfma_f32_16x16x32_bf16 v[84:87], a[236:239], a[216:219], v[84:87]
  v_mul_f32 v194, v98, v194
  v_mul_f32 v195, v98, v195
  v_mul_f32 v216, v98, v216
  v_mfma_f32_16x16x32_bf16 v[80:83], a[236:239], a[192:195], v[80:83]
  ds_read_b128 a[248:251], v2 offset:4096
  v_mul_f32 v217, v98, v217
  v_mul_f32 v218, v98, v218
  v_mul_f32 v219, v98, v219
  v_mfma_f32_16x16x32_bf16 v[76:79], a[236:239], a[168:171], v[76:79]
  ds_read_b128 a[244:247], v0 offset:6144
  v_mul_f32 v240, v98, v240
  v_mul_f32 v241, v98, v241
  v_mul_f32 v242, v98, v242
  v_mfma_f32_16x16x32_bf16 v[72:75], a[236:239], a[144:147], v[72:75]
  s_waitcnt lgkmcnt(7)
  v_mul_f32 v243, v98, v243
  v_cvt_pk_bf16_f32 v168, v168, v169
  v_cvt_pk_bf16_f32 v169, v170, v171
  v_mfma_f32_16x16x32_bf16 v[24:27], a[240:243], a[148:151], v[24:27]
  ds_read_b128 a[236:239], v1 offset:4096
  v_cvt_pk_bf16_f32 v192, v192, v193
  v_cvt_pk_bf16_f32 v193, v194, v195
  v_cvt_pk_bf16_f32 v216, v216, v217
  v_mfma_f32_16x16x32_bf16 v[28:31], a[240:243], a[172:175], v[28:31]
  v_cvt_pk_bf16_f32 v217, v218, v219
  v_cvt_pk_bf16_f32 v240, v240, v241
  v_cvt_pk_bf16_f32 v241, v242, v243
  s_waitcnt lgkmcnt(4)
  s_add_u32 s35, s51, 6144
  v_mfma_f32_16x16x32_bf16 v[32:35], a[240:243], a[196:199], v[32:35]
  buffer_store_dwordx4 v[64:67], v104, s[20:23], s35 offen offset:0 sc1
  buffer_store_dwordx4 v[68:71], v104, s[20:23], s35 offen offset:3072 sc1
  ds_write2_b64 v102, v[168:169], v[192:193] offset0:0 offset1:4
  ds_write2_b64 v102, v[216:217], v[240:241] offset0:8 offset1:12
  ds_read_b128 v[64:67], v103 offset:0
  ds_read_b128 v[68:71], v103 offset:1152
  v_mfma_f32_16x16x32_bf16 v[36:39], a[240:243], a[220:223], v[36:39]
  s_waitcnt lgkmcnt(6)
  v_accvgpr_read_b32 v48, a104
  v_accvgpr_read_b32 v49, a105
  v_accvgpr_read_b32 v50, a106
  v_accvgpr_read_b32 v51, a107
  v_mfma_f32_16x16x32_bf16 v[40:43], a[240:243], a[248:251], v[40:43]
  v_accvgpr_read_b32 v52, a128
  v_accvgpr_read_b32 v53, a129
  v_accvgpr_read_b32 v54, a130
  v_accvgpr_read_b32 v55, a131
  v_mfma_f32_16x16x32_bf16 v[44:47], a[240:243], a[252:255], v[44:47]
  s_waitcnt lgkmcnt(5)
  v_mul_f32 v48, v98, v48
  v_mul_f32 v49, v98, v49
  v_mul_f32 v50, v98, v50
  v_mul_f32 v51, v98, v51
  v_mfma_f32_16x16x32_bf16 v[92:95], a[244:247], a[252:255], v[92:95]
  ds_read_b128 a[252:255], v3 offset:6144
  v_mul_f32 v52, v98, v52
  v_mul_f32 v53, v98, v53
  v_mul_f32 v54, v98, v54
  v_mul_f32 v55, v98, v55
  v_mfma_f32_16x16x32_bf16 v[88:91], a[244:247], a[248:251], v[88:91]
  v_mul_f32 v120, v98, v120
  v_mul_f32 v121, v98, v121
  v_mul_f32 v122, v98, v122
  v_mul_f32 v123, v98, v123
  v_mfma_f32_16x16x32_bf16 v[84:87], a[244:247], a[220:223], v[84:87]
  v_mul_f32 v144, v98, v144
  v_mul_f32 v145, v98, v145
  v_mul_f32 v146, v98, v146
  v_mul_f32 v147, v98, v147
  v_mfma_f32_16x16x32_bf16 v[80:83], a[244:247], a[196:199], v[80:83]
  ds_read_b128 a[248:251], v3 offset:4096
  v_cvt_pk_bf16_f32 v48, v48, v49
  v_cvt_pk_bf16_f32 v49, v50, v51
  v_cvt_pk_bf16_f32 v52, v52, v53
  v_cvt_pk_bf16_f32 v53, v54, v55
  v_mfma_f32_16x16x32_bf16 v[76:79], a[244:247], a[172:175], v[76:79]
  ds_read_b128 a[240:243], v1 offset:6144
  v_cvt_pk_bf16_f32 v120, v120, v121
  v_cvt_pk_bf16_f32 v121, v122, v123
  v_cvt_pk_bf16_f32 v144, v144, v145
  v_cvt_pk_bf16_f32 v145, v146, v147
  s_waitcnt lgkmcnt(3)
  s_add_u32 s35, s51, 12288
  v_mfma_f32_16x16x32_bf16 v[72:75], a[244:247], a[148:151], v[72:75]
  buffer_store_dwordx4 v[64:67], v104, s[20:23], s35 offen offset:256 sc1
  buffer_store_dwordx4 v[68:71], v104, s[20:23], s35 offen offset:3328 sc1
  ds_write2_b64 v102, v[48:49], v[52:53] offset0:0 offset1:4
  ds_write2_b64 v102, v[120:121], v[144:145] offset0:8 offset1:12
  ds_read_b128 v[64:67], v103 offset:0
  ds_read_b128 v[68:71], v103 offset:1152
  v_mfma_f32_16x16x32_bf16 v[24:27], a[236:239], a[152:155], v[24:27]
  ds_read_b128 a[244:247], v0 offset:8192
  v_accvgpr_read_b32 v48, a8
  v_accvgpr_read_b32 v49, a9
  v_accvgpr_read_b32 v50, a10
  v_accvgpr_read_b32 v51, a11
  v_accvgpr_read_b32 v52, a32
  v_mfma_f32_16x16x32_bf16 v[28:31], a[236:239], a[176:179], v[28:31]
  v_accvgpr_read_b32 v53, a33
  v_accvgpr_read_b32 v54, a34
  v_accvgpr_read_b32 v55, a35
  v_accvgpr_read_b32 v56, a56
  v_accvgpr_read_b32 v57, a57
  v_mfma_f32_16x16x32_bf16 v[32:35], a[236:239], a[200:203], v[32:35]
  v_accvgpr_read_b32 v58, a58
  v_accvgpr_read_b32 v59, a59
  v_accvgpr_read_b32 v60, a80
  v_accvgpr_read_b32 v61, a81
  v_accvgpr_read_b32 v62, a82
  v_mfma_f32_16x16x32_bf16 v[36:39], a[236:239], a[224:227], v[36:39]
  s_waitcnt lgkmcnt(6)
  v_accvgpr_read_b32 v63, a83
  v_mul_f32 v48, v98, v48
  v_mul_f32 v49, v98, v49
  v_mul_f32 v50, v98, v50
  v_mul_f32 v51, v98, v51
  v_mfma_f32_16x16x32_bf16 v[40:43], a[236:239], a[248:251], v[40:43]
  v_mul_f32 v52, v98, v52
  v_mul_f32 v53, v98, v53
  v_mul_f32 v54, v98, v54
  v_mul_f32 v55, v98, v55
  v_mul_f32 v56, v98, v56
  v_mfma_f32_16x16x32_bf16 v[44:47], a[236:239], a[252:255], v[44:47]
  s_waitcnt lgkmcnt(5)
  v_mul_f32 v57, v98, v57
  v_mul_f32 v58, v98, v58
  v_mul_f32 v59, v98, v59
  v_mul_f32 v60, v98, v60
  v_mul_f32 v61, v98, v61
  v_mfma_f32_16x16x32_bf16 v[92:95], a[240:243], a[252:255], v[92:95]
  ds_read_b128 a[252:255], v2 offset:10240
  v_mul_f32 v62, v98, v62
  v_mul_f32 v63, v98, v63
  v_cvt_pk_bf16_f32 v48, v48, v49
  v_cvt_pk_bf16_f32 v49, v50, v51
  v_cvt_pk_bf16_f32 v52, v52, v53
  v_mfma_f32_16x16x32_bf16 v[88:91], a[240:243], a[248:251], v[88:91]
  v_cvt_pk_bf16_f32 v53, v54, v55
  v_cvt_pk_bf16_f32 v56, v56, v57
  v_cvt_pk_bf16_f32 v57, v58, v59
  v_cvt_pk_bf16_f32 v60, v60, v61
  v_cvt_pk_bf16_f32 v61, v62, v63
  s_waitcnt lgkmcnt(2)
  s_add_u32 s35, s51, 12288
  v_mfma_f32_16x16x32_bf16 v[84:87], a[240:243], a[224:227], v[84:87]
  buffer_store_dwordx4 v[64:67], v104, s[20:23], s35 offen offset:128 sc1
  buffer_store_dwordx4 v[68:71], v104, s[20:23], s35 offen offset:3200 sc1
  ds_write2_b64 v102, v[48:49], v[52:53] offset0:0 offset1:4
  ds_write2_b64 v102, v[56:57], v[60:61] offset0:8 offset1:12
  ds_read_b128 v[64:67], v103 offset:0
  ds_read_b128 v[68:71], v103 offset:1152
  s_add_u32 m0, s25, 61440
  s_nop 0
  buffer_load_dwordx4 v8, s[16:19], s27 offen offset:0 nt lds
  s_add_u32 m0, s25, 65408
  s_nop 0
  buffer_load_dwordx4 v8, s[16:19], s27 offen offset:128 nt lds
  s_add_u32 m0, s25, 69376
  s_nop 0
  buffer_load_dwordx4 v8, s[16:19], s27 offen offset:256 nt lds
  v_mfma_f32_16x16x32_bf16 v[80:83], a[240:243], a[200:203], v[80:83]
  ds_read_b128 a[248:251], v2 offset:8192
  v_mul_f32 v172, v99, v172
  v_mul_f32 v173, v99, v173
  v_mul_f32 v174, v99, v174
  v_mfma_f32_16x16x32_bf16 v[76:79], a[240:243], a[176:179], v[76:79]
  ds_read_b128 a[236:239], v0 offset:10240
  v_mul_f32 v175, v99, v175
  v_mul_f32 v196, v99, v196
  v_mul_f32 v197, v99, v197
  v_mfma_f32_16x16x32_bf16 v[72:75], a[240:243], a[152:155], v[72:75]
  s_waitcnt lgkmcnt(7)
  v_mul_f32 v198, v99, v198
  v_mul_f32 v199, v99, v199
  v_mul_f32 v220, v99, v220
  v_mfma_f32_16x16x32_bf16 v[24:27], a[244:247], a[156:159], v[24:27]
  ds_read_b128 a[240:243], v1 offset:8192
  v_mul_f32 v221, v99, v221
  v_mul_f32 v222, v99, v222
  v_mul_f32 v223, v99, v223
  v_mfma_f32_16x16x32_bf16 v[28:31], a[244:247], a[180:183], v[28:31]
  v_mul_f32 v244, v99, v244
  v_mul_f32 v245, v99, v245
  v_mul_f32 v246, v99, v246
  v_mfma_f32_16x16x32_bf16 v[32:35], a[244:247], a[204:207], v[32:35]
  v_mul_f32 v247, v99, v247
  v_cvt_pk_bf16_f32 v172, v172, v173
  v_cvt_pk_bf16_f32 v173, v174, v175
  v_mfma_f32_16x16x32_bf16 v[36:39], a[244:247], a[228:231], v[36:39]
  s_waitcnt lgkmcnt(2)
  v_cvt_pk_bf16_f32 v196, v196, v197
  v_cvt_pk_bf16_f32 v197, v198, v199
  v_cvt_pk_bf16_f32 v220, v220, v221
  v_mfma_f32_16x16x32_bf16 v[40:43], a[244:247], a[248:251], v[40:43]
  v_cvt_pk_bf16_f32 v221, v222, v223
  v_cvt_pk_bf16_f32 v244, v244, v245
  v_cvt_pk_bf16_f32 v245, v246, v247
  s_add_u32 s35, s51, 12288
  v_mfma_f32_16x16x32_bf16 v[44:47], a[244:247], a[252:255], v[44:47]
  buffer_store_dwordx4 v[64:67], v104, s[20:23], s35 offen offset:0 sc1
  buffer_store_dwordx4 v[68:71], v104, s[20:23], s35 offen offset:3072 sc1
  ds_write2_b64 v102, v[172:173], v[196:197] offset0:0 offset1:4
  ds_write2_b64 v102, v[220:221], v[244:245] offset0:8 offset1:12
  ds_read_b128 v[64:67], v103 offset:0
  ds_read_b128 v[68:71], v103 offset:1152
  s_waitcnt lgkmcnt(5)
  v_mfma_f32_16x16x32_bf16 v[92:95], a[236:239], a[252:255], v[92:95]
  ds_read_b128 a[252:255], v3 offset:10240
  v_accvgpr_read_b32 v48, a108
  v_accvgpr_read_b32 v49, a109
  v_accvgpr_read_b32 v50, a110
  v_accvgpr_read_b32 v51, a111
  v_mfma_f32_16x16x32_bf16 v[88:91], a[236:239], a[248:251], v[88:91]
  v_accvgpr_read_b32 v52, a132
  v_accvgpr_read_b32 v53, a133
  v_accvgpr_read_b32 v54, a134
  v_accvgpr_read_b32 v55, a135
  v_mfma_f32_16x16x32_bf16 v[84:87], a[236:239], a[228:231], v[84:87]
  v_mul_f32 v48, v99, v48
  v_mul_f32 v49, v99, v49
  v_mul_f32 v50, v99, v50
  v_mul_f32 v51, v99, v51
  v_mfma_f32_16x16x32_bf16 v[80:83], a[236:239], a[204:207], v[80:83]
  ds_read_b128 a[248:251], v3 offset:8192
  v_mul_f32 v52, v99, v52
  v_mul_f32 v53, v99, v53
  v_mul_f32 v54, v99, v54
  v_mul_f32 v55, v99, v55
  v_mfma_f32_16x16x32_bf16 v[76:79], a[236:239], a[180:183], v[76:79]
  ds_read_b128 a[244:247], v1 offset:10240
  v_mul_f32 v124, v99, v124
  v_mul_f32 v125, v99, v125
  v_mul_f32 v126, v99, v126
  v_mul_f32 v127, v99, v127
  v_mfma_f32_16x16x32_bf16 v[72:75], a[236:239], a[156:159], v[72:75]
  s_waitcnt lgkmcnt(7)
  v_mul_f32 v148, v99, v148
  v_mul_f32 v149, v99, v149
  v_mul_f32 v150, v99, v150
  v_mul_f32 v151, v99, v151
  v_mfma_f32_16x16x32_bf16 v[24:27], a[240:243], a[160:163], v[24:27]
  v_cvt_pk_bf16_f32 v48, v48, v49
  v_cvt_pk_bf16_f32 v49, v50, v51
  v_cvt_pk_bf16_f32 v52, v52, v53
  v_cvt_pk_bf16_f32 v53, v54, v55
  v_mfma_f32_16x16x32_bf16 v[28:31], a[240:243], a[184:187], v[28:31]
  v_cvt_pk_bf16_f32 v124, v124, v125
  v_cvt_pk_bf16_f32 v125, v126, v127
  v_cvt_pk_bf16_f32 v148, v148, v149
  v_cvt_pk_bf16_f32 v149, v150, v151
  s_waitcnt lgkmcnt(3)
  s_add_u32 s35, s51, 18432
  v_mfma_f32_16x16x32_bf16 v[32:35], a[240:243], a[208:211], v[32:35]
  buffer_store_dwordx4 v[64:67], v104, s[20:23], s35 offen offset:256 sc1
  buffer_store_dwordx4 v[68:71], v104, s[20:23], s35 offen offset:3328 sc1
  ds_write2_b64 v102, v[48:49], v[52:53] offset0:0 offset1:4
  ds_write2_b64 v102, v[124:125], v[148:149] offset0:8 offset1:12
  ds_read_b128 v[64:67], v103 offset:0
  ds_read_b128 v[68:71], v103 offset:1152
  s_add_u32 m0, s25, 24576
  s_nop 0
  buffer_load_dwordx4 v8, s[12:15], s26 offen offset:0 nt lds
  s_add_u32 m0, s25, 28544
  s_nop 0
  buffer_load_dwordx4 v8, s[12:15], s26 offen offset:128 nt lds
  s_add_u32 m0, s25, 32512
  s_nop 0
  buffer_load_dwordx4 v8, s[12:15], s26 offen offset:256 nt lds
  v_mfma_f32_16x16x32_bf16 v[36:39], a[240:243], a[232:235], v[36:39]
  s_waitcnt lgkmcnt(5)
  v_accvgpr_read_b32 v48, a12
  v_accvgpr_read_b32 v49, a13
  v_accvgpr_read_b32 v50, a14
  v_accvgpr_read_b32 v51, a15
  v_accvgpr_read_b32 v52, a36
  v_mfma_f32_16x16x32_bf16 v[40:43], a[240:243], a[248:251], v[40:43]
  v_accvgpr_read_b32 v53, a37
  v_accvgpr_read_b32 v54, a38
  v_accvgpr_read_b32 v55, a39
  v_accvgpr_read_b32 v56, a60
  v_accvgpr_read_b32 v57, a61
  v_mfma_f32_16x16x32_bf16 v[44:47], a[240:243], a[252:255], v[44:47]
  s_waitcnt lgkmcnt(4)
  v_accvgpr_read_b32 v58, a62
  v_accvgpr_read_b32 v59, a63
  v_accvgpr_read_b32 v60, a84
  v_accvgpr_read_b32 v61, a85
  v_accvgpr_read_b32 v62, a86
  v_mfma_f32_16x16x32_bf16 v[92:95], a[244:247], a[252:255], v[92:95]
  v_accvgpr_read_b32 v63, a87
  v_mul_f32 v48, v99, v48
  v_mul_f32 v49, v99, v49
  v_mul_f32 v50, v99, v50
  v_mul_f32 v51, v99, v51
  v_mfma_f32_16x16x32_bf16 v[88:91], a[244:247], a[248:251], v[88:91]
  v_mul_f32 v52, v99, v52
  v_mul_f32 v53, v99, v53
  v_mul_f32 v54, v99, v54
  v_mul_f32 v55, v99, v55
  v_mul_f32 v56, v99, v56
  v_mfma_f32_16x16x32_bf16 v[84:87], a[244:247], a[232:235], v[84:87]
  v_mul_f32 v57, v99, v57
  v_mul_f32 v58, v99, v58
  v_mul_f32 v59, v99, v59
  v_mul_f32 v60, v99, v60
  v_mul_f32 v61, v99, v61
  v_mfma_f32_16x16x32_bf16 v[80:83], a[244:247], a[208:211], v[80:83]
  v_mul_f32 v62, v99, v62
  v_mul_f32 v63, v99, v63
  v_cvt_pk_bf16_f32 v48, v48, v49
  v_cvt_pk_bf16_f32 v49, v50, v51
  v_cvt_pk_bf16_f32 v52, v52, v53
  v_mfma_f32_16x16x32_bf16 v[76:79], a[244:247], a[184:187], v[76:79]
  v_cvt_pk_bf16_f32 v53, v54, v55
  v_cvt_pk_bf16_f32 v56, v56, v57
  v_cvt_pk_bf16_f32 v57, v58, v59
  v_cvt_pk_bf16_f32 v60, v60, v61
  v_cvt_pk_bf16_f32 v61, v62, v63
  s_waitcnt lgkmcnt(0)
  s_add_u32 s35, s51, 18432
  v_mfma_f32_16x16x32_bf16 v[72:75], a[244:247], a[160:163], v[72:75]
  buffer_store_dwordx4 v[64:67], v104, s[20:23], s35 offen offset:128 sc1
  buffer_store_dwordx4 v[68:71], v104, s[20:23], s35 offen offset:3200 sc1
  ds_write2_b64 v102, v[48:49], v[52:53] offset0:0 offset1:4
  ds_write2_b64 v102, v[56:57], v[60:61] offset0:8 offset1:12
  ds_read_b128 v[64:67], v103 offset:0
  ds_read_b128 v[68:71], v103 offset:1152
  v_max3_f32 v162, v32, v33, v34
  v_mul_f32 v176, v100, v176
  v_mul_f32 v177, v100, v177
  v_mul_f32 v178, v100, v178
  v_max3_f32 v161, v28, v29, v30
  v_mul_f32 v179, v100, v179
  v_mul_f32 v200, v100, v200
  v_max3_f32 v160, v24, v25, v26
  v_mul_f32 v201, v100, v201
  v_mul_f32 v202, v100, v202
  v_mul_f32 v203, v100, v203
  v_max3_f32 v162, v162, v35, v80
  v_mul_f32 v224, v100, v224
  v_mul_f32 v225, v100, v225
  v_max3_f32 v161, v161, v31, v76
  v_mul_f32 v226, v100, v226
  v_mul_f32 v227, v100, v227
  v_max3_f32 v160, v160, v27, v72
  v_mul_f32 v248, v100, v248
  v_mul_f32 v249, v100, v249
  v_mul_f32 v250, v100, v250
  v_max3_f32 v162, v162, v81, v82
  v_mul_f32 v251, v100, v251
  v_cvt_pk_bf16_f32 v176, v176, v177
  v_max3_f32 v161, v161, v77, v78
  v_cvt_pk_bf16_f32 v177, v178, v179
  v_cvt_pk_bf16_f32 v200, v200, v201
  v_cvt_pk_bf16_f32 v201, v202, v203
  v_max3_f32 v160, v160, v73, v74
  v_cvt_pk_bf16_f32 v224, v224, v225
  v_cvt_pk_bf16_f32 v225, v226, v227
  v_max3_f32 v162, v162, v83, v79
  v_cvt_pk_bf16_f32 v248, v248, v249
  v_cvt_pk_bf16_f32 v249, v250, v251
  s_waitcnt lgkmcnt(0)
  s_add_u32 s35, s51, 18432
  buffer_store_dwordx4 v[64:67], v104, s[20:23], s35 offen offset:0 sc1
  buffer_store_dwordx4 v[68:71], v104, s[20:23], s35 offen offset:3072 sc1
  ds_write2_b64 v102, v[176:177], v[200:201] offset0:0 offset1:4
  ds_write2_b64 v102, v[224:225], v[248:249] offset0:8 offset1:12
  ds_read_b128 v[64:67], v103 offset:0
  ds_read_b128 v[68:71], v103 offset:1152
  s_add_u32 s27, s27, 12288
  s_cmp_eq_u32 s27, s59
  s_cselect_b32 s27, s58, s27
  s_add_u32 m0, s25, 73728
  s_nop 0
  buffer_load_dwordx4 v8, s[16:19], s27 offen offset:0 nt lds
  s_add_u32 m0, s25, 77696
  s_nop 0
  buffer_load_dwordx4 v8, s[16:19], s27 offen offset:128 nt lds
  s_add_u32 m0, s25, 81664
  s_nop 0
  buffer_load_dwordx4 v8, s[16:19], s27 offen offset:256 nt lds
  v_max3_f32 v160, v160, v161, v75
  v_accvgpr_read_b32 v48, a112
  v_accvgpr_read_b32 v49, a113
  v_accvgpr_read_b32 v50, a114
  v_max_f32 v160, v160, v162
  v_accvgpr_read_b32 v51, a115
  v_accvgpr_read_b32 v52, a136
  v_mov_b32 v161, v160
  v_accvgpr_read_b32 v53, a137
  v_accvgpr_read_b32 v54, a138
  s_nop 1
  v_accvgpr_read_b32 v55, a139
  v_mul_f32 v48, v100, v48
  v_mul_f32 v49, v100, v49
  v_permlane32_swap_b32 v161, v160
  v_mul_f32 v50, v100, v50
  v_mul_f32 v51, v100, v51
  v_max_f32 v160, v160, v161
  v_mul_f32 v52, v100, v52
  v_mul_f32 v53, v100, v53
  v_mov_b32 v161, v160
  v_mul_f32 v54, v100, v54
  v_mul_f32 v55, v100, v55
  s_nop 1
  v_mul_f32 v128, v100, v128
  v_mul_f32 v129, v100, v129
  v_mul_f32 v130, v100, v130
  v_permlane16_swap_b32 v161, v160
  v_mul_f32 v131, v100, v131
  v_mul_f32 v152, v100, v152
  v_max_f32 v160, v160, v161
  v_mul_f32 v153, v100, v153
  v_mul_f32 v154, v100, v154
  v_sub_f32 v10, 0x4266823a, v160
  v_mul_f32 v155, v100, v155
  v_cvt_pk_bf16_f32 v48, v48, v49
  v_cvt_pk_bf16_f32 v49, v50, v51
  v_sub_f32 v11, 0x4266823a, v160
  v_cvt_pk_bf16_f32 v52, v52, v53
  v_cvt_pk_bf16_f32 v53, v54, v55
  v_sub_f32 v12, 0x4266823a, v160
  v_cvt_pk_bf16_f32 v128, v128, v129
  v_cvt_pk_bf16_f32 v129, v130, v131
  v_sub_f32 v13, 0x4266823a, v160
  v_cvt_pk_bf16_f32 v152, v152, v153
  v_cvt_pk_bf16_f32 v153, v154, v155
  s_waitcnt lgkmcnt(0)
  s_add_u32 s35, s51, 24576
  buffer_store_dwordx4 v[64:67], v104, s[20:23], s35 offen offset:256 sc1
  buffer_store_dwordx4 v[68:71], v104, s[20:23], s35 offen offset:3328 sc1
  ds_write2_b64 v102, v[48:49], v[52:53] offset0:0 offset1:4
  ds_write2_b64 v102, v[128:129], v[152:153] offset0:8 offset1:12
  ds_read_b128 v[64:67], v103 offset:0
  ds_read_b128 v[68:71], v103 offset:1152
  v_mul_f32 v9, s30, v10
  v_accvgpr_read_b32 v48, a16
  v_accvgpr_read_b32 v49, a17
  v_accvgpr_read_b32 v50, a18
  v_fmamk_f32 v24, v24, 0x3dd53b95, v9
  v_accvgpr_read_b32 v51, a19
  v_accvgpr_read_b32 v52, a40
  v_exp_f32 v24, v24
  v_accvgpr_read_b32 v53, a41
  v_accvgpr_read_b32 v54, a42
  v_fmamk_f32 v25, v25, 0x3dd53b95, v9
  v_accvgpr_read_b32 v55, a43
  v_accvgpr_read_b32 v56, a64
  v_add_f32 v15, v15, v24
  v_accvgpr_read_b32 v57, a65
  v_accvgpr_read_b32 v58, a66
  v_accvgpr_read_b32 v59, a67
  v_exp_f32 v25, v25
  v_accvgpr_read_b32 v60, a88
  v_accvgpr_read_b32 v61, a89
  v_fmamk_f32 v26, v26, 0x3dd53b95, v9
  v_accvgpr_read_b32 v62, a90
  v_accvgpr_read_b32 v63, a91
  v_add_f32 v15, v15, v25
  v_cvt_pk_bf16_f32 v24, v24, v25
  v_mul_f32 v48, v100, v48
  v_mul_f32 v49, v100, v49
  v_exp_f32 v26, v26
  v_mul_f32 v50, v100, v50
  v_mul_f32 v51, v100, v51
  v_fmamk_f32 v27, v27, 0x3dd53b95, v9
  v_mul_f32 v52, v100, v52
  v_mul_f32 v53, v100, v53
  v_mul_f32 v54, v100, v54
  v_add_f32 v15, v15, v26
  v_mul_f32 v55, v100, v55
  v_mul_f32 v56, v100, v56
  v_exp_f32 v27, v27
  v_mul_f32 v57, v100, v57
  v_mul_f32 v58, v100, v58
  v_fmamk_f32 v72, v72, 0x3dd53b95, v9
  v_mul_f32 v59, v100, v59
  v_mul_f32 v60, v100, v60
  v_add_f32 v15, v15, v27
  v_cvt_pk_bf16_f32 v25, v26, v27
  v_mul_f32 v61, v100, v61
  v_mul_f32 v62, v100, v62
  v_mul_f32 v63, v100, v63
  v_exp_f32 v72, v72
  v_cvt_pk_bf16_f32 v48, v48, v49
  v_cvt_pk_bf16_f32 v49, v50, v51
  v_fmamk_f32 v73, v73, 0x3dd53b95, v9
  v_cvt_pk_bf16_f32 v52, v52, v53
  v_cvt_pk_bf16_f32 v53, v54, v55
  v_add_f32 v15, v15, v72
  v_cvt_pk_bf16_f32 v56, v56, v57
  v_cvt_pk_bf16_f32 v57, v58, v59
  v_exp_f32 v73, v73
  v_cvt_pk_bf16_f32 v60, v60, v61
  v_cvt_pk_bf16_f32 v61, v62, v63
  s_waitcnt lgkmcnt(0)
  s_add_u32 s35, s51, 24576
  buffer_store_dwordx4 v[64:67], v104, s[20:23], s35 offen offset:128 sc1
  buffer_store_dwordx4 v[68:71], v104, s[20:23], s35 offen offset:3200 sc1
  ds_write2_b64 v102, v[48:49], v[52:53] offset0:0 offset1:4
  ds_write2_b64 v102, v[56:57], v[60:61] offset0:8 offset1:12
  ds_read_b128 v[64:67], v103 offset:0
  ds_read_b128 v[68:71], v103 offset:1152
  v_fmamk_f32 v74, v74, 0x3dd53b95, v9
  v_mul_f32 v180, v101, v180
  v_mul_f32 v181, v101, v181
  v_mul_f32 v182, v101, v182
  v_add_f32 v15, v15, v73
  v_cvt_pk_bf16_f32 v26, v72, v73
  v_mul_f32 v183, v101, v183
  v_mul_f32 v204, v101, v204
  v_exp_f32 v74, v74
  v_mul_f32 v205, v101, v205
  v_mul_f32 v206, v101, v206
  v_fmamk_f32 v75, v75, 0x3dd53b95, v9
  v_mul_f32 v207, v101, v207
  v_mul_f32 v228, v101, v228
  v_add_f32 v15, v15, v74
  v_mul_f32 v229, v101, v229
  v_mul_f32 v230, v101, v230
  v_mul_f32 v231, v101, v231
  v_exp_f32 v75, v75
  v_mul_f32 v252, v101, v252
  v_mul_f32 v253, v101, v253
  v_fmamk_f32 v28, v28, 0x3dd53b95, v9
  v_mul_f32 v254, v101, v254
  v_mul_f32 v255, v101, v255
  v_add_f32 v15, v15, v75
  v_cvt_pk_bf16_f32 v27, v74, v75
  v_cvt_pk_bf16_f32 v180, v180, v181
  v_cvt_pk_bf16_f32 v181, v182, v183
  v_exp_f32 v28, v28
  v_cvt_pk_bf16_f32 v204, v204, v205
  v_cvt_pk_bf16_f32 v205, v206, v207
  v_cvt_pk_bf16_f32 v228, v228, v229
  v_fmamk_f32 v29, v29, 0x3dd53b95, v9
  v_cvt_pk_bf16_f32 v229, v230, v231
  v_cvt_pk_bf16_f32 v252, v252, v253
  v_add_f32 v16, v16, v28
  v_cvt_pk_bf16_f32 v253, v254, v255
  v_mbcnt_lo_u32_b32 v188, -1, 0
  v_exp_f32 v29, v29
  v_mbcnt_hi_u32_b32 v188, -1, v188
  v_lshrrev_b32 v189, 5, v188
  v_fmamk_f32 v30, v30, 0x3dd53b95, v9
  v_and_b32 v190, 7, v188
  v_xor_b32 v189, v189, v190
  v_lshlrev_b32 v189, 4, v189
  v_add_f32 v16, v16, v29
  v_cvt_pk_bf16_f32 v28, v28, v29
  v_and_b32 v190, 15, v188
  v_lshl_add_u32 v189, v190, 7, v189
  v_exp_f32 v30, v30
  v_bfe_u32 v190, v188, 4, 1
  v_lshl_add_u32 v189, v190, 3, v189
  v_fmamk_f32 v31, v31, 0x3dd53b95, v9
  v_add_u32 v184, s50, v189
  v_xor_b32 v185, 32, v184
  v_add_f32 v16, v16, v30
  v_xor_b32 v186, 64, v184
  v_xor_b32 v187, 96, v184
  s_waitcnt lgkmcnt(0)
  s_add_u32 s35, s51, 24576
  buffer_store_dwordx4 v[64:67], v104, s[20:23], s35 offen offset:0 sc1
  buffer_store_dwordx4 v[68:71], v104, s[20:23], s35 offen offset:3072 sc1
  ds_write2_b64 v102, v[180:181], v[204:205] offset0:0 offset1:4
  ds_write2_b64 v102, v[228:229], v[252:253] offset0:8 offset1:12
  ds_read_b128 v[64:67], v103 offset:0
  ds_read_b128 v[68:71], v103 offset:1152
  v_exp_f32 v31, v31
  v_accvgpr_read_b32 v48, a116
  v_accvgpr_read_b32 v49, a117
  v_accvgpr_read_b32 v50, a118
  v_fmamk_f32 v76, v76, 0x3dd53b95, v9
  v_accvgpr_read_b32 v51, a119
  v_mul_f32 v48, v101, v48
  v_add_f32 v16, v16, v31
  v_cvt_pk_bf16_f32 v29, v30, v31
  v_mul_f32 v49, v101, v49
  v_mul_f32 v50, v101, v50
  v_exp_f32 v76, v76
  v_mul_f32 v51, v101, v51
  v_mul_f32 v108, v101, v108
  v_fmamk_f32 v77, v77, 0x3dd53b95, v9
  v_mul_f32 v109, v101, v109
  v_mul_f32 v110, v101, v110
  v_add_f32 v16, v16, v76
  v_mul_f32 v111, v101, v111
  v_mul_f32 v132, v101, v132
  v_exp_f32 v77, v77
  v_mul_f32 v133, v101, v133
  v_mul_f32 v134, v101, v134
  v_mul_f32 v135, v101, v135
  v_fmamk_f32 v78, v78, 0x3dd53b95, v9
  v_mul_f32 v156, v101, v156
  v_mul_f32 v157, v101, v157
  v_add_f32 v16, v16, v77
  v_cvt_pk_bf16_f32 v30, v76, v77
  v_mul_f32 v158, v101, v158
  v_mul_f32 v159, v101, v159
  v_exp_f32 v78, v78
  v_cvt_pk_bf16_f32 v48, v48, v49
  v_cvt_pk_bf16_f32 v49, v50, v51
  v_fmamk_f32 v79, v79, 0x3dd53b95, v9
  v_cvt_pk_bf16_f32 v108, v108, v109
  v_cvt_pk_bf16_f32 v109, v110, v111
  v_add_f32 v16, v16, v78
  v_cvt_pk_bf16_f32 v132, v132, v133
  v_cvt_pk_bf16_f32 v133, v134, v135
  v_exp_f32 v79, v79
  v_cvt_pk_bf16_f32 v156, v156, v157
  v_cvt_pk_bf16_f32 v157, v158, v159
  s_waitcnt lgkmcnt(0)
  s_add_u32 s35, s51, 30720
  buffer_store_dwordx4 v[64:67], v104, s[20:23], s35 offen offset:256 sc1
  buffer_store_dwordx4 v[68:71], v104, s[20:23], s35 offen offset:3328 sc1
  ds_write_b64 v184, v[48:49] offset:0
  ds_write_b64 v185, v[108:109] offset:0
  ds_write_b64 v186, v[132:133] offset:0
  ds_write_b64 v187, v[156:157] offset:0
  v_fmamk_f32 v32, v32, 0x3dd53b95, v9
  v_accvgpr_read_b32 v48, a20
  v_accvgpr_read_b32 v49, a21
  v_accvgpr_read_b32 v50, a22
  v_add_f32 v16, v16, v79
  v_cvt_pk_bf16_f32 v31, v78, v79
  v_accvgpr_read_b32 v51, a23
  v_accvgpr_read_b32 v52, a44
  v_exp_f32 v32, v32
  v_accvgpr_read_b32 v53, a45
  v_accvgpr_read_b32 v54, a46
  v_fmamk_f32 v33, v33, 0x3dd53b95, v9
  v_accvgpr_read_b32 v55, a47
  v_accvgpr_read_b32 v56, a68
  v_add_f32 v17, v17, v32
  v_accvgpr_read_b32 v57, a69
  v_accvgpr_read_b32 v58, a70
  v_accvgpr_read_b32 v59, a71
  v_exp_f32 v33, v33
  v_accvgpr_read_b32 v60, a92
  v_accvgpr_read_b32 v61, a93
  v_fmamk_f32 v34, v34, 0x3dd53b95, v9
  v_accvgpr_read_b32 v62, a94
  v_accvgpr_read_b32 v63, a95
  v_add_f32 v17, v17, v33
  v_cvt_pk_bf16_f32 v32, v32, v33
  v_mul_f32 v48, v101, v48
  v_mul_f32 v49, v101, v49
  v_exp_f32 v34, v34
  v_mul_f32 v50, v101, v50
  v_mul_f32 v51, v101, v51
  v_fmamk_f32 v35, v35, 0x3dd53b95, v9
  v_mul_f32 v52, v101, v52
  v_mul_f32 v53, v101, v53
  v_mul_f32 v54, v101, v54
  v_add_f32 v17, v17, v34
  v_mul_f32 v55, v101, v55
  v_mul_f32 v56, v101, v56
  v_exp_f32 v35, v35
  v_mul_f32 v57, v101, v57
  v_mul_f32 v58, v101, v58
  v_fmamk_f32 v80, v80, 0x3dd53b95, v9
  v_mul_f32 v59, v101, v59
  v_mul_f32 v60, v101, v60
  v_add_f32 v17, v17, v35
  v_cvt_pk_bf16_f32 v33, v34, v35
  v_mul_f32 v61, v101, v61
  v_mul_f32 v62, v101, v62
  v_mul_f32 v63, v101, v63
  v_exp_f32 v80, v80
  v_cvt_pk_bf16_f32 v48, v48, v49
  v_cvt_pk_bf16_f32 v49, v50, v51
  v_fmamk_f32 v81, v81, 0x3dd53b95, v9
  v_cvt_pk_bf16_f32 v52, v52, v53
  v_cvt_pk_bf16_f32 v53, v54, v55
  v_add_f32 v17, v17, v80
  v_cvt_pk_bf16_f32 v56, v56, v57
  v_cvt_pk_bf16_f32 v57, v58, v59
  v_exp_f32 v81, v81
  v_cvt_pk_bf16_f32 v60, v60, v61
  v_cvt_pk_bf16_f32 v61, v62, v63
  ds_write_b64 v184, v[48:49] offset:2048
  ds_write_b64 v185, v[52:53] offset:2048
  ds_write_b64 v186, v[56:57] offset:2048
  ds_write_b64 v187, v[60:61] offset:2048
  s_add_u32 s26, s26, 12288
  s_cmp_eq_u32 s26, s57
  s_cselect_b32 s26, s56, s26
  s_add_u32 s27, s27, 12288
  s_cmp_eq_u32 s27, s59
  s_cselect_b32 s27, s58, s27
  s_waitcnt vmcnt(47) lgkmcnt(0)
  s_barrier
  ds_read_b128 a[236:239], v0 offset:12288
  ds_read_b128 a[248:251], v2 offset:0
  ds_read_b128 a[252:255], v2 offset:2048
  ds_read_b128 a[240:243], v0 offset:14336
  v_fmamk_f32 v82, v82, 0x3dd53b95, v9
  v_add_f32 v17, v17, v81
  v_cvt_pk_bf16_f32 v34, v80, v81
  v_exp_f32 v82, v82
  v_fmamk_f32 v83, v83, 0x3dd53b95, v9
  v_add_f32 v17, v17, v82
  v_exp_f32 v83, v83
  v_fmamk_f32 v36, v36, 0x3dd53b95, v9
  v_add_f32 v17, v17, v83
  v_cvt_pk_bf16_f32 v35, v82, v83
  v_exp_f32 v36, v36
  v_fmamk_f32 v37, v37, 0x3dd53b95, v9
  v_add_f32 v18, v18, v36
  v_exp_f32 v37, v37
  s_waitcnt lgkmcnt(3)
  s_branch L_q1
L_aw0:
  s_waitcnt vmcnt(5)
  s_branch L_ar0
L_aw1:
  s_waitcnt vmcnt(5)
  s_branch L_ar1
L_aw2:
  s_waitcnt vmcnt(5)
  s_branch L_ar2
L_aw3:
  s_waitcnt vmcnt(5)
  s_branch L_ar3
L_aw4:
  s_waitcnt vmcnt(5)
  s_branch L_ar4
L_aw5:
  s_waitcnt vmcnt(5)
  s_branch L_ar5
L_aw6:
  s_waitcnt vmcnt(5)
  s_branch L_ar6
L_aw7:
  s_waitcnt vmcnt(5)
  s_branch L_ar7
L_aw8:
  s_waitcnt vmcnt(5)
  s_branch L_ar8
L_aw9:
  s_waitcnt vmcnt(5)
  s_branch L_ar9
L_aw10:
  s_waitcnt vmcnt(5)
  s_branch L_ar10
L_aw11:
  s_waitcnt vmcnt(5)
  s_branch L_ar11
L_aw12:
  s_waitcnt vmcnt(5)
  s_branch L_ar12
L_aw13:
  s_waitcnt vmcnt(5)
  s_branch L_ar13
L_aw14:
  s_waitcnt vmcnt(5)
  s_branch L_ar14
L_aw15:
  s_waitcnt vmcnt(5)
  s_branch L_ar15
L_aw16:
  s_waitcnt vmcnt(5)
  s_branch L_ar16
L_aw17:
  s_waitcnt vmcnt(5)
  s_branch L_ar17
L_aw18:
  s_waitcnt vmcnt(5)
  s_branch L_ar18
L_aw19:
  s_waitcnt vmcnt(5)
  s_branch L_ar19
L_aw20:
  s_waitcnt vmcnt(5)
  s_branch L_ar20
L_aw21:
  s_waitcnt vmcnt(5)
  s_branch L_ar21
L_aw22:
  s_waitcnt vmcnt(5)
  s_branch L_ar22
L_aw23:
  s_waitcnt vmcnt(5)
  s_branch L_ar23
L_aw24:
  s_waitcnt vmcnt(5)
  s_branch L_ar24
L_aw25:
  s_waitcnt vmcnt(5)
  s_branch L_ar25
L_aw26:
  s_waitcnt vmcnt(5)
  s_branch L_ar26
L_aw27:
  s_waitcnt vmcnt(5)
  s_branch L_ar27
L_aw28:
  s_waitcnt vmcnt(5)
  s_branch L_ar28
L_tail:
  v_mfma_f32_16x16x32_bf16 a[0:3], a[236:239], v[24:27], a[0:3]
  ds_read_b64_tr_b16 a[244:245], v6 offset:12288
  v_mul_f32 v50, s30, v50
  v_mbcnt_lo_u32_b32 v94, -1, 0
  v_mfma_f32_16x16x32_bf16 a[4:7], a[236:239], v[28:31], a[4:7]
  v_add_f32 v15, v15, v49
  v_cvt_pk_bf16_f32 v48, v48, v49
  v_mbcnt_hi_u32_b32 v94, -1, v94
  v_mfma_f32_16x16x32_bf16 a[8:11], a[236:239], v[32:35], a[8:11]
  v_exp_f32 v50, v50
  v_lshrrev_b32 v95, 3, v94
  v_mfma_f32_16x16x32_bf16 a[12:15], a[236:239], v[36:39], a[12:15]
  ds_read_b64_tr_b16 a[246:247], v6 offset:14336
  v_mul_f32 v51, s30, v51
  v_and_b32 v94, 7, v94
  v_mfma_f32_16x16x32_bf16 a[16:19], a[236:239], v[40:43], a[16:19]
  v_add_f32 v15, v15, v50
  v_xor_b32 v92, v94, v95
  v_mfma_f32_16x16x32_bf16 a[20:23], a[236:239], v[44:47], a[20:23]
  s_waitcnt lgkmcnt(2)
  v_exp_f32 v51, v51
  v_lshlrev_b32 v92, 4, v92
  v_mfma_f32_16x16x32_bf16 a[44:47], a[240:243], v[44:47], a[44:47]
  ds_read_b64_tr_b16 a[236:237], v7 offset:12288
  v_mul_f32 v72, s30, v72
  v_lshl_add_u32 v92, v95, 7, v92
  v_mfma_f32_16x16x32_bf16 a[40:43], a[240:243], v[40:43], a[40:43]
  v_add_f32 v15, v15, v51
  v_cvt_pk_bf16_f32 v49, v50, v51
  v_add_u32 v92, s50, v92
  v_mfma_f32_16x16x32_bf16 a[36:39], a[240:243], v[36:39], a[36:39]
  v_exp_f32 v72, v72
  v_mul_u32_u24 v95, 384, v95
  v_mfma_f32_16x16x32_bf16 a[32:35], a[240:243], v[32:35], a[32:35]
  ds_read_b64_tr_b16 a[238:239], v7 offset:14336
  v_mul_f32 v73, s30, v73
  v_lshl_add_u32 v93, v94, 4, v95
  v_mfma_f32_16x16x32_bf16 a[28:31], a[240:243], v[28:31], a[28:31]
  ds_read_b128 v[84:87], v92 offset:0
  v_add_f32 v15, v15, v72
  v_mfma_f32_16x16x32_bf16 a[24:27], a[240:243], v[24:27], a[24:27]
  s_waitcnt lgkmcnt(3)
  v_exp_f32 v73, v73
  v_mfma_f32_16x16x32_bf16 a[48:51], a[244:247], v[24:27], a[48:51]
  ds_read_b64_tr_b16 a[240:241], v4 offset:16384
  v_mul_f32 v74, s30, v74
  v_mfma_f32_16x16x32_bf16 a[52:55], a[244:247], v[28:31], a[52:55]
  ds_read_b128 v[88:91], v92 offset:1024
  v_add_f32 v15, v15, v73
  v_cvt_pk_bf16_f32 v50, v72, v73
  v_mfma_f32_16x16x32_bf16 a[56:59], a[244:247], v[32:35], a[56:59]
  s_add_u32 s35, s51, 30720
  v_exp_f32 v74, v74
  v_mfma_f32_16x16x32_bf16 a[60:63], a[244:247], v[36:39], a[60:63]
  ds_read_b64_tr_b16 a[242:243], v4 offset:18432
  v_mul_f32 v75, s30, v75
  v_mfma_f32_16x16x32_bf16 a[64:67], a[244:247], v[40:43], a[64:67]
  v_add_f32 v15, v15, v74
  v_mfma_f32_16x16x32_bf16 a[68:71], a[244:247], v[44:47], a[68:71]
  s_waitcnt lgkmcnt(1)
  v_exp_f32 v75, v75
  v_mfma_f32_16x16x32_bf16 a[92:95], a[236:239], v[44:47], a[92:95]
  ds_read_b64_tr_b16 a[244:245], v5 offset:16384
  v_mul_f32 v52, s30, v52
  v_mfma_f32_16x16x32_bf16 a[88:91], a[236:239], v[40:43], a[88:91]
  buffer_store_dwordx4 v[84:87], v93, s[20:23], s35 offen offset:128 sc1
  v_add_f32 v15, v15, v75
  v_cvt_pk_bf16_f32 v51, v74, v75
  v_mfma_f32_16x16x32_bf16 a[84:87], a[236:239], v[36:39], a[84:87]
  v_exp_f32 v52, v52
  v_mfma_f32_16x16x32_bf16 a[80:83], a[236:239], v[32:35], a[80:83]
  ds_read_b64_tr_b16 a[246:247], v5 offset:18432
  v_mul_f32 v53, s30, v53
  v_mfma_f32_16x16x32_bf16 a[76:79], a[236:239], v[28:31], a[76:79]
  buffer_store_dwordx4 v[88:91], v93, s[20:23], s35 offen offset:3200 sc1
  v_add_f32 v16, v16, v52
  v_mfma_f32_16x16x32_bf16 a[72:75], a[236:239], v[24:27], a[72:75]
  s_waitcnt lgkmcnt(2)
  v_exp_f32 v53, v53
  v_mfma_f32_16x16x32_bf16 a[96:99], a[240:243], v[24:27], a[96:99]
  ds_read_b64_tr_b16 a[236:237], v6 offset:16384
  v_mul_f32 v54, s30, v54
  v_mfma_f32_16x16x32_bf16 a[100:103], a[240:243], v[28:31], a[100:103]
  v_add_f32 v16, v16, v53
  v_cvt_pk_bf16_f32 v52, v52, v53
  v_mfma_f32_16x16x32_bf16 a[104:107], a[240:243], v[32:35], a[104:107]
  v_exp_f32 v54, v54
  v_mfma_f32_16x16x32_bf16 a[108:111], a[240:243], v[36:39], a[108:111]
  ds_read_b64_tr_b16 a[238:239], v6 offset:18432
  v_mul_f32 v55, s30, v55
  v_mfma_f32_16x16x32_bf16 a[112:115], a[240:243], v[40:43], a[112:115]
  ds_read_b128 v[84:87], v92 offset:2048
  v_add_f32 v16, v16, v54
  v_mfma_f32_16x16x32_bf16 a[116:119], a[240:243], v[44:47], a[116:119]
  s_waitcnt lgkmcnt(3)
  v_exp_f32 v55, v55
  v_mfma_f32_16x16x32_bf16 v[108:111], a[244:247], v[44:47], v[108:111]
  ds_read_b64_tr_b16 a[240:241], v7 offset:16384
  v_mul_f32 v76, s30, v76
  v_mfma_f32_16x16x32_bf16 a[136:139], a[244:247], v[40:43], a[136:139]
  ds_read_b128 v[88:91], v92 offset:3072
  v_add_f32 v16, v16, v55
  v_cvt_pk_bf16_f32 v53, v54, v55
  v_mfma_f32_16x16x32_bf16 a[132:135], a[244:247], v[36:39], a[132:135]
  s_add_u32 s35, s51, 30720
  v_exp_f32 v76, v76
  v_mfma_f32_16x16x32_bf16 a[128:131], a[244:247], v[32:35], a[128:131]
  ds_read_b64_tr_b16 a[242:243], v7 offset:18432
  v_mul_f32 v77, s30, v77
  v_mfma_f32_16x16x32_bf16 a[124:127], a[244:247], v[28:31], a[124:127]
  v_add_f32 v16, v16, v76
  v_mfma_f32_16x16x32_bf16 a[120:123], a[244:247], v[24:27], a[120:123]
  s_waitcnt lgkmcnt(1)
  v_exp_f32 v77, v77
  v_mfma_f32_16x16x32_bf16 v[112:115], a[236:239], v[24:27], v[112:115]
  ds_read_b64_tr_b16 a[244:245], v4 offset:20480
  v_mul_f32 v78, s30, v78
  v_mfma_f32_16x16x32_bf16 v[116:119], a[236:239], v[28:31], v[116:119]
  buffer_store_dwordx4 v[84:87], v93, s[20:23], s35 offen offset:0 sc1
  v_add_f32 v16, v16, v77
  v_cvt_pk_bf16_f32 v54, v76, v77
  v_mfma_f32_16x16x32_bf16 v[120:123], a[236:239], v[32:35], v[120:123]
  v_exp_f32 v78, v78
  v_mfma_f32_16x16x32_bf16 v[124:127], a[236:239], v[36:39], v[124:127]
  ds_read_b64_tr_b16 a[246:247], v4 offset:22528
  v_mul_f32 v79, s30, v79
  v_mfma_f32_16x16x32_bf16 v[128:131], a[236:239], v[40:43], v[128:131]
  buffer_store_dwordx4 v[88:91], v93, s[20:23], s35 offen offset:3072 sc1
  v_add_f32 v16, v16, v78
  v_mfma_f32_16x16x32_bf16 v[132:135], a[236:239], v[44:47], v[132:135]
  s_waitcnt lgkmcnt(2)
  v_exp_f32 v79, v79
  v_mfma_f32_16x16x32_bf16 v[156:159], a[240:243], v[44:47], v[156:159]
  ds_read_b64_tr_b16 a[236:237], v5 offset:20480
  v_mul_f32 v56, s30, v56
  v_mfma_f32_16x16x32_bf16 v[152:155], a[240:243], v[40:43], v[152:155]
  v_add_f32 v16, v16, v79
  v_cvt_pk_bf16_f32 v55, v78, v79
  v_mfma_f32_16x16x32_bf16 v[148:151], a[240:243], v[36:39], v[148:151]
  v_exp_f32 v56, v56
  v_mfma_f32_16x16x32_bf16 v[144:147], a[240:243], v[32:35], v[144:147]
  ds_read_b64_tr_b16 a[238:239], v5 offset:22528
  v_mul_f32 v57, s30, v57
  v_mfma_f32_16x16x32_bf16 v[140:143], a[240:243], v[28:31], v[140:143]
  v_add_f32 v17, v17, v56
  v_mfma_f32_16x16x32_bf16 v[136:139], a[240:243], v[24:27], v[136:139]
  s_waitcnt lgkmcnt(2)
  v_exp_f32 v57, v57
  v_mfma_f32_16x16x32_bf16 v[160:163], a[244:247], v[24:27], v[160:163]
  ds_read_b64_tr_b16 a[240:241], v6 offset:20480
  v_mul_f32 v58, s30, v58
  v_mfma_f32_16x16x32_bf16 v[164:167], a[244:247], v[28:31], v[164:167]
  v_add_f32 v17, v17, v57
  v_cvt_pk_bf16_f32 v56, v56, v57
  v_mfma_f32_16x16x32_bf16 v[168:171], a[244:247], v[32:35], v[168:171]
  v_exp_f32 v58, v58
  v_mfma_f32_16x16x32_bf16 v[172:175], a[244:247], v[36:39], v[172:175]
  ds_read_b64_tr_b16 a[242:243], v6 offset:22528
  v_mul_f32 v59, s30, v59
  v_mfma_f32_16x16x32_bf16 v[176:179], a[244:247], v[40:43], v[176:179]
  v_add_f32 v17, v17, v58
  v_mfma_f32_16x16x32_bf16 v[180:183], a[244:247], v[44:47], v[180:183]
  s_waitcnt lgkmcnt(2)
  v_exp_f32 v59, v59
  v_mfma_f32_16x16x32_bf16 v[204:207], a[236:239], v[44:47], v[204:207]
  ds_read_b64_tr_b16 a[244:245], v7 offset:20480
  v_mul_f32 v80, s30, v80
  v_mfma_f32_16x16x32_bf16 v[200:203], a[236:239], v[40:43], v[200:203]
  v_add_f32 v17, v17, v59
  v_cvt_pk_bf16_f32 v57, v58, v59
  v_mfma_f32_16x16x32_bf16 v[196:199], a[236:239], v[36:39], v[196:199]
  s_mov_b32 s51, s29
  v_exp_f32 v80, v80
  v_mfma_f32_16x16x32_bf16 v[192:195], a[236:239], v[32:35], v[192:195]
  ds_read_b64_tr_b16 a[246:247], v7 offset:22528
  v_mul_f32 v81, s30, v81
  v_mfma_f32_16x16x32_bf16 v[188:191], a[236:239], v[28:31], v[188:191]
  v_add_f32 v17, v17, v80
  v_mfma_f32_16x16x32_bf16 v[184:187], a[236:239], v[24:27], v[184:187]
  s_waitcnt lgkmcnt(2)
  v_exp_f32 v81, v81
  v_mfma_f32_16x16x32_bf16 v[208:211], a[240:243], v[24:27], v[208:211]
  v_mul_f32 v82, s30, v82
  v_mul_f32 v83, s30, v83
  v_mfma_f32_16x16x32_bf16 v[212:215], a[240:243], v[28:31], v[212:215]
  v_add_f32 v17, v17, v81
  v_cvt_pk_bf16_f32 v58, v80, v81
  v_mfma_f32_16x16x32_bf16 v[216:219], a[240:243], v[32:35], v[216:219]
  s_waitcnt vmcnt(10) lgkmcnt(0)
  v_exp_f32 v82, v82
  v_mfma_f32_16x16x32_bf16 v[220:223], a[240:243], v[36:39], v[220:223]
  s_barrier
  v_mfma_f32_16x16x32_bf16 v[224:227], a[240:243], v[40:43], v[224:227]
  ds_read_b128 a[236:239], v0 offset:24576
  v_add_f32 v17, v17, v82
  v_mfma_f32_16x16x32_bf16 v[228:231], a[240:243], v[44:47], v[228:231]
  v_exp_f32 v83, v83
  v_mfma_f32_16x16x32_bf16 v[252:255], a[244:247], v[44:47], v[252:255]
  v_mul_f32 v60, s30, v60
  v_mfma_f32_16x16x32_bf16 v[248:251], a[244:247], v[40:43], v[248:251]
  v_add_f32 v17, v17, v83
  v_cvt_pk_bf16_f32 v59, v82, v83
  v_mfma_f32_16x16x32_bf16 v[244:247], a[244:247], v[36:39], v[244:247]
  v_exp_f32 v60, v60
  v_mfma_f32_16x16x32_bf16 v[240:243], a[244:247], v[32:35], v[240:243]
  v_mul_f32 v61, s30, v61
  v_mfma_f32_16x16x32_bf16 v[236:239], a[244:247], v[28:31], v[236:239]
  ds_read_b128 a[240:243], v0 offset:26624
  v_add_f32 v18, v18, v60
  v_mfma_f32_16x16x32_bf16 v[232:235], a[244:247], v[24:27], v[232:235]
  s_waitcnt lgkmcnt(1)
  v_exp_f32 v61, v61
  v_mfma_f32_16x16x32_bf16 v[24:27], a[236:239], a[140:143], v[10:13]
  ds_read_b128 a[244:247], v1 offset:24576
  v_mul_f32 v62, s30, v62
  v_mfma_f32_16x16x32_bf16 v[28:31], a[236:239], a[164:167], v[10:13]
  v_add_f32 v18, v18, v61
  v_cvt_pk_bf16_f32 v60, v60, v61
  v_mfma_f32_16x16x32_bf16 v[32:35], a[236:239], a[188:191], v[10:13]
  s_waitcnt lgkmcnt(1)
  v_exp_f32 v62, v62
  v_mfma_f32_16x16x32_bf16 v[80:83], a[240:243], a[188:191], v[10:13]
  ds_read_b128 a[236:239], v1 offset:26624
  v_mul_f32 v63, s30, v63
  v_mfma_f32_16x16x32_bf16 v[76:79], a[240:243], a[164:167], v[10:13]
  v_add_f32 v18, v18, v62
  v_mfma_f32_16x16x32_bf16 v[72:75], a[240:243], a[140:143], v[10:13]
  s_waitcnt lgkmcnt(1)
  v_exp_f32 v63, v63
  v_mfma_f32_16x16x32_bf16 v[24:27], a[244:247], a[144:147], v[24:27]
  ds_read_b128 a[240:243], v0 offset:28672
  v_mul_f32 v96, s30, v96
  v_mfma_f32_16x16x32_bf16 v[28:31], a[244:247], a[168:171], v[28:31]
  v_add_f32 v18, v18, v63
  v_cvt_pk_bf16_f32 v61, v62, v63
  v_mfma_f32_16x16x32_bf16 v[32:35], a[244:247], a[192:195], v[32:35]
  s_waitcnt lgkmcnt(1)
  v_exp_f32 v96, v96
  v_mfma_f32_16x16x32_bf16 v[80:83], a[236:239], a[192:195], v[80:83]
  ds_read_b128 a[244:247], v0 offset:30720
  v_mul_f32 v97, s30, v97
  v_mfma_f32_16x16x32_bf16 v[76:79], a[236:239], a[168:171], v[76:79]
  v_add_f32 v18, v18, v96
  v_mfma_f32_16x16x32_bf16 v[72:75], a[236:239], a[144:147], v[72:75]
  s_waitcnt lgkmcnt(1)
  v_exp_f32 v97, v97
  v_mfma_f32_16x16x32_bf16 v[24:27], a[240:243], a[148:151], v[24:27]
  ds_read_b128 a[236:239], v1 offset:28672
  v_mul_f32 v98, s30, v98
  v_mfma_f32_16x16x32_bf16 v[28:31], a[240:243], a[172:175], v[28:31]
  v_add_f32 v18, v18, v97
  v_cvt_pk_bf16_f32 v62, v96, v97
  v_mfma_f32_16x16x32_bf16 v[32:35], a[240:243], a[196:199], v[32:35]
  s_waitcnt lgkmcnt(1)
  v_exp_f32 v98, v98
  v_mfma_f32_16x16x32_bf16 v[80:83], a[244:247], a[196:199], v[80:83]
  ds_read_b128 a[240:243], v1 offset:30720
  v_mul_f32 v99, s30, v99
  v_mfma_f32_16x16x32_bf16 v[76:79], a[244:247], a[172:175], v[76:79]
  v_add_f32 v18, v18, v98
  v_mfma_f32_16x16x32_bf16 v[72:75], a[244:247], a[148:151], v[72:75]
  s_waitcnt lgkmcnt(1)
  v_exp_f32 v99, v99
  v_mfma_f32_16x16x32_bf16 v[24:27], a[236:239], a[152:155], v[24:27]
  ds_read_b128 a[244:247], v0 offset:32768
  v_mul_f32 v64, s30, v64
  v_mfma_f32_16x16x32_bf16 v[28:31], a[236:239], a[176:179], v[28:31]
  v_add_f32 v18, v18, v99
  v_cvt_pk_bf16_f32 v63, v98, v99
  v_mfma_f32_16x16x32_bf16 v[32:35], a[236:239], a[200:203], v[32:35]
  s_waitcnt lgkmcnt(1)
  v_exp_f32 v64, v64
  v_mfma_f32_16x16x32_bf16 v[80:83], a[240:243], a[200:203], v[80:83]
  ds_read_b128 a[236:239], v0 offset:34816
  v_mul_f32 v65, s30, v65
  v_mfma_f32_16x16x32_bf16 v[76:79], a[240:243], a[176:179], v[76:79]
  v_add_f32 v19, v19, v64
  v_mfma_f32_16x16x32_bf16 v[72:75], a[240:243], a[152:155], v[72:75]
  s_waitcnt lgkmcnt(1)
  v_exp_f32 v65, v65
  v_mfma_f32_16x16x32_bf16 v[24:27], a[244:247], a[156:159], v[24:27]
  ds_read_b128 a[240:243], v1 offset:32768
  v_mul_f32 v66, s30, v66
  v_mfma_f32_16x16x32_bf16 v[28:31], a[244:247], a[180:183], v[28:31]
  v_add_f32 v19, v19, v65
  v_cvt_pk_bf16_f32 v64, v64, v65
  v_mfma_f32_16x16x32_bf16 v[32:35], a[244:247], a[204:207], v[32:35]
  s_waitcnt lgkmcnt(1)
  v_exp_f32 v66, v66
  v_mfma_f32_16x16x32_bf16 v[80:83], a[236:239], a[204:207], v[80:83]
  ds_read_b128 a[244:247], v1 offset:34816
  v_mul_f32 v67, s30, v67
  v_mfma_f32_16x16x32_bf16 v[76:79], a[236:239], a[180:183], v[76:79]
  v_add_f32 v19, v19, v66
  v_mfma_f32_16x16x32_bf16 v[72:75], a[236:239], a[156:159], v[72:75]
  s_waitcnt lgkmcnt(1)
  v_exp_f32 v67, v67
  v_mfma_f32_16x16x32_bf16 v[24:27], a[240:243], a[160:163], v[24:27]
  ds_read_b128 a[236:239], v0 offset:36864
  v_mul_f32 v100, s30, v100
  v_mfma_f32_16x16x32_bf16 v[28:31], a[240:243], a[184:187], v[28:31]
  v_add_f32 v19, v19, v67
  v_cvt_pk_bf16_f32 v65, v66, v67
  v_mfma_f32_16x16x32_bf16 v[32:35], a[240:243], a[208:211], v[32:35]
  s_waitcnt lgkmcnt(1)
  v_exp_f32 v100, v100
  v_mfma_f32_16x16x32_bf16 v[80:83], a[244:247], a[208:211], v[80:83]
  ds_read_b128 a[240:243], v0 offset:38912
  v_mul_f32 v101, s30, v101
  v_mfma_f32_16x16x32_bf16 v[76:79], a[244:247], a[184:187], v[76:79]
  v_add_f32 v19, v19, v100
  v_mfma_f32_16x16x32_bf16 v[72:75], a[244:247], a[160:163], v[72:75]
  s_waitcnt lgkmcnt(1)
  v_exp_f32 v101, v101
  v_mfma_f32_16x16x32_bf16 v[36:39], a[236:239], a[140:143], v[10:13]
  ds_read_b128 a[244:247], v1 offset:36864
  v_mul_f32 v102, s30, v102
  v_mfma_f32_16x16x32_bf16 v[40:43], a[236:239], a[164:167], v[10:13]
  v_add_f32 v19, v19, v101
  v_cvt_pk_bf16_f32 v66, v100, v101
  v_mfma_f32_16x16x32_bf16 v[44:47], a[236:239], a[188:191], v[10:13]
  s_waitcnt lgkmcnt(1)
  v_exp_f32 v102, v102
  v_mfma_f32_16x16x32_bf16 v[92:95], a[240:243], a[188:191], v[10:13]
  ds_read_b128 a[236:239], v1 offset:38912
  v_mul_f32 v103, s30, v103
  v_mfma_f32_16x16x32_bf16 v[88:91], a[240:243], a[164:167], v[10:13]
  v_add_f32 v19, v19, v102
  v_mfma_f32_16x16x32_bf16 v[84:87], a[240:243], a[140:143], v[10:13]
  s_waitcnt lgkmcnt(1)
  v_exp_f32 v103, v103
  v_mfma_f32_16x16x32_bf16 v[36:39], a[244:247], a[144:147], v[36:39]
  ds_read_b128 a[240:243], v0 offset:40960
  v_mul_f32 v68, s30, v68
  v_mfma_f32_16x16x32_bf16 v[40:43], a[244:247], a[168:171], v[40:43]
  v_add_f32 v19, v19, v103
  v_cvt_pk_bf16_f32 v67, v102, v103
  v_mfma_f32_16x16x32_bf16 v[44:47], a[244:247], a[192:195], v[44:47]
  s_waitcnt lgkmcnt(1)
  v_exp_f32 v68, v68
  v_mfma_f32_16x16x32_bf16 v[92:95], a[236:239], a[192:195], v[92:95]
  ds_read_b128 a[244:247], v0 offset:43008
  v_mul_f32 v69, s30, v69
  v_mfma_f32_16x16x32_bf16 v[88:91], a[236:239], a[168:171], v[88:91]
  v_add_f32 v20, v20, v68
  v_mfma_f32_16x16x32_bf16 v[84:87], a[236:239], a[144:147], v[84:87]
  s_waitcnt lgkmcnt(1)
  v_exp_f32 v69, v69
  v_mfma_f32_16x16x32_bf16 v[36:39], a[240:243], a[148:151], v[36:39]
  ds_read_b128 a[236:239], v1 offset:40960
  v_mul_f32 v70, s30, v70
  v_mfma_f32_16x16x32_bf16 v[40:43], a[240:243], a[172:175], v[40:43]
  v_add_f32 v20, v20, v69
  v_cvt_pk_bf16_f32 v68, v68, v69
  v_mfma_f32_16x16x32_bf16 v[44:47], a[240:243], a[196:199], v[44:47]
  s_waitcnt lgkmcnt(1)
  v_exp_f32 v70, v70
  v_mfma_f32_16x16x32_bf16 v[92:95], a[244:247], a[196:199], v[92:95]
  ds_read_b128 a[240:243], v1 offset:43008
  v_mul_f32 v71, s30, v71
  v_mfma_f32_16x16x32_bf16 v[88:91], a[244:247], a[172:175], v[88:91]
  v_add_f32 v20, v20, v70
  v_mfma_f32_16x16x32_bf16 v[84:87], a[244:247], a[148:151], v[84:87]
  s_waitcnt lgkmcnt(1)
  v_exp_f32 v71, v71
  v_mfma_f32_16x16x32_bf16 v[36:39], a[236:239], a[152:155], v[36:39]
  ds_read_b128 a[244:247], v0 offset:45056
  v_mul_f32 v104, s30, v104
  v_mfma_f32_16x16x32_bf16 v[40:43], a[236:239], a[176:179], v[40:43]
  v_add_f32 v20, v20, v71
  v_cvt_pk_bf16_f32 v69, v70, v71
  v_mfma_f32_16x16x32_bf16 v[44:47], a[236:239], a[200:203], v[44:47]
  s_waitcnt lgkmcnt(1)
  v_exp_f32 v104, v104
  v_mfma_f32_16x16x32_bf16 v[92:95], a[240:243], a[200:203], v[92:95]
  ds_read_b128 a[236:239], v0 offset:47104
  v_mul_f32 v105, s30, v105
  v_mfma_f32_16x16x32_bf16 v[88:91], a[240:243], a[176:179], v[88:91]
  v_add_f32 v20, v20, v104
  v_mfma_f32_16x16x32_bf16 v[84:87], a[240:243], a[152:155], v[84:87]
  s_waitcnt lgkmcnt(1)
  v_exp_f32 v105, v105
  v_mfma_f32_16x16x32_bf16 v[36:39], a[244:247], a[156:159], v[36:39]
  ds_read_b128 a[240:243], v1 offset:45056
  v_mul_f32 v106, s30, v106
  v_mfma_f32_16x16x32_bf16 v[40:43], a[244:247], a[180:183], v[40:43]
  v_add_f32 v20, v20, v105
  v_cvt_pk_bf16_f32 v70, v104, v105
  v_mfma_f32_16x16x32_bf16 v[44:47], a[244:247], a[204:207], v[44:47]
  s_waitcnt lgkmcnt(1)
  v_exp_f32 v106, v106
  v_mfma_f32_16x16x32_bf16 v[92:95], a[236:239], a[204:207], v[92:95]
  ds_read_b128 a[244:247], v1 offset:47104
  v_mul_f32 v107, s30, v107
  v_mfma_f32_16x16x32_bf16 v[88:91], a[236:239], a[180:183], v[88:91]
  v_add_f32 v20, v20, v106
  v_mfma_f32_16x16x32_bf16 v[84:87], a[236:239], a[156:159], v[84:87]
  s_waitcnt lgkmcnt(1)
  v_exp_f32 v107, v107
  v_mfma_f32_16x16x32_bf16 v[36:39], a[240:243], a[160:163], v[36:39]
  ds_read_b64_tr_b16 a[236:237], v4 offset:24576
  v_mul_f32 v24, s30, v24
  v_mfma_f32_16x16x32_bf16 v[40:43], a[240:243], a[184:187], v[40:43]
  ds_read_b64_tr_b16 a[238:239], v4 offset:26624
  v_add_f32 v20, v20, v107
  v_cvt_pk_bf16_f32 v71, v106, v107
  v_mfma_f32_16x16x32_bf16 v[44:47], a[240:243], a[208:211], v[44:47]
  s_waitcnt lgkmcnt(2)
  v_exp_f32 v24, v24
  v_mfma_f32_16x16x32_bf16 v[92:95], a[244:247], a[208:211], v[92:95]
  ds_read_b64_tr_b16 a[240:241], v5 offset:24576
  v_mul_f32 v25, s30, v25
  v_mfma_f32_16x16x32_bf16 v[88:91], a[244:247], a[184:187], v[88:91]
  ds_read_b64_tr_b16 a[242:243], v5 offset:26624
  v_add_f32 v15, v15, v24
  v_mfma_f32_16x16x32_bf16 v[84:87], a[244:247], a[160:163], v[84:87]
  s_waitcnt lgkmcnt(2)
  v_exp_f32 v25, v25
  v_mfma_f32_16x16x32_bf16 a[0:3], a[236:239], v[48:51], a[0:3]
  ds_read_b64_tr_b16 a[244:245], v6 offset:24576
  v_mul_f32 v26, s30, v26
  v_mfma_f32_16x16x32_bf16 a[4:7], a[236:239], v[52:55], a[4:7]
  v_add_f32 v15, v15, v25
  v_cvt_pk_bf16_f32 v24, v24, v25
  v_mfma_f32_16x16x32_bf16 a[8:11], a[236:239], v[56:59], a[8:11]
  v_exp_f32 v26, v26
  v_mfma_f32_16x16x32_bf16 a[12:15], a[236:239], v[60:63], a[12:15]
  ds_read_b64_tr_b16 a[246:247], v6 offset:26624
  v_mul_f32 v27, s30, v27
  v_mfma_f32_16x16x32_bf16 a[16:19], a[236:239], v[64:67], a[16:19]
  ds_read_b128 a[140:143], v2 offset:0
  v_add_f32 v15, v15, v26
  v_mfma_f32_16x16x32_bf16 a[20:23], a[236:239], v[68:71], a[20:23]
  s_waitcnt lgkmcnt(3)
  v_exp_f32 v27, v27
  v_mfma_f32_16x16x32_bf16 a[44:47], a[240:243], v[68:71], a[44:47]
  ds_read_b64_tr_b16 a[236:237], v7 offset:24576
  v_mul_f32 v72, s30, v72
  v_mfma_f32_16x16x32_bf16 a[40:43], a[240:243], v[64:67], a[40:43]
  v_add_f32 v15, v15, v27
  v_cvt_pk_bf16_f32 v25, v26, v27
  v_mfma_f32_16x16x32_bf16 a[36:39], a[240:243], v[60:63], a[36:39]
  v_exp_f32 v72, v72
  v_mfma_f32_16x16x32_bf16 a[32:35], a[240:243], v[56:59], a[32:35]
  ds_read_b64_tr_b16 a[238:239], v7 offset:26624
  v_mul_f32 v73, s30, v73
  v_mfma_f32_16x16x32_bf16 a[28:31], a[240:243], v[52:55], a[28:31]
  ds_read_b128 a[164:167], v2 offset:2048
  v_add_f32 v15, v15, v72
  v_mfma_f32_16x16x32_bf16 a[24:27], a[240:243], v[48:51], a[24:27]
  s_waitcnt lgkmcnt(4)
  v_exp_f32 v73, v73
  v_mfma_f32_16x16x32_bf16 a[48:51], a[244:247], v[48:51], a[48:51]
  ds_read_b64_tr_b16 a[240:241], v4 offset:28672
  v_mul_f32 v74, s30, v74
  v_mfma_f32_16x16x32_bf16 a[52:55], a[244:247], v[52:55], a[52:55]
  v_add_f32 v15, v15, v73
  v_cvt_pk_bf16_f32 v26, v72, v73
  v_mfma_f32_16x16x32_bf16 a[56:59], a[244:247], v[56:59], a[56:59]
  v_exp_f32 v74, v74
  v_mfma_f32_16x16x32_bf16 a[60:63], a[244:247], v[60:63], a[60:63]
  ds_read_b64_tr_b16 a[242:243], v4 offset:30720
  v_mul_f32 v75, s30, v75
  v_mfma_f32_16x16x32_bf16 a[64:67], a[244:247], v[64:67], a[64:67]
  ds_read_b128 a[144:147], v3 offset:0
  v_add_f32 v15, v15, v74
  v_mfma_f32_16x16x32_bf16 a[68:71], a[244:247], v[68:71], a[68:71]
  s_waitcnt lgkmcnt(4)
  v_exp_f32 v75, v75
  v_mfma_f32_16x16x32_bf16 a[92:95], a[236:239], v[68:71], a[92:95]
  ds_read_b64_tr_b16 a[244:245], v5 offset:28672
  v_mul_f32 v28, s30, v28
  v_mfma_f32_16x16x32_bf16 a[88:91], a[236:239], v[64:67], a[88:91]
  v_add_f32 v15, v15, v75
  v_cvt_pk_bf16_f32 v27, v74, v75
  v_mfma_f32_16x16x32_bf16 a[84:87], a[236:239], v[60:63], a[84:87]
  v_exp_f32 v28, v28
  v_mfma_f32_16x16x32_bf16 a[80:83], a[236:239], v[56:59], a[80:83]
  ds_read_b64_tr_b16 a[246:247], v5 offset:30720
  v_mul_f32 v29, s30, v29
  v_mfma_f32_16x16x32_bf16 a[76:79], a[236:239], v[52:55], a[76:79]
  ds_read_b128 a[168:171], v3 offset:2048
  v_add_f32 v16, v16, v28
  v_mfma_f32_16x16x32_bf16 a[72:75], a[236:239], v[48:51], a[72:75]
  s_waitcnt lgkmcnt(4)
  v_exp_f32 v29, v29
  v_mfma_f32_16x16x32_bf16 a[96:99], a[240:243], v[48:51], a[96:99]
  ds_read_b64_tr_b16 a[236:237], v6 offset:28672
  v_mul_f32 v30, s30, v30
  v_mfma_f32_16x16x32_bf16 a[100:103], a[240:243], v[52:55], a[100:103]
  v_add_f32 v16, v16, v29
  v_cvt_pk_bf16_f32 v28, v28, v29
  v_mfma_f32_16x16x32_bf16 a[104:107], a[240:243], v[56:59], a[104:107]
  v_exp_f32 v30, v30
  v_mfma_f32_16x16x32_bf16 a[108:111], a[240:243], v[60:63], a[108:111]
  ds_read_b64_tr_b16 a[238:239], v6 offset:30720
  v_mul_f32 v31, s30, v31
  v_mfma_f32_16x16x32_bf16 a[112:115], a[240:243], v[64:67], a[112:115]
  ds_read_b128 a[148:151], v2 offset:4096
  v_add_f32 v16, v16, v30
  v_mfma_f32_16x16x32_bf16 a[116:119], a[240:243], v[68:71], a[116:119]
  s_waitcnt lgkmcnt(4)
  v_exp_f32 v31, v31
  v_mfma_f32_16x16x32_bf16 v[108:111], a[244:247], v[68:71], v[108:111]
  ds_read_b64_tr_b16 a[240:241], v7 offset:28672
  v_mul_f32 v76, s30, v76
  v_mfma_f32_16x16x32_bf16 a[136:139], a[244:247], v[64:67], a[136:139]
  v_add_f32 v16, v16, v31
  v_cvt_pk_bf16_f32 v29, v30, v31
  v_mfma_f32_16x16x32_bf16 a[132:135], a[244:247], v[60:63], a[132:135]
  v_exp_f32 v76, v76
  v_mfma_f32_16x16x32_bf16 a[128:131], a[244:247], v[56:59], a[128:131]
  ds_read_b64_tr_b16 a[242:243], v7 offset:30720
  v_mul_f32 v77, s30, v77
  v_mfma_f32_16x16x32_bf16 a[124:127], a[244:247], v[52:55], a[124:127]
  ds_read_b128 a[172:175], v2 offset:6144
  v_add_f32 v16, v16, v76
  v_mfma_f32_16x16x32_bf16 a[120:123], a[244:247], v[48:51], a[120:123]
  s_waitcnt lgkmcnt(4)
  v_exp_f32 v77, v77
  v_mfma_f32_16x16x32_bf16 v[112:115], a[236:239], v[48:51], v[112:115]
  ds_read_b64_tr_b16 a[244:245], v4 offset:32768
  v_mul_f32 v78, s30, v78
  v_mfma_f32_16x16x32_bf16 v[116:119], a[236:239], v[52:55], v[116:119]
  v_add_f32 v16, v16, v77
  v_cvt_pk_bf16_f32 v30, v76, v77
  v_mfma_f32_16x16x32_bf16 v[120:123], a[236:239], v[56:59], v[120:123]
  v_exp_f32 v78, v78
  v_mfma_f32_16x16x32_bf16 v[124:127], a[236:239], v[60:63], v[124:127]
  ds_read_b64_tr_b16 a[246:247], v4 offset:34816
  v_mul_f32 v79, s30, v79
  v_mfma_f32_16x16x32_bf16 v[128:131], a[236:239], v[64:67], v[128:131]
  ds_read_b128 a[152:155], v3 offset:4096
  v_add_f32 v16, v16, v78
  v_mfma_f32_16x16x32_bf16 v[132:135], a[236:239], v[68:71], v[132:135]
  s_waitcnt lgkmcnt(4)
  v_exp_f32 v79, v79
  v_mfma_f32_16x16x32_bf16 v[156:159], a[240:243], v[68:71], v[156:159]
  ds_read_b64_tr_b16 a[236:237], v5 offset:32768
  v_mul_f32 v32, s30, v32
  v_mfma_f32_16x16x32_bf16 v[152:155], a[240:243], v[64:67], v[152:155]
  v_add_f32 v16, v16, v79
  v_cvt_pk_bf16_f32 v31, v78, v79
  v_mfma_f32_16x16x32_bf16 v[148:151], a[240:243], v[60:63], v[148:151]
  v_exp_f32 v32, v32
  v_mfma_f32_16x16x32_bf16 v[144:147], a[240:243], v[56:59], v[144:147]
  ds_read_b64_tr_b16 a[238:239], v5 offset:34816
  v_mul_f32 v33, s30, v33
  v_mfma_f32_16x16x32_bf16 v[140:143], a[240:243], v[52:55], v[140:143]
  ds_read_b128 a[176:179], v3 offset:6144
  v_add_f32 v17, v17, v32
  v_mfma_f32_16x16x32_bf16 v[136:139], a[240:243], v[48:51], v[136:139]
  s_waitcnt lgkmcnt(4)
  v_exp_f32 v33, v33
  v_mfma_f32_16x16x32_bf16 v[160:163], a[244:247], v[48:51], v[160:163]
  ds_read_b64_tr_b16 a[240:241], v6 offset:32768
  v_mul_f32 v34, s30, v34
  v_mfma_f32_16x16x32_bf16 v[164:167], a[244:247], v[52:55], v[164:167]
  v_add_f32 v17, v17, v33
  v_cvt_pk_bf16_f32 v32, v32, v33
  v_mfma_f32_16x16x32_bf16 v[168:171], a[244:247], v[56:59], v[168:171]
  v_exp_f32 v34, v34
  v_mfma_f32_16x16x32_bf16 v[172:175], a[244:247], v[60:63], v[172:175]
  ds_read_b64_tr_b16 a[242:243], v6 offset:34816
  v_mul_f32 v35, s30, v35
  v_mfma_f32_16x16x32_bf16 v[176:179], a[244:247], v[64:67], v[176:179]
  ds_read_b128 a[156:159], v2 offset:8192
  v_add_f32 v17, v17, v34
  v_mfma_f32_16x16x32_bf16 v[180:183], a[244:247], v[68:71], v[180:183]
  s_waitcnt lgkmcnt(4)
  v_exp_f32 v35, v35
  v_mfma_f32_16x16x32_bf16 v[204:207], a[236:239], v[68:71], v[204:207]
  ds_read_b64_tr_b16 a[244:245], v7 offset:32768
  v_mul_f32 v80, s30, v80
  v_mfma_f32_16x16x32_bf16 v[200:203], a[236:239], v[64:67], v[200:203]
  v_add_f32 v17, v17, v35
  v_cvt_pk_bf16_f32 v33, v34, v35
  v_mfma_f32_16x16x32_bf16 v[196:199], a[236:239], v[60:63], v[196:199]
  v_exp_f32 v80, v80
  v_mfma_f32_16x16x32_bf16 v[192:195], a[236:239], v[56:59], v[192:195]
  ds_read_b64_tr_b16 a[246:247], v7 offset:34816
  v_mul_f32 v81, s30, v81
  v_mfma_f32_16x16x32_bf16 v[188:191], a[236:239], v[52:55], v[188:191]
  ds_read_b128 a[180:183], v2 offset:10240
  v_add_f32 v17, v17, v80
  v_mfma_f32_16x16x32_bf16 v[184:187], a[236:239], v[48:51], v[184:187]
  s_waitcnt lgkmcnt(4)
  v_exp_f32 v81, v81
  v_mfma_f32_16x16x32_bf16 v[208:211], a[240:243], v[48:51], v[208:211]
  ds_read_b128 a[236:239], v0 offset:24576
  v_mul_f32 v82, s30, v82
  v_mfma_f32_16x16x32_bf16 v[212:215], a[240:243], v[52:55], v[212:215]
  v_add_f32 v17, v17, v81
  v_cvt_pk_bf16_f32 v34, v80, v81
  v_mfma_f32_16x16x32_bf16 v[216:219], a[240:243], v[56:59], v[216:219]
  s_waitcnt vmcnt(4)
  v_exp_f32 v82, v82
  v_mfma_f32_16x16x32_bf16 v[220:223], a[240:243], v[60:63], v[220:223]
  v_mul_f32 v83, s30, v83
  v_mfma_f32_16x16x32_bf16 v[224:227], a[240:243], v[64:67], v[224:227]
  ds_read_b128 a[160:163], v3 offset:8192
  s_barrier
  v_add_f32 v17, v17, v82
  v_mfma_f32_16x16x32_bf16 v[228:231], a[240:243], v[68:71], v[228:231]
  s_waitcnt lgkmcnt(3)
  v_exp_f32 v83, v83
  v_mfma_f32_16x16x32_bf16 v[252:255], a[244:247], v[68:71], v[252:255]
  ds_read_b128 a[240:243], v0 offset:26624
  v_mul_f32 v36, s30, v36
  v_mfma_f32_16x16x32_bf16 v[248:251], a[244:247], v[64:67], v[248:251]
  v_add_f32 v17, v17, v83
  v_cvt_pk_bf16_f32 v35, v82, v83
  v_mfma_f32_16x16x32_bf16 v[244:247], a[244:247], v[60:63], v[244:247]
  v_exp_f32 v36, v36
  v_mfma_f32_16x16x32_bf16 v[240:243], a[244:247], v[56:59], v[240:243]
  v_mul_f32 v37, s30, v37
  v_mfma_f32_16x16x32_bf16 v[236:239], a[244:247], v[52:55], v[236:239]
  ds_read_b128 a[184:187], v3 offset:10240
  v_add_f32 v15, v15, v36
  v_mfma_f32_16x16x32_bf16 v[232:235], a[244:247], v[48:51], v[232:235]
  s_waitcnt lgkmcnt(3)
  v_exp_f32 v37, v37
  v_mfma_f32_16x16x32_bf16 v[48:51], a[236:239], a[212:215], v[10:13]
  ds_read_b128 a[244:247], v1 offset:24576
  v_mul_f32 v38, s30, v38
  v_mfma_f32_16x16x32_bf16 v[52:55], a[236:239], a[140:143], v[10:13]
  v_add_f32 v15, v15, v37
  v_cvt_pk_bf16_f32 v36, v36, v37
  v_mfma_f32_16x16x32_bf16 v[56:59], a[236:239], a[164:167], v[10:13]
  s_waitcnt lgkmcnt(2)
  v_exp_f32 v38, v38
  v_mfma_f32_16x16x32_bf16 v[104:107], a[240:243], a[164:167], v[10:13]
  ds_read_b128 a[236:239], v1 offset:26624
  v_mul_f32 v39, s30, v39
  v_mfma_f32_16x16x32_bf16 v[100:103], a[240:243], a[140:143], v[10:13]
  v_add_f32 v15, v15, v38
  v_mfma_f32_16x16x32_bf16 v[96:99], a[240:243], a[212:215], v[10:13]
  s_waitcnt lgkmcnt(1)
  v_exp_f32 v39, v39
  v_mfma_f32_16x16x32_bf16 v[48:51], a[244:247], a[216:219], v[48:51]
  ds_read_b128 a[240:243], v0 offset:28672
  v_mul_f32 v84, s30, v84
  v_mfma_f32_16x16x32_bf16 v[52:55], a[244:247], a[144:147], v[52:55]
  v_add_f32 v15, v15, v39
  v_cvt_pk_bf16_f32 v37, v38, v39
  v_mfma_f32_16x16x32_bf16 v[56:59], a[244:247], a[168:171], v[56:59]
  s_waitcnt lgkmcnt(1)
  v_exp_f32 v84, v84
  v_mfma_f32_16x16x32_bf16 v[104:107], a[236:239], a[168:171], v[104:107]
  ds_read_b128 a[244:247], v0 offset:30720
  v_mul_f32 v85, s30, v85
  v_mfma_f32_16x16x32_bf16 v[100:103], a[236:239], a[144:147], v[100:103]
  v_add_f32 v15, v15, v84
  v_mfma_f32_16x16x32_bf16 v[96:99], a[236:239], a[216:219], v[96:99]
  s_waitcnt lgkmcnt(1)
  v_exp_f32 v85, v85
  v_mfma_f32_16x16x32_bf16 v[48:51], a[240:243], a[220:223], v[48:51]
  ds_read_b128 a[236:239], v1 offset:28672
  v_mul_f32 v86, s30, v86
  v_mfma_f32_16x16x32_bf16 v[52:55], a[240:243], a[148:151], v[52:55]
  v_add_f32 v15, v15, v85
  v_cvt_pk_bf16_f32 v38, v84, v85
  v_mfma_f32_16x16x32_bf16 v[56:59], a[240:243], a[172:175], v[56:59]
  s_waitcnt lgkmcnt(1)
  v_exp_f32 v86, v86
  v_mfma_f32_16x16x32_bf16 v[104:107], a[244:247], a[172:175], v[104:107]
  ds_read_b128 a[240:243], v1 offset:30720
  v_mul_f32 v87, s30, v87
  v_mfma_f32_16x16x32_bf16 v[100:103], a[244:247], a[148:151], v[100:103]
  v_add_f32 v15, v15, v86
  v_mfma_f32_16x16x32_bf16 v[96:99], a[244:247], a[220:223], v[96:99]
  s_waitcnt lgkmcnt(1)
  v_exp_f32 v87, v87
  v_mfma_f32_16x16x32_bf16 v[48:51], a[236:239], a[224:227], v[48:51]
  ds_read_b128 a[244:247], v0 offset:32768
  v_mul_f32 v40, s30, v40
  v_mfma_f32_16x16x32_bf16 v[52:55], a[236:239], a[152:155], v[52:55]
  v_add_f32 v15, v15, v87
  v_cvt_pk_bf16_f32 v39, v86, v87
  v_mfma_f32_16x16x32_bf16 v[56:59], a[236:239], a[176:179], v[56:59]
  s_waitcnt lgkmcnt(1)
  v_exp_f32 v40, v40
  v_mfma_f32_16x16x32_bf16 v[104:107], a[240:243], a[176:179], v[104:107]
  ds_read_b128 a[236:239], v0 offset:34816
  v_mul_f32 v41, s30, v41
  v_mfma_f32_16x16x32_bf16 v[100:103], a[240:243], a[152:155], v[100:103]
  v_add_f32 v16, v16, v40
  v_mfma_f32_16x16x32_bf16 v[96:99], a[240:243], a[224:227], v[96:99]
  s_waitcnt lgkmcnt(1)
  v_exp_f32 v41, v41
  v_mfma_f32_16x16x32_bf16 v[48:51], a[244:247], a[228:231], v[48:51]
  ds_read_b128 a[240:243], v1 offset:32768
  v_mul_f32 v42, s30, v42
  v_mfma_f32_16x16x32_bf16 v[52:55], a[244:247], a[156:159], v[52:55]
  v_add_f32 v16, v16, v41
  v_cvt_pk_bf16_f32 v40, v40, v41
  v_mfma_f32_16x16x32_bf16 v[56:59], a[244:247], a[180:183], v[56:59]
  s_waitcnt lgkmcnt(1)
  v_exp_f32 v42, v42
  v_mfma_f32_16x16x32_bf16 v[104:107], a[236:239], a[180:183], v[104:107]
  ds_read_b128 a[244:247], v1 offset:34816
  v_mul_f32 v43, s30, v43
  v_mfma_f32_16x16x32_bf16 v[100:103], a[236:239], a[156:159], v[100:103]
  v_add_f32 v16, v16, v42
  v_mfma_f32_16x16x32_bf16 v[96:99], a[236:239], a[228:231], v[96:99]
  s_waitcnt lgkmcnt(1)
  v_exp_f32 v43, v43
  v_mfma_f32_16x16x32_bf16 v[48:51], a[240:243], a[232:235], v[48:51]
  ds_read_b64_tr_b16 a[236:237], v4 offset:36864
  v_mul_f32 v88, s30, v88
  v_mfma_f32_16x16x32_bf16 v[52:55], a[240:243], a[160:163], v[52:55]
  ds_read_b64_tr_b16 a[238:239], v4 offset:38912
  v_add_f32 v16, v16, v43
  v_cvt_pk_bf16_f32 v41, v42, v43
  v_mfma_f32_16x16x32_bf16 v[56:59], a[240:243], a[184:187], v[56:59]
  s_waitcnt lgkmcnt(2)
  v_exp_f32 v88, v88
  v_mfma_f32_16x16x32_bf16 v[104:107], a[244:247], a[184:187], v[104:107]
  ds_read_b64_tr_b16 a[240:241], v5 offset:36864
  v_mul_f32 v89, s30, v89
  v_mfma_f32_16x16x32_bf16 v[100:103], a[244:247], a[160:163], v[100:103]
  ds_read_b64_tr_b16 a[242:243], v5 offset:38912
  v_add_f32 v16, v16, v88
  v_mfma_f32_16x16x32_bf16 v[96:99], a[244:247], a[232:235], v[96:99]
  s_waitcnt lgkmcnt(2)
  v_exp_f32 v89, v89
  v_mfma_f32_16x16x32_bf16 a[0:3], a[236:239], v[24:27], a[0:3]
  ds_read_b64_tr_b16 a[244:245], v6 offset:36864
  v_mul_f32 v90, s30, v90
  v_mfma_f32_16x16x32_bf16 a[4:7], a[236:239], v[28:31], a[4:7]
  ds_read_b64_tr_b16 a[246:247], v6 offset:38912
  v_add_f32 v16, v16, v89
  v_cvt_pk_bf16_f32 v42, v88, v89
  v_mfma_f32_16x16x32_bf16 a[8:11], a[236:239], v[32:35], a[8:11]
  s_waitcnt lgkmcnt(2)
  v_exp_f32 v90, v90
  v_mfma_f32_16x16x32_bf16 a[32:35], a[240:243], v[32:35], a[32:35]
  ds_read_b64_tr_b16 a[236:237], v7 offset:36864
  v_mul_f32 v91, s30, v91
  v_mfma_f32_16x16x32_bf16 a[28:31], a[240:243], v[28:31], a[28:31]
  ds_read_b64_tr_b16 a[238:239], v7 offset:38912
  v_add_f32 v16, v16, v90
  v_mfma_f32_16x16x32_bf16 a[24:27], a[240:243], v[24:27], a[24:27]
  s_waitcnt lgkmcnt(2)
  v_exp_f32 v91, v91
  v_mfma_f32_16x16x32_bf16 a[48:51], a[244:247], v[24:27], a[48:51]
  ds_read_b64_tr_b16 a[240:241], v4 offset:40960
  v_mul_f32 v44, s30, v44
  v_mfma_f32_16x16x32_bf16 a[52:55], a[244:247], v[28:31], a[52:55]
  ds_read_b64_tr_b16 a[242:243], v4 offset:43008
  v_add_f32 v16, v16, v91
  v_cvt_pk_bf16_f32 v43, v90, v91
  v_mfma_f32_16x16x32_bf16 a[56:59], a[244:247], v[32:35], a[56:59]
  s_waitcnt lgkmcnt(2)
  v_exp_f32 v44, v44
  v_mfma_f32_16x16x32_bf16 a[80:83], a[236:239], v[32:35], a[80:83]
  ds_read_b64_tr_b16 a[244:245], v5 offset:40960
  v_mul_f32 v45, s30, v45
  v_mfma_f32_16x16x32_bf16 a[76:79], a[236:239], v[28:31], a[76:79]
  ds_read_b64_tr_b16 a[246:247], v5 offset:43008
  v_add_f32 v17, v17, v44
  v_mfma_f32_16x16x32_bf16 a[72:75], a[236:239], v[24:27], a[72:75]
  s_waitcnt lgkmcnt(2)
  v_exp_f32 v45, v45
  v_mfma_f32_16x16x32_bf16 a[96:99], a[240:243], v[24:27], a[96:99]
  ds_read_b64_tr_b16 a[236:237], v6 offset:40960
  v_mul_f32 v46, s30, v46
  v_mfma_f32_16x16x32_bf16 a[100:103], a[240:243], v[28:31], a[100:103]
  ds_read_b64_tr_b16 a[238:239], v6 offset:43008
  v_add_f32 v17, v17, v45
  v_cvt_pk_bf16_f32 v44, v44, v45
  v_mfma_f32_16x16x32_bf16 a[104:107], a[240:243], v[32:35], a[104:107]
  s_waitcnt lgkmcnt(2)
  v_exp_f32 v46, v46
  v_mfma_f32_16x16x32_bf16 a[128:131], a[244:247], v[32:35], a[128:131]
  ds_read_b64_tr_b16 a[240:241], v7 offset:40960
  v_mul_f32 v47, s30, v47
  v_mfma_f32_16x16x32_bf16 a[124:127], a[244:247], v[28:31], a[124:127]
  ds_read_b64_tr_b16 a[242:243], v7 offset:43008
  v_add_f32 v17, v17, v46
  v_mfma_f32_16x16x32_bf16 a[120:123], a[244:247], v[24:27], a[120:123]
  s_waitcnt lgkmcnt(2)
  v_exp_f32 v47, v47
  v_mfma_f32_16x16x32_bf16 v[112:115], a[236:239], v[24:27], v[112:115]
  ds_read_b64_tr_b16 a[244:245], v4 offset:45056
  v_mul_f32 v92, s30, v92
  v_mfma_f32_16x16x32_bf16 v[116:119], a[236:239], v[28:31], v[116:119]
  ds_read_b64_tr_b16 a[246:247], v4 offset:47104
  v_add_f32 v17, v17, v47
  v_cvt_pk_bf16_f32 v45, v46, v47
  v_mfma_f32_16x16x32_bf16 v[120:123], a[236:239], v[32:35], v[120:123]
  s_waitcnt lgkmcnt(2)
  v_exp_f32 v92, v92
  v_mfma_f32_16x16x32_bf16 v[144:147], a[240:243], v[32:35], v[144:147]
  ds_read_b64_tr_b16 a[236:237], v5 offset:45056
  v_mul_f32 v93, s30, v93
  v_mfma_f32_16x16x32_bf16 v[140:143], a[240:243], v[28:31], v[140:143]
  ds_read_b64_tr_b16 a[238:239], v5 offset:47104
  v_add_f32 v17, v17, v92
  v_mfma_f32_16x16x32_bf16 v[136:139], a[240:243], v[24:27], v[136:139]
  s_waitcnt lgkmcnt(2)
  v_exp_f32 v93, v93
  v_mfma_f32_16x16x32_bf16 v[160:163], a[244:247], v[24:27], v[160:163]
  ds_read_b64_tr_b16 a[240:241], v6 offset:45056
  v_mul_f32 v94, s30, v94
  v_mfma_f32_16x16x32_bf16 v[164:167], a[244:247], v[28:31], v[164:167]
  ds_read_b64_tr_b16 a[242:243], v6 offset:47104
  v_add_f32 v17, v17, v93
  v_cvt_pk_bf16_f32 v46, v92, v93
  v_mfma_f32_16x16x32_bf16 v[168:171], a[244:247], v[32:35], v[168:171]
  s_waitcnt lgkmcnt(2)
  v_exp_f32 v94, v94
  v_mfma_f32_16x16x32_bf16 v[192:195], a[236:239], v[32:35], v[192:195]
  ds_read_b64_tr_b16 a[244:245], v7 offset:45056
  v_mul_f32 v95, s30, v95
  v_mfma_f32_16x16x32_bf16 v[188:191], a[236:239], v[28:31], v[188:191]
  ds_read_b64_tr_b16 a[246:247], v7 offset:47104
  v_add_f32 v17, v17, v94
  v_mfma_f32_16x16x32_bf16 v[184:187], a[236:239], v[24:27], v[184:187]
  s_waitcnt lgkmcnt(2)
  v_exp_f32 v95, v95
  v_mfma_f32_16x16x32_bf16 v[208:211], a[240:243], v[24:27], v[208:211]
  ds_read_b64_tr_b16 a[236:237], v4 offset:0
  v_mul_f32 v48, s30, v48
  v_mfma_f32_16x16x32_bf16 v[212:215], a[240:243], v[28:31], v[212:215]
  ds_read_b64_tr_b16 a[238:239], v4 offset:2048
  v_add_f32 v17, v17, v95
  v_cvt_pk_bf16_f32 v47, v94, v95
  v_mfma_f32_16x16x32_bf16 v[216:219], a[240:243], v[32:35], v[216:219]
  s_waitcnt lgkmcnt(2)
  v_exp_f32 v48, v48
  v_mfma_f32_16x16x32_bf16 v[240:243], a[244:247], v[32:35], v[240:243]
  ds_read_b64_tr_b16 a[240:241], v5 offset:0
  v_mul_f32 v49, s30, v49
  v_mfma_f32_16x16x32_bf16 v[236:239], a[244:247], v[28:31], v[236:239]
  ds_read_b64_tr_b16 a[242:243], v5 offset:2048
  v_add_f32 v18, v18, v48
  v_mfma_f32_16x16x32_bf16 v[232:235], a[244:247], v[24:27], v[232:235]
  s_waitcnt lgkmcnt(2)
  v_exp_f32 v49, v49
  v_mfma_f32_16x16x32_bf16 a[0:3], a[236:239], v[36:39], a[0:3]
  ds_read_b64_tr_b16 a[244:245], v6 offset:0
  v_mul_f32 v50, s30, v50
  v_mfma_f32_16x16x32_bf16 a[4:7], a[236:239], v[40:43], a[4:7]
  ds_read_b64_tr_b16 a[246:247], v6 offset:2048
  v_add_f32 v18, v18, v49
  v_cvt_pk_bf16_f32 v48, v48, v49
  v_mfma_f32_16x16x32_bf16 a[8:11], a[236:239], v[44:47], a[8:11]
  s_waitcnt lgkmcnt(2)
  v_exp_f32 v50, v50
  v_mov_b32 v24, v15
  v_mov_b32 v25, v16
  v_mfma_f32_16x16x32_bf16 a[32:35], a[240:243], v[44:47], a[32:35]
  ds_read_b64_tr_b16 a[236:237], v7 offset:0
  v_mul_f32 v51, s30, v51
  v_mov_b32 v26, v17
  v_mfma_f32_16x16x32_bf16 a[28:31], a[240:243], v[40:43], a[28:31]
  ds_read_b64_tr_b16 a[238:239], v7 offset:2048
  v_add_f32 v18, v18, v50
  v_permlane32_swap_b32 v24, v15
  v_mfma_f32_16x16x32_bf16 a[24:27], a[240:243], v[36:39], a[24:27]
  s_waitcnt lgkmcnt(2)
  v_exp_f32 v51, v51
  v_permlane32_swap_b32 v25, v16
  v_mfma_f32_16x16x32_bf16 a[48:51], a[244:247], v[36:39], a[48:51]
  ds_read_b64_tr_b16 a[240:241], v4 offset:4096
  v_mul_f32 v96, s30, v96
  v_permlane32_swap_b32 v26, v17
  v_add_f32 v15, v15, v24
  v_mfma_f32_16x16x32_bf16 a[52:55], a[244:247], v[40:43], a[52:55]
  ds_read_b64_tr_b16 a[242:243], v4 offset:6144
  v_add_f32 v18, v18, v51
  v_cvt_pk_bf16_f32 v49, v50, v51
  v_add_f32 v16, v16, v25
  v_mfma_f32_16x16x32_bf16 a[56:59], a[244:247], v[44:47], a[56:59]
  s_waitcnt lgkmcnt(2)
  v_exp_f32 v96, v96
  v_add_f32 v17, v17, v26
  v_mfma_f32_16x16x32_bf16 a[80:83], a[236:239], v[44:47], a[80:83]
  ds_read_b64_tr_b16 a[244:245], v5 offset:4096
  v_mul_f32 v97, s30, v97
  v_mov_b32 v24, v15
  v_mfma_f32_16x16x32_bf16 a[76:79], a[236:239], v[40:43], a[76:79]
  ds_read_b64_tr_b16 a[246:247], v5 offset:6144
  v_add_f32 v18, v18, v96
  v_mov_b32 v25, v16
  v_mov_b32 v26, v17
  v_mfma_f32_16x16x32_bf16 a[72:75], a[236:239], v[36:39], a[72:75]
  s_waitcnt lgkmcnt(2)
  v_exp_f32 v97, v97
  v_permlane16_swap_b32 v24, v15
  v_mfma_f32_16x16x32_bf16 a[96:99], a[240:243], v[36:39], a[96:99]
  ds_read_b64_tr_b16 a[236:237], v6 offset:4096
  v_mul_f32 v98, s30, v98
  v_permlane16_swap_b32 v25, v16
  v_mfma_f32_16x16x32_bf16 a[100:103], a[240:243], v[40:43], a[100:103]
  ds_read_b64_tr_b16 a[238:239], v6 offset:6144
  v_add_f32 v18, v18, v97
  v_cvt_pk_bf16_f32 v50, v96, v97
  v_permlane16_swap_b32 v26, v17
  v_mfma_f32_16x16x32_bf16 a[104:107], a[240:243], v[44:47], a[104:107]
  s_waitcnt lgkmcnt(2)
  v_exp_f32 v98, v98
  v_add_f32 v15, v15, v24
  v_add_f32 v16, v16, v25
  v_mfma_f32_16x16x32_bf16 a[128:131], a[244:247], v[44:47], a[128:131]
  ds_read_b64_tr_b16 a[240:241], v7 offset:4096
  v_mul_f32 v99, s30, v99
  v_add_f32 v17, v17, v26
  v_mfma_f32_16x16x32_bf16 a[124:127], a[244:247], v[40:43], a[124:127]
  ds_read_b64_tr_b16 a[242:243], v7 offset:6144
  v_add_f32 v18, v18, v98
  v_rcp_f32 v84, v15
  v_mfma_f32_16x16x32_bf16 a[120:123], a[244:247], v[36:39], a[120:123]
  s_waitcnt lgkmcnt(2)
  v_exp_f32 v99, v99
  v_rcp_f32 v85, v16
  v_mfma_f32_16x16x32_bf16 v[112:115], a[236:239], v[36:39], v[112:115]
  ds_read_b64_tr_b16 a[244:245], v4 offset:8192
  v_mul_f32 v52, s30, v52
  v_rcp_f32 v86, v17
  v_max3_f32 v24, v15, v16, v17
  v_mfma_f32_16x16x32_bf16 v[116:119], a[236:239], v[40:43], v[116:119]
  ds_read_b64_tr_b16 a[246:247], v4 offset:10240
  v_add_f32 v18, v18, v99
  v_cvt_pk_bf16_f32 v51, v98, v99
  v_max3_f32 v25, v84, v85, v86
  v_mfma_f32_16x16x32_bf16 v[120:123], a[236:239], v[44:47], v[120:123]
  s_waitcnt lgkmcnt(2)
  v_exp_f32 v52, v52
  v_mul_f32 v25, 0x49800000, v25
  v_mfma_f32_16x16x32_bf16 v[144:147], a[240:243], v[44:47], v[144:147]
  ds_read_b64_tr_b16 a[236:237], v5 offset:8192
  v_mul_f32 v53, s30, v53
  v_max_f32 v24, v24, v25
  v_mfma_f32_16x16x32_bf16 v[140:143], a[240:243], v[40:43], v[140:143]
  ds_read_b64_tr_b16 a[238:239], v5 offset:10240
  v_add_f32 v19, v19, v52
  v_cmp_ngt_f32 vcc, 0x5d800000, v24
  v_mbcnt_lo_u32_b32 v28, -1, 0
  v_mfma_f32_16x16x32_bf16 v[136:139], a[240:243], v[36:39], v[136:139]
  s_waitcnt lgkmcnt(2)
  v_exp_f32 v53, v53
  v_mbcnt_hi_u32_b32 v28, -1, v28
  v_mfma_f32_16x16x32_bf16 v[160:163], a[244:247], v[36:39], v[160:163]
  ds_read_b64_tr_b16 a[240:241], v6 offset:8192
  v_mul_f32 v54, s30, v54
  v_and_b32 v29, 15, v28
  v_mfma_f32_16x16x32_bf16 v[164:167], a[244:247], v[40:43], v[164:167]
  ds_read_b64_tr_b16 a[242:243], v6 offset:10240
  v_add_f32 v19, v19, v53
  v_cvt_pk_bf16_f32 v52, v52, v53
  v_lshrrev_b32 v30, 4, v28
  v_mfma_f32_16x16x32_bf16 v[168:171], a[244:247], v[44:47], v[168:171]
  s_waitcnt lgkmcnt(2)
  v_exp_f32 v54, v54
  v_mul_u32_u24 v29, 144, v29
  v_lshlrev_b32 v30, 3, v30
  v_mfma_f32_16x16x32_bf16 v[192:195], a[236:239], v[44:47], v[192:195]
  ds_read_b64_tr_b16 a[244:245], v7 offset:8192
  v_mul_f32 v55, s30, v55
  v_add3_u32 v90, v29, v30, s50
  v_mfma_f32_16x16x32_bf16 v[188:191], a[236:239], v[40:43], v[188:191]
  ds_read_b64_tr_b16 a[246:247], v7 offset:10240
  v_add_f32 v19, v19, v54
  v_lshrrev_b32 v29, 3, v28
  v_mfma_f32_16x16x32_bf16 v[184:187], a[236:239], v[36:39], v[184:187]
  s_waitcnt lgkmcnt(2)
  v_exp_f32 v55, v55
  v_and_b32 v31, 7, v28
  v_mfma_f32_16x16x32_bf16 v[208:211], a[240:243], v[36:39], v[208:211]
  ds_read_b128 a[236:239], v0 offset:36864
  v_mul_f32 v100, s30, v100
  v_lshlrev_b32 v31, 4, v31
  v_mul_u32_u24 v30, 144, v29
  v_mfma_f32_16x16x32_bf16 v[212:215], a[240:243], v[40:43], v[212:215]
  v_add_f32 v19, v19, v55
  v_cvt_pk_bf16_f32 v53, v54, v55
  v_add3_u32 v91, v30, v31, s50
  v_mfma_f32_16x16x32_bf16 v[216:219], a[240:243], v[44:47], v[216:219]
  s_waitcnt lgkmcnt(1)
  v_exp_f32 v100, v100
  v_mul_u32_u24 v29, 384, v29
  v_mfma_f32_16x16x32_bf16 v[240:243], a[244:247], v[44:47], v[240:243]
  ds_read_b128 a[240:243], v0 offset:38912
  v_mul_f32 v101, s30, v101
  v_add_u32 v92, v31, v29
  v_mfma_f32_16x16x32_bf16 v[236:239], a[244:247], v[40:43], v[236:239]
  v_add_f32 v19, v19, v100
  v_mfma_f32_16x16x32_bf16 v[232:235], a[244:247], v[36:39], v[232:235]
  s_waitcnt lgkmcnt(1)
  v_exp_f32 v101, v101
  s_cmp_lg_u64 vcc, 0
  s_cselect_b32 s37, 1, 0
  s_lshl_b32 s37, s37, s33
  s_or_b32 s38, s38, s37
  v_mfma_f32_16x16x32_bf16 v[60:63], a[236:239], a[212:215], v[10:13]
  ds_read_b128 a[244:247], v1 offset:36864
  v_mul_f32 v102, s30, v102
  v_accvgpr_read_b32 v24, a0
  v_accvgpr_read_b32 v25, a1
  v_accvgpr_read_b32 v26, a2
  v_accvgpr_read_b32 v27, a3
  v_mfma_f32_16x16x32_bf16 v[64:67], a[236:239], a[140:143], v[10:13]
  v_add_f32 v19, v19, v101
  v_cvt_pk_bf16_f32 v54, v100, v101
  v_accvgpr_read_b32 v28, a24
  v_accvgpr_read_b32 v29, a25
  v_accvgpr_read_b32 v30, a26
  v_mfma_f32_16x16x32_bf16 v[68:71], a[236:239], a[164:167], v[10:13]
  s_waitcnt lgkmcnt(1)
  v_accvgpr_read_b32 v31, a27
  v_exp_f32 v102, v102
  v_accvgpr_read_b32 v32, a48
  v_accvgpr_read_b32 v33, a49
  v_accvgpr_read_b32 v34, a50
  v_mfma_f32_16x16x32_bf16 v[80:83], a[240:243], a[164:167], v[10:13]
  ds_read_b128 a[236:239], v1 offset:38912
  v_accvgpr_read_b32 v35, a51
  v_mul_f32 v103, s30, v103
  v_accvgpr_read_b32 v36, a72
  v_accvgpr_read_b32 v37, a73
  v_mfma_f32_16x16x32_bf16 v[76:79], a[240:243], a[140:143], v[10:13]
  v_accvgpr_read_b32 v38, a74
  v_accvgpr_read_b32 v39, a75
  v_add_f32 v19, v19, v102
  v_mul_f32 v24, v84, v24
  v_mul_f32 v25, v84, v25
  v_mfma_f32_16x16x32_bf16 v[72:75], a[240:243], a[212:215], v[10:13]
  s_waitcnt lgkmcnt(1)
  v_mul_f32 v26, v84, v26
  v_mul_f32 v27, v84, v27
  v_exp_f32 v103, v103
  v_mul_f32 v28, v84, v28
  v_mul_f32 v29, v84, v29
  v_mfma_f32_16x16x32_bf16 v[60:63], a[244:247], a[216:219], v[60:63]
  ds_read_b128 a[240:243], v0 offset:40960
  v_mul_f32 v30, v84, v30
  v_mul_f32 v31, v84, v31
  v_mul_f32 v56, s30, v56
  v_mul_f32 v32, v84, v32
  v_mul_f32 v33, v84, v33
  v_mfma_f32_16x16x32_bf16 v[64:67], a[244:247], a[144:147], v[64:67]
  v_mul_f32 v34, v84, v34
  v_mul_f32 v35, v84, v35
  v_add_f32 v19, v19, v103
  v_cvt_pk_bf16_f32 v55, v102, v103
  v_mfma_f32_16x16x32_bf16 v[68:71], a[244:247], a[168:171], v[68:71]
  s_waitcnt lgkmcnt(1)
  v_mul_f32 v36, v84, v36
  v_mul_f32 v37, v84, v37
  v_mul_f32 v38, v84, v38
  v_mul_f32 v39, v84, v39
  v_exp_f32 v56, v56
  v_mfma_f32_16x16x32_bf16 v[80:83], a[236:239], a[168:171], v[80:83]
  ds_read_b128 a[244:247], v0 offset:43008
  v_cvt_pk_bf16_f32 v24, v24, v25
  v_cvt_pk_bf16_f32 v25, v26, v27
  v_cvt_pk_bf16_f32 v28, v28, v29
  v_cvt_pk_bf16_f32 v29, v30, v31
  v_mul_f32 v57, s30, v57
  v_mfma_f32_16x16x32_bf16 v[76:79], a[236:239], a[144:147], v[76:79]
  v_cvt_pk_bf16_f32 v32, v32, v33
  v_cvt_pk_bf16_f32 v33, v34, v35
  v_cvt_pk_bf16_f32 v36, v36, v37
  v_cvt_pk_bf16_f32 v37, v38, v39
  v_mfma_f32_16x16x32_bf16 v[72:75], a[236:239], a[216:219], v[72:75]
  ds_write2_b64 v90, v[24:25], v[28:29] offset0:0 offset1:4
  ds_write2_b64 v90, v[32:33], v[36:37] offset0:8 offset1:12
  ds_read_b128 v[40:43], v91 offset:0
  ds_read_b128 v[44:47], v91 offset:1152
  s_waitcnt lgkmcnt(5)
  v_mfma_f32_16x16x32_bf16 v[60:63], a[240:243], a[220:223], v[60:63]
  ds_read_b128 a[236:239], v1 offset:40960
  v_add_f32 v20, v20, v56
  v_accvgpr_read_b32 v24, a96
  v_accvgpr_read_b32 v25, a97
  v_accvgpr_read_b32 v26, a98
  v_mfma_f32_16x16x32_bf16 v[64:67], a[240:243], a[148:151], v[64:67]
  v_accvgpr_read_b32 v27, a99
  v_exp_f32 v57, v57
  v_accvgpr_read_b32 v28, a120
  v_accvgpr_read_b32 v29, a121
  v_mfma_f32_16x16x32_bf16 v[68:71], a[240:243], a[172:175], v[68:71]
  s_waitcnt lgkmcnt(5)
  v_accvgpr_read_b32 v30, a122
  v_mul_f32 v58, s30, v58
  v_accvgpr_read_b32 v31, a123
  v_mul_f32 v24, v84, v24
  v_mfma_f32_16x16x32_bf16 v[80:83], a[244:247], a[172:175], v[80:83]
  ds_read_b128 a[240:243], v1 offset:43008
  v_mul_f32 v25, v84, v25
  v_add_f32 v20, v20, v57
  v_cvt_pk_bf16_f32 v56, v56, v57
  v_mul_f32 v26, v84, v26
  v_mfma_f32_16x16x32_bf16 v[76:79], a[244:247], a[148:151], v[76:79]
  v_mul_f32 v27, v84, v27
  v_mul_f32 v28, v84, v28
  v_exp_f32 v58, v58
  v_mul_f32 v29, v84, v29
  v_mfma_f32_16x16x32_bf16 v[72:75], a[244:247], a[220:223], v[72:75]
  s_waitcnt lgkmcnt(1)
  v_mul_f32 v30, v84, v30
  v_mul_f32 v31, v84, v31
  v_mul_f32 v59, s30, v59
  v_mul_f32 v112, v84, v112
  v_mfma_f32_16x16x32_bf16 v[60:63], a[236:239], a[224:227], v[60:63]
  ds_read_b128 a[244:247], v0 offset:45056
  v_mul_f32 v113, v84, v113
  v_mul_f32 v114, v84, v114
  v_mul_f32 v115, v84, v115
  v_add_f32 v20, v20, v58
  v_mfma_f32_16x16x32_bf16 v[64:67], a[236:239], a[152:155], v[64:67]
  v_mul_f32 v136, v84, v136
  v_mul_f32 v137, v84, v137
  v_mul_f32 v138, v84, v138
  v_exp_f32 v59, v59
  v_mfma_f32_16x16x32_bf16 v[68:71], a[236:239], a[176:179], v[68:71]
  s_waitcnt lgkmcnt(1)
  v_mul_f32 v139, v84, v139
  v_cvt_pk_bf16_f32 v24, v24, v25
  v_cvt_pk_bf16_f32 v25, v26, v27
  v_mul_f32 v104, s30, v104
  v_mfma_f32_16x16x32_bf16 v[80:83], a[240:243], a[176:179], v[80:83]
  ds_read_b128 a[236:239], v0 offset:47104
  v_cvt_pk_bf16_f32 v28, v28, v29
  v_cvt_pk_bf16_f32 v29, v30, v31
  v_cvt_pk_bf16_f32 v112, v112, v113
  v_add_f32 v20, v20, v59
  v_mfma_f32_16x16x32_bf16 v[76:79], a[240:243], a[152:155], v[76:79]
  v_cvt_pk_bf16_f32 v57, v58, v59
  v_cvt_pk_bf16_f32 v113, v114, v115
  v_cvt_pk_bf16_f32 v136, v136, v137
  v_cvt_pk_bf16_f32 v137, v138, v139
  s_add_u32 s35, s51, 0
  v_mfma_f32_16x16x32_bf16 v[72:75], a[240:243], a[224:227], v[72:75]
  buffer_store_dwordx4 v[40:43], v92, s[20:23], s35 offen offset:0 sc0 sc1
  buffer_store_dwordx4 v[44:47], v92, s[20:23], s35 offen offset:3072 sc0 sc1
  ds_write2_b64 v90, v[24:25], v[28:29] offset0:0 offset1:4
  ds_write2_b64 v90, v[112:113], v[136:137] offset0:8 offset1:12
  ds_read_b128 v[40:43], v91 offset:0
  ds_read_b128 v[44:47], v91 offset:1152
  s_waitcnt lgkmcnt(5)
  v_mfma_f32_16x16x32_bf16 v[60:63], a[244:247], a[228:231], v[60:63]
  ds_read_b128 a[240:243], v1 offset:45056
  v_exp_f32 v104, v104
  v_mul_f32 v160, v84, v160
  v_mul_f32 v161, v84, v161
  v_mul_f32 v162, v84, v162
  v_mfma_f32_16x16x32_bf16 v[64:67], a[244:247], a[156:159], v[64:67]
  v_mul_f32 v105, s30, v105
  v_mul_f32 v163, v84, v163
  v_mul_f32 v184, v84, v184
  v_mfma_f32_16x16x32_bf16 v[68:71], a[244:247], a[180:183], v[68:71]
  s_waitcnt lgkmcnt(5)
  v_add_f32 v20, v20, v104
  v_mul_f32 v185, v84, v185
  v_mul_f32 v186, v84, v186
  v_exp_f32 v105, v105
  v_mfma_f32_16x16x32_bf16 v[80:83], a[236:239], a[180:183], v[80:83]
  ds_read_b128 a[244:247], v1 offset:47104
  v_mul_f32 v187, v84, v187
  v_mul_f32 v208, v84, v208
  v_mul_f32 v106, s30, v106
  v_mfma_f32_16x16x32_bf16 v[76:79], a[236:239], a[156:159], v[76:79]
  v_mul_f32 v209, v84, v209
  v_mul_f32 v210, v84, v210
  v_add_f32 v20, v20, v105
  v_mfma_f32_16x16x32_bf16 v[72:75], a[236:239], a[228:231], v[72:75]
  s_waitcnt lgkmcnt(1)
  v_cvt_pk_bf16_f32 v58, v104, v105
  v_mul_f32 v211, v84, v211
  v_mul_f32 v232, v84, v232
  v_mul_f32 v233, v84, v233
  v_mfma_f32_16x16x32_bf16 v[60:63], a[240:243], a[232:235], v[60:63]
  ds_read_b64_tr_b16 a[236:237], v4 offset:36864
  v_exp_f32 v106, v106
  v_mul_f32 v234, v84, v234
  v_mul_f32 v235, v84, v235
  v_mfma_f32_16x16x32_bf16 v[64:67], a[240:243], a[160:163], v[64:67]
  ds_read_b64_tr_b16 a[238:239], v4 offset:38912
  v_mul_f32 v107, s30, v107
  v_cvt_pk_bf16_f32 v160, v160, v161
  v_cvt_pk_bf16_f32 v161, v162, v163
  v_mfma_f32_16x16x32_bf16 v[68:71], a[240:243], a[184:187], v[68:71]
  s_waitcnt lgkmcnt(2)
  v_add_f32 v20, v20, v106
  v_cvt_pk_bf16_f32 v184, v184, v185
  v_cvt_pk_bf16_f32 v185, v186, v187
  v_exp_f32 v107, v107
  v_mfma_f32_16x16x32_bf16 v[80:83], a[244:247], a[184:187], v[80:83]
  ds_read_b64_tr_b16 a[240:241], v5 offset:36864
  v_cvt_pk_bf16_f32 v208, v208, v209
  v_cvt_pk_bf16_f32 v209, v210, v211
  v_add_f32 v20, v20, v107
  v_mfma_f32_16x16x32_bf16 v[76:79], a[244:247], a[160:163], v[76:79]
  ds_read_b64_tr_b16 a[242:243], v5 offset:38912
  v_cvt_pk_bf16_f32 v59, v106, v107
  v_cvt_pk_bf16_f32 v232, v232, v233
  v_cvt_pk_bf16_f32 v233, v234, v235
  s_add_u32 s35, s51, 0
  v_mfma_f32_16x16x32_bf16 v[72:75], a[244:247], a[232:235], v[72:75]
  buffer_store_dwordx4 v[40:43], v92, s[20:23], s35 offen offset:128 sc0 sc1
  buffer_store_dwordx4 v[44:47], v92, s[20:23], s35 offen offset:3200 sc0 sc1
  ds_write2_b64 v90, v[160:161], v[184:185] offset0:0 offset1:4
  ds_write2_b64 v90, v[208:209], v[232:233] offset0:8 offset1:12
  ds_read_b128 v[40:43], v91 offset:0
  ds_read_b128 v[44:47], v91 offset:1152
  s_waitcnt lgkmcnt(6)
  v_mfma_f32_16x16x32_bf16 a[12:15], a[236:239], v[48:51], a[12:15]
  ds_read_b64_tr_b16 a[244:245], v6 offset:36864
  v_mul_f32 v60, s30, v60
  v_accvgpr_read_b32 v24, a4
  v_accvgpr_read_b32 v25, a5
  v_exp_f32 v60, v60
  v_accvgpr_read_b32 v26, a6
  v_accvgpr_read_b32 v27, a7
  v_mul_f32 v61, s30, v61
  v_mfma_f32_16x16x32_bf16 a[16:19], a[236:239], v[52:55], a[16:19]
  ds_read_b64_tr_b16 a[246:247], v6 offset:38912
  v_accvgpr_read_b32 v28, a28
  v_add_f32 v18, v18, v60
  v_accvgpr_read_b32 v29, a29
  v_accvgpr_read_b32 v30, a30
  v_exp_f32 v61, v61
  v_accvgpr_read_b32 v31, a31
  v_mfma_f32_16x16x32_bf16 a[20:23], a[236:239], v[56:59], a[20:23]
  s_waitcnt lgkmcnt(6)
  v_accvgpr_read_b32 v32, a52
  v_mul_f32 v62, s30, v62
  v_accvgpr_read_b32 v33, a53
  v_add_f32 v18, v18, v61
  v_cvt_pk_bf16_f32 v60, v60, v61
  v_accvgpr_read_b32 v34, a54
  v_mfma_f32_16x16x32_bf16 a[44:47], a[240:243], v[56:59], a[44:47]
  ds_read_b64_tr_b16 a[236:237], v7 offset:36864
  v_accvgpr_read_b32 v35, a55
  v_exp_f32 v62, v62
  v_accvgpr_read_b32 v36, a76
  v_accvgpr_read_b32 v37, a77
  v_mul_f32 v63, s30, v63
  v_accvgpr_read_b32 v38, a78
  v_mfma_f32_16x16x32_bf16 a[40:43], a[240:243], v[52:55], a[40:43]
  ds_read_b64_tr_b16 a[238:239], v7 offset:38912
  v_add_f32 v18, v18, v62
  v_accvgpr_read_b32 v39, a79
  v_mul_f32 v24, v85, v24
  v_exp_f32 v63, v63
  v_mul_f32 v25, v85, v25
  v_mul_f32 v26, v85, v26
  v_mfma_f32_16x16x32_bf16 a[36:39], a[240:243], v[48:51], a[36:39]
  s_waitcnt lgkmcnt(2)
  v_mul_f32 v72, s30, v72
  v_mul_f32 v27, v85, v27
  v_add_f32 v18, v18, v63
  v_cvt_pk_bf16_f32 v61, v62, v63
  v_mul_f32 v28, v85, v28
  v_mul_f32 v29, v85, v29
  v_mfma_f32_16x16x32_bf16 a[60:63], a[244:247], v[48:51], a[60:63]
  ds_read_b64_tr_b16 a[240:241], v4 offset:40960
  v_exp_f32 v72, v72
  v_mul_f32 v30, v85, v30
  v_mul_f32 v31, v85, v31
  v_mul_f32 v73, s30, v73
  v_mul_f32 v32, v85, v32
  v_add_f32 v18, v18, v72
  v_mfma_f32_16x16x32_bf16 a[64:67], a[244:247], v[52:55], a[64:67]
  ds_read_b64_tr_b16 a[242:243], v4 offset:43008
  v_mul_f32 v33, v85, v33
  v_mul_f32 v34, v85, v34
  v_exp_f32 v73, v73
  v_mul_f32 v35, v85, v35
  v_mul_f32 v36, v85, v36
  v_mul_f32 v74, s30, v74
  v_mfma_f32_16x16x32_bf16 a[68:71], a[244:247], v[56:59], a[68:71]
  s_waitcnt lgkmcnt(2)
  v_mul_f32 v37, v85, v37
  v_add_f32 v18, v18, v73
  v_cvt_pk_bf16_f32 v62, v72, v73
  v_mul_f32 v38, v85, v38
  v_mul_f32 v39, v85, v39
  v_exp_f32 v74, v74
  v_mfma_f32_16x16x32_bf16 a[92:95], a[236:239], v[56:59], a[92:95]
  ds_read_b64_tr_b16 a[244:245], v5 offset:40960
  v_cvt_pk_bf16_f32 v24, v24, v25
  v_cvt_pk_bf16_f32 v25, v26, v27
  v_mul_f32 v75, s30, v75
  v_cvt_pk_bf16_f32 v28, v28, v29
  v_add_f32 v18, v18, v74
  v_cvt_pk_bf16_f32 v29, v30, v31
  v_mfma_f32_16x16x32_bf16 a[88:91], a[236:239], v[52:55], a[88:91]
  ds_read_b64_tr_b16 a[246:247], v5 offset:43008
  v_cvt_pk_bf16_f32 v32, v32, v33
  v_exp_f32 v75, v75
  v_cvt_pk_bf16_f32 v33, v34, v35
  v_cvt_pk_bf16_f32 v36, v36, v37
  v_mul_f32 v64, s30, v64
  v_cvt_pk_bf16_f32 v37, v38, v39
  s_add_u32 s35, s51, 0
  v_mfma_f32_16x16x32_bf16 a[84:87], a[236:239], v[48:51], a[84:87]
  buffer_store_dwordx4 v[40:43], v92, s[20:23], s35 offen offset:256 sc0 sc1
  buffer_store_dwordx4 v[44:47], v92, s[20:23], s35 offen offset:3328 sc0 sc1
  ds_write2_b64 v90, v[24:25], v[28:29] offset0:0 offset1:4
  ds_write2_b64 v90, v[32:33], v[36:37] offset0:8 offset1:12
  ds_read_b128 v[40:43], v91 offset:0
  ds_read_b128 v[44:47], v91 offset:1152
  s_waitcnt lgkmcnt(6)
  v_mfma_f32_16x16x32_bf16 a[108:111], a[240:243], v[48:51], a[108:111]
  ds_read_b64_tr_b16 a[236:237], v6 offset:40960
  v_add_f32 v18, v18, v75
  v_cvt_pk_bf16_f32 v63, v74, v75
  v_accvgpr_read_b32 v24, a100
  v_accvgpr_read_b32 v25, a101
  v_exp_f32 v64, v64
  v_accvgpr_read_b32 v26, a102
  v_mfma_f32_16x16x32_bf16 a[112:115], a[240:243], v[52:55], a[112:115]
  ds_read_b64_tr_b16 a[238:239], v6 offset:43008
  v_mul_f32 v65, s30, v65
  v_accvgpr_read_b32 v27, a103
  v_add_f32 v19, v19, v64
  v_accvgpr_read_b32 v28, a124
  v_accvgpr_read_b32 v29, a125
  v_mfma_f32_16x16x32_bf16 a[116:119], a[240:243], v[56:59], a[116:119]
  s_waitcnt lgkmcnt(6)
  v_exp_f32 v65, v65
  v_accvgpr_read_b32 v30, a126
  v_mul_f32 v66, s30, v66
  v_accvgpr_read_b32 v31, a127
  v_add_f32 v19, v19, v65
  v_cvt_pk_bf16_f32 v64, v64, v65
  v_mfma_f32_16x16x32_bf16 v[108:111], a[244:247], v[56:59], v[108:111]
  ds_read_b64_tr_b16 a[240:241], v7 offset:40960
  v_mul_f32 v24, v85, v24
  v_mul_f32 v25, v85, v25
  v_exp_f32 v66, v66
  v_mul_f32 v26, v85, v26
  v_mul_f32 v67, s30, v67
  v_mfma_f32_16x16x32_bf16 a[136:139], a[244:247], v[52:55], a[136:139]
  ds_read_b64_tr_b16 a[242:243], v7 offset:43008
  v_mul_f32 v27, v85, v27
  v_add_f32 v19, v19, v66
  v_mul_f32 v28, v85, v28
  v_mul_f32 v29, v85, v29
  v_exp_f32 v67, v67
  v_mul_f32 v30, v85, v30
  v_mfma_f32_16x16x32_bf16 a[132:135], a[244:247], v[48:51], a[132:135]
  s_waitcnt lgkmcnt(2)
  v_mul_f32 v76, s30, v76
  v_mul_f32 v31, v85, v31
  v_add_f32 v19, v19, v67
  v_cvt_pk_bf16_f32 v65, v66, v67
  v_mul_f32 v116, v85, v116
  v_mfma_f32_16x16x32_bf16 v[124:127], a[236:239], v[48:51], v[124:127]
  ds_read_b64_tr_b16 a[244:245], v4 offset:45056
  v_mul_f32 v117, v85, v117
  v_exp_f32 v76, v76
  v_mul_f32 v118, v85, v118
  v_mul_f32 v77, s30, v77
  v_mul_f32 v119, v85, v119
  v_add_f32 v19, v19, v76
  v_mfma_f32_16x16x32_bf16 v[128:131], a[236:239], v[52:55], v[128:131]
  ds_read_b64_tr_b16 a[246:247], v4 offset:47104
  v_mul_f32 v140, v85, v140
  v_mul_f32 v141, v85, v141
  v_exp_f32 v77, v77
  v_mul_f32 v142, v85, v142
  v_mul_f32 v78, s30, v78
  v_mfma_f32_16x16x32_bf16 v[132:135], a[236:239], v[56:59], v[132:135]
  s_waitcnt lgkmcnt(2)
  v_mul_f32 v143, v85, v143
  v_add_f32 v19, v19, v77
  v_cvt_pk_bf16_f32 v66, v76, v77
  v_cvt_pk_bf16_f32 v24, v24, v25
  v_cvt_pk_bf16_f32 v25, v26, v27
  v_exp_f32 v78, v78
  v_mfma_f32_16x16x32_bf16 v[156:159], a[240:243], v[56:59], v[156:159]
  ds_read_b64_tr_b16 a[236:237], v5 offset:45056
  v_cvt_pk_bf16_f32 v28, v28, v29
  v_mul_f32 v79, s30, v79
  v_cvt_pk_bf16_f32 v29, v30, v31
  v_add_f32 v19, v19, v78
  v_cvt_pk_bf16_f32 v116, v116, v117
  v_mfma_f32_16x16x32_bf16 v[152:155], a[240:243], v[52:55], v[152:155]
  ds_read_b64_tr_b16 a[238:239], v5 offset:47104
  v_cvt_pk_bf16_f32 v117, v118, v119
  v_exp_f32 v79, v79
  v_cvt_pk_bf16_f32 v140, v140, v141
  v_mul_f32 v68, s30, v68
  v_cvt_pk_bf16_f32 v141, v142, v143
  s_add_u32 s35, s51, 6144
  v_mfma_f32_16x16x32_bf16 v[148:151], a[240:243], v[48:51], v[148:151]
  buffer_store_dwordx4 v[40:43], v92, s[20:23], s35 offen offset:0 sc0 sc1
  buffer_store_dwordx4 v[44:47], v92, s[20:23], s35 offen offset:3072 sc0 sc1
  ds_write2_b64 v90, v[24:25], v[28:29] offset0:0 offset1:4
  ds_write2_b64 v90, v[116:117], v[140:141] offset0:8 offset1:12
  ds_read_b128 v[40:43], v91 offset:0
  ds_read_b128 v[44:47], v91 offset:1152
  s_waitcnt lgkmcnt(6)
  v_mfma_f32_16x16x32_bf16 v[172:175], a[244:247], v[48:51], v[172:175]
  ds_read_b64_tr_b16 a[240:241], v6 offset:45056
  v_add_f32 v19, v19, v79
  v_cvt_pk_bf16_f32 v67, v78, v79
  v_mul_f32 v164, v85, v164
  v_exp_f32 v68, v68
  v_mul_f32 v165, v85, v165
  v_mfma_f32_16x16x32_bf16 v[176:179], a[244:247], v[52:55], v[176:179]
  ds_read_b64_tr_b16 a[242:243], v6 offset:47104
  v_mul_f32 v69, s30, v69
  v_mul_f32 v166, v85, v166
  v_add_f32 v20, v20, v68
  v_mul_f32 v167, v85, v167
  v_exp_f32 v69, v69
  v_mfma_f32_16x16x32_bf16 v[180:183], a[244:247], v[56:59], v[180:183]
  s_waitcnt lgkmcnt(6)
  v_mul_f32 v188, v85, v188
  v_mul_f32 v70, s30, v70
  v_mul_f32 v189, v85, v189
  v_add_f32 v20, v20, v69
  v_cvt_pk_bf16_f32 v68, v68, v69
  v_mfma_f32_16x16x32_bf16 v[204:207], a[236:239], v[56:59], v[204:207]
  ds_read_b64_tr_b16 a[244:245], v7 offset:45056
  v_mul_f32 v190, v85, v190
  v_exp_f32 v70, v70
  v_mul_f32 v191, v85, v191
  v_mul_f32 v71, s30, v71
  v_mul_f32 v212, v85, v212
  v_mfma_f32_16x16x32_bf16 v[200:203], a[236:239], v[52:55], v[200:203]
  ds_read_b64_tr_b16 a[246:247], v7 offset:47104
  v_add_f32 v20, v20, v70
  v_mul_f32 v213, v85, v213
  v_exp_f32 v71, v71
  v_mul_f32 v214, v85, v214
  v_mul_f32 v80, s30, v80
  v_mfma_f32_16x16x32_bf16 v[196:199], a[236:239], v[48:51], v[196:199]
  s_waitcnt lgkmcnt(2)
  v_mul_f32 v215, v85, v215
  v_add_f32 v20, v20, v71
  v_cvt_pk_bf16_f32 v69, v70, v71
  v_mul_f32 v236, v85, v236
  v_mfma_f32_16x16x32_bf16 v[220:223], a[240:243], v[48:51], v[220:223]
  ds_read_b64_tr_b16 a[236:237], v4 offset:0
  v_exp_f32 v80, v80
  v_mul_f32 v237, v85, v237
  v_mul_f32 v81, s30, v81
  v_mul_f32 v238, v85, v238
  v_add_f32 v20, v20, v80
  v_mfma_f32_16x16x32_bf16 v[224:227], a[240:243], v[52:55], v[224:227]
  ds_read_b64_tr_b16 a[238:239], v4 offset:2048
  v_mul_f32 v239, v85, v239
  v_exp_f32 v81, v81
  v_cvt_pk_bf16_f32 v164, v164, v165
  v_mul_f32 v82, s30, v82
  v_cvt_pk_bf16_f32 v165, v166, v167
  v_mfma_f32_16x16x32_bf16 v[228:231], a[240:243], v[56:59], v[228:231]
  s_waitcnt lgkmcnt(2)
  v_add_f32 v20, v20, v81
  v_cvt_pk_bf16_f32 v70, v80, v81
  v_cvt_pk_bf16_f32 v188, v188, v189
  v_exp_f32 v82, v82
  v_cvt_pk_bf16_f32 v189, v190, v191
  v_mfma_f32_16x16x32_bf16 v[252:255], a[244:247], v[56:59], v[252:255]
  ds_read_b64_tr_b16 a[240:241], v5 offset:0
  v_mul_f32 v83, s30, v83
  v_cvt_pk_bf16_f32 v212, v212, v213
  v_add_f32 v20, v20, v82
  v_cvt_pk_bf16_f32 v213, v214, v215
  v_exp_f32 v83, v83
  v_mfma_f32_16x16x32_bf16 v[248:251], a[244:247], v[52:55], v[248:251]
  ds_read_b64_tr_b16 a[242:243], v5 offset:2048
  v_cvt_pk_bf16_f32 v236, v236, v237
  s_nop 0
  v_cvt_pk_bf16_f32 v237, v238, v239
  v_add_f32 v20, v20, v83
  v_cvt_pk_bf16_f32 v71, v82, v83
  s_add_u32 s35, s51, 6144
  v_mfma_f32_16x16x32_bf16 v[244:247], a[244:247], v[48:51], v[244:247]
  buffer_store_dwordx4 v[40:43], v92, s[20:23], s35 offen offset:128 sc0 sc1
  buffer_store_dwordx4 v[44:47], v92, s[20:23], s35 offen offset:3200 sc0 sc1
  ds_write2_b64 v90, v[164:165], v[188:189] offset0:0 offset1:4
  ds_write2_b64 v90, v[212:213], v[236:237] offset0:8 offset1:12
  ds_read_b128 v[40:43], v91 offset:0
  ds_read_b128 v[44:47], v91 offset:1152
  s_waitcnt lgkmcnt(6)
  v_mfma_f32_16x16x32_bf16 a[12:15], a[236:239], v[60:63], a[12:15]
  ds_read_b64_tr_b16 a[244:245], v6 offset:0
  v_mov_b32 v72, v18
  v_accvgpr_read_b32 v24, a8
  v_accvgpr_read_b32 v25, a9
  v_accvgpr_read_b32 v26, a10
  v_accvgpr_read_b32 v27, a11
  v_mfma_f32_16x16x32_bf16 a[16:19], a[236:239], v[64:67], a[16:19]
  ds_read_b64_tr_b16 a[246:247], v6 offset:2048
  v_accvgpr_read_b32 v28, a32
  v_mov_b32 v73, v19
  v_accvgpr_read_b32 v29, a33
  v_accvgpr_read_b32 v30, a34
  v_mfma_f32_16x16x32_bf16 a[20:23], a[236:239], v[68:71], a[20:23]
  s_waitcnt lgkmcnt(6)
  v_accvgpr_read_b32 v31, a35
  v_accvgpr_read_b32 v32, a56
  v_accvgpr_read_b32 v33, a57
  v_mov_b32 v74, v20
  v_accvgpr_read_b32 v34, a58
  v_mfma_f32_16x16x32_bf16 a[44:47], a[240:243], v[68:71], a[44:47]
  ds_read_b64_tr_b16 a[236:237], v7 offset:0
  v_accvgpr_read_b32 v35, a59
  v_accvgpr_read_b32 v36, a80
  v_accvgpr_read_b32 v37, a81
  v_accvgpr_read_b32 v38, a82
  v_mfma_f32_16x16x32_bf16 a[40:43], a[240:243], v[64:67], a[40:43]
  ds_read_b64_tr_b16 a[238:239], v7 offset:2048
  v_permlane32_swap_b32 v72, v18
  v_accvgpr_read_b32 v39, a83
  v_mul_f32 v24, v86, v24
  v_mul_f32 v25, v86, v25
  v_mfma_f32_16x16x32_bf16 a[36:39], a[240:243], v[60:63], a[36:39]
  s_waitcnt lgkmcnt(2)
  v_mul_f32 v26, v86, v26
  v_mul_f32 v27, v86, v27
  v_permlane32_swap_b32 v73, v19
  v_mul_f32 v28, v86, v28
  v_mul_f32 v29, v86, v29
  v_mfma_f32_16x16x32_bf16 a[60:63], a[244:247], v[60:63], a[60:63]
  ds_read_b64_tr_b16 a[240:241], v4 offset:4096
  v_mul_f32 v30, v86, v30
  v_mul_f32 v31, v86, v31
  v_mul_f32 v32, v86, v32
  v_permlane32_swap_b32 v74, v20
  v_mfma_f32_16x16x32_bf16 a[64:67], a[244:247], v[64:67], a[64:67]
  ds_read_b64_tr_b16 a[242:243], v4 offset:6144
  v_mul_f32 v33, v86, v33
  v_mul_f32 v34, v86, v34
  v_mul_f32 v35, v86, v35
  v_mul_f32 v36, v86, v36
  v_mfma_f32_16x16x32_bf16 a[68:71], a[244:247], v[68:71], a[68:71]
  s_waitcnt lgkmcnt(2)
  v_mul_f32 v37, v86, v37
  v_add_f32 v18, v18, v72
  v_mul_f32 v38, v86, v38
  v_mul_f32 v39, v86, v39
  v_cvt_pk_bf16_f32 v24, v24, v25
  v_mfma_f32_16x16x32_bf16 a[92:95], a[236:239], v[68:71], a[92:95]
  ds_read_b64_tr_b16 a[244:245], v5 offset:4096
  v_cvt_pk_bf16_f32 v25, v26, v27
  v_cvt_pk_bf16_f32 v28, v28, v29
  v_add_f32 v19, v19, v73
  v_cvt_pk_bf16_f32 v29, v30, v31
  v_mfma_f32_16x16x32_bf16 a[88:91], a[236:239], v[64:67], a[88:91]
  ds_read_b64_tr_b16 a[246:247], v5 offset:6144
  v_cvt_pk_bf16_f32 v32, v32, v33
  v_cvt_pk_bf16_f32 v33, v34, v35
  v_cvt_pk_bf16_f32 v36, v36, v37
  v_cvt_pk_bf16_f32 v37, v38, v39
  s_add_u32 s35, s51, 6144
  v_mfma_f32_16x16x32_bf16 a[84:87], a[236:239], v[60:63], a[84:87]
  buffer_store_dwordx4 v[40:43], v92, s[20:23], s35 offen offset:256 sc0 sc1
  buffer_store_dwordx4 v[44:47], v92, s[20:23], s35 offen offset:3328 sc0 sc1
  ds_write2_b64 v90, v[24:25], v[28:29] offset0:0 offset1:4
  ds_write2_b64 v90, v[32:33], v[36:37] offset0:8 offset1:12
  ds_read_b128 v[40:43], v91 offset:0
  ds_read_b128 v[44:47], v91 offset:1152
  s_waitcnt lgkmcnt(6)
  v_mfma_f32_16x16x32_bf16 a[108:111], a[240:243], v[60:63], a[108:111]
  ds_read_b64_tr_b16 a[236:237], v6 offset:4096
  v_add_f32 v20, v20, v74
  v_accvgpr_read_b32 v24, a104
  v_accvgpr_read_b32 v25, a105
  v_accvgpr_read_b32 v26, a106
  v_mfma_f32_16x16x32_bf16 a[112:115], a[240:243], v[64:67], a[112:115]
  ds_read_b64_tr_b16 a[238:239], v6 offset:6144
  v_accvgpr_read_b32 v27, a107
  v_mov_b32 v72, v18
  v_accvgpr_read_b32 v28, a128
  v_accvgpr_read_b32 v29, a129
  v_mfma_f32_16x16x32_bf16 a[116:119], a[240:243], v[68:71], a[116:119]
  s_waitcnt lgkmcnt(6)
  v_accvgpr_read_b32 v30, a130
  v_accvgpr_read_b32 v31, a131
  v_mov_b32 v73, v19
  v_mul_f32 v24, v86, v24
  v_mfma_f32_16x16x32_bf16 v[108:111], a[244:247], v[68:71], v[108:111]
  ds_read_b64_tr_b16 a[240:241], v7 offset:4096
  v_mul_f32 v25, v86, v25
  v_mul_f32 v26, v86, v26
  v_mov_b32 v74, v20
  v_mfma_f32_16x16x32_bf16 a[136:139], a[244:247], v[64:67], a[136:139]
  ds_read_b64_tr_b16 a[242:243], v7 offset:6144
  v_mul_f32 v27, v86, v27
  v_mul_f32 v28, v86, v28
  v_mul_f32 v29, v86, v29
  v_mul_f32 v30, v86, v30
  v_mfma_f32_16x16x32_bf16 a[132:135], a[244:247], v[60:63], a[132:135]
  s_waitcnt lgkmcnt(2)
  v_permlane16_swap_b32 v72, v18
  v_mul_f32 v31, v86, v31
  v_mul_f32 v120, v86, v120
  v_mul_f32 v121, v86, v121
  v_mfma_f32_16x16x32_bf16 v[124:127], a[236:239], v[60:63], v[124:127]
  ds_read_b64_tr_b16 a[244:245], v4 offset:8192
  v_permlane16_swap_b32 v73, v19
  v_mul_f32 v122, v86, v122
  v_mul_f32 v123, v86, v123
  v_mul_f32 v144, v86, v144
  v_mfma_f32_16x16x32_bf16 v[128:131], a[236:239], v[64:67], v[128:131]
  ds_read_b64_tr_b16 a[246:247], v4 offset:10240
  v_mul_f32 v145, v86, v145
  v_permlane16_swap_b32 v74, v20
  v_mul_f32 v146, v86, v146
  v_mfma_f32_16x16x32_bf16 v[132:135], a[236:239], v[68:71], v[132:135]
  s_waitcnt lgkmcnt(2)
  v_mul_f32 v147, v86, v147
  v_cvt_pk_bf16_f32 v24, v24, v25
  v_add_f32 v18, v18, v72
  v_cvt_pk_bf16_f32 v25, v26, v27
  v_mfma_f32_16x16x32_bf16 v[156:159], a[240:243], v[68:71], v[156:159]
  ds_read_b64_tr_b16 a[236:237], v5 offset:8192
  v_cvt_pk_bf16_f32 v28, v28, v29
  v_cvt_pk_bf16_f32 v29, v30, v31
  v_cvt_pk_bf16_f32 v120, v120, v121
  v_add_f32 v19, v19, v73
  v_mfma_f32_16x16x32_bf16 v[152:155], a[240:243], v[64:67], v[152:155]
  ds_read_b64_tr_b16 a[238:239], v5 offset:10240
  v_cvt_pk_bf16_f32 v121, v122, v123
  v_cvt_pk_bf16_f32 v144, v144, v145
  v_cvt_pk_bf16_f32 v145, v146, v147
  s_add_u32 s35, s51, 12288
  v_mfma_f32_16x16x32_bf16 v[148:151], a[240:243], v[60:63], v[148:151]
  buffer_store_dwordx4 v[40:43], v92, s[20:23], s35 offen offset:0 sc0 sc1
  buffer_store_dwordx4 v[44:47], v92, s[20:23], s35 offen offset:3072 sc0 sc1
  ds_write2_b64 v90, v[24:25], v[28:29] offset0:0 offset1:4
  ds_write2_b64 v90, v[120:121], v[144:145] offset0:8 offset1:12
  ds_read_b128 v[40:43], v91 offset:0
  ds_read_b128 v[44:47], v91 offset:1152
  s_waitcnt lgkmcnt(6)
  v_mfma_f32_16x16x32_bf16 v[172:175], a[244:247], v[60:63], v[172:175]
  ds_read_b64_tr_b16 a[240:241], v6 offset:8192
  v_add_f32 v20, v20, v74
  v_mul_f32 v168, v86, v168
  v_mul_f32 v169, v86, v169
  v_mfma_f32_16x16x32_bf16 v[176:179], a[244:247], v[64:67], v[176:179]
  ds_read_b64_tr_b16 a[242:243], v6 offset:10240
  v_mul_f32 v170, v86, v170
  v_rcp_f32 v87, v18
  v_mul_f32 v171, v86, v171
  v_mfma_f32_16x16x32_bf16 v[180:183], a[244:247], v[68:71], v[180:183]
  s_waitcnt lgkmcnt(6)
  v_mul_f32 v192, v86, v192
  v_mul_f32 v193, v86, v193
  v_rcp_f32 v88, v19
  v_mfma_f32_16x16x32_bf16 v[204:207], a[236:239], v[68:71], v[204:207]
  ds_read_b64_tr_b16 a[244:245], v7 offset:8192
  v_mul_f32 v194, v86, v194
  v_mul_f32 v195, v86, v195
  v_rcp_f32 v89, v20
  v_mfma_f32_16x16x32_bf16 v[200:203], a[236:239], v[64:67], v[200:203]
  ds_read_b64_tr_b16 a[246:247], v7 offset:10240
  v_mul_f32 v216, v86, v216
  v_mul_f32 v217, v86, v217
  v_mul_f32 v218, v86, v218
  v_mfma_f32_16x16x32_bf16 v[196:199], a[236:239], v[60:63], v[196:199]
  s_waitcnt lgkmcnt(2)
  v_max3_f32 v72, v18, v19, v20
  v_mul_f32 v219, v86, v219
  v_mul_f32 v240, v86, v240
  v_mfma_f32_16x16x32_bf16 v[220:223], a[240:243], v[60:63], v[220:223]
  v_mul_f32 v241, v86, v241
  v_max3_f32 v73, v87, v88, v89
  v_mul_f32 v242, v86, v242
  v_mfma_f32_16x16x32_bf16 v[224:227], a[240:243], v[64:67], v[224:227]
  v_mul_f32 v243, v86, v243
  v_mul_f32 v73, 0x49800000, v73
  v_cvt_pk_bf16_f32 v168, v168, v169
  v_mfma_f32_16x16x32_bf16 v[228:231], a[240:243], v[68:71], v[228:231]
  s_waitcnt lgkmcnt(0)
  v_cvt_pk_bf16_f32 v169, v170, v171
  v_cvt_pk_bf16_f32 v192, v192, v193
  v_max_f32 v72, v72, v73
  v_mfma_f32_16x16x32_bf16 v[252:255], a[244:247], v[68:71], v[252:255]
  v_cvt_pk_bf16_f32 v193, v194, v195
  v_cvt_pk_bf16_f32 v216, v216, v217
  v_cvt_pk_bf16_f32 v217, v218, v219
  v_mfma_f32_16x16x32_bf16 v[248:251], a[244:247], v[64:67], v[248:251]
  v_cmp_ngt_f32 vcc, 0x5d800000, v72
  v_cvt_pk_bf16_f32 v240, v240, v241
  v_cvt_pk_bf16_f32 v241, v242, v243
  s_add_u32 s35, s51, 12288
  v_mfma_f32_16x16x32_bf16 v[244:247], a[244:247], v[60:63], v[244:247]
  buffer_store_dwordx4 v[40:43], v92, s[20:23], s35 offen offset:128 sc0 sc1
  buffer_store_dwordx4 v[44:47], v92, s[20:23], s35 offen offset:3200 sc0 sc1
  ds_write2_b64 v90, v[168:169], v[192:193] offset0:0 offset1:4
  ds_write2_b64 v90, v[216:217], v[240:241] offset0:8 offset1:12
  ds_read_b128 v[40:43], v91 offset:0
  ds_read_b128 v[44:47], v91 offset:1152
  s_nop 0
  s_cmp_lg_u64 vcc, 0
  s_cselect_b32 s37, 1, 0
  s_lshl_b32 s37, s37, s33
  s_or_b32 s38, s38, s37
  v_accvgpr_read_b32 v24, a12
  v_accvgpr_read_b32 v25, a13
  v_accvgpr_read_b32 v26, a14
  v_accvgpr_read_b32 v27, a15
  v_accvgpr_read_b32 v28, a36
  v_accvgpr_read_b32 v29, a37
  v_accvgpr_read_b32 v30, a38
  v_accvgpr_read_b32 v31, a39
  v_accvgpr_read_b32 v32, a60
  v_accvgpr_read_b32 v33, a61
  v_accvgpr_read_b32 v34, a62
  v_accvgpr_read_b32 v35, a63
  v_accvgpr_read_b32 v36, a84
  v_accvgpr_read_b32 v37, a85
  v_accvgpr_read_b32 v38, a86
  v_accvgpr_read_b32 v39, a87
  v_mul_f32 v24, v87, v24
  v_mul_f32 v25, v87, v25
  v_mul_f32 v26, v87, v26
  v_mul_f32 v27, v87, v27
  v_mul_f32 v28, v87, v28
  v_mul_f32 v29, v87, v29
  v_mul_f32 v30, v87, v30
  v_mul_f32 v31, v87, v31
  v_mul_f32 v32, v87, v32
  v_mul_f32 v33, v87, v33
  v_mul_f32 v34, v87, v34
  v_mul_f32 v35, v87, v35
  v_mul_f32 v36, v87, v36
  v_mul_f32 v37, v87, v37
  v_mul_f32 v38, v87, v38
  v_mul_f32 v39, v87, v39
  v_cvt_pk_bf16_f32 v24, v24, v25
  v_cvt_pk_bf16_f32 v25, v26, v27
  v_cvt_pk_bf16_f32 v28, v28, v29
  v_cvt_pk_bf16_f32 v29, v30, v31
  v_cvt_pk_bf16_f32 v32, v32, v33
  v_cvt_pk_bf16_f32 v33, v34, v35
  v_cvt_pk_bf16_f32 v36, v36, v37
  v_cvt_pk_bf16_f32 v37, v38, v39
  s_waitcnt lgkmcnt(0)
  s_add_u32 s35, s51, 12288
  buffer_store_dwordx4 v[40:43], v92, s[20:23], s35 offen offset:256 sc0 sc1
  buffer_store_dwordx4 v[44:47], v92, s[20:23], s35 offen offset:3328 sc0 sc1
  ds_write2_b64 v90, v[24:25], v[28:29] offset0:0 offset1:4
  ds_write2_b64 v90, v[32:33], v[36:37] offset0:8 offset1:12
  ds_read_b128 v[40:43], v91 offset:0
  ds_read_b128 v[44:47], v91 offset:1152
  v_accvgpr_read_b32 v24, a108
  v_accvgpr_read_b32 v25, a109
  v_accvgpr_read_b32 v26, a110
  v_accvgpr_read_b32 v27, a111
  v_accvgpr_read_b32 v28, a132
  v_accvgpr_read_b32 v29, a133
  v_accvgpr_read_b32 v30, a134
  v_accvgpr_read_b32 v31, a135
  v_mul_f32 v24, v87, v24
  v_mul_f32 v25, v87, v25
  v_mul_f32 v26, v87, v26
  v_mul_f32 v27, v87, v27
  v_mul_f32 v28, v87, v28
  v_mul_f32 v29, v87, v29
  v_mul_f32 v30, v87, v30
  v_mul_f32 v31, v87, v31
  v_mul_f32 v124, v87, v124
  v_mul_f32 v125, v87, v125
  v_mul_f32 v126, v87, v126
  v_mul_f32 v127, v87, v127
  v_mul_f32 v148, v87, v148
  v_mul_f32 v149, v87, v149
  v_mul_f32 v150, v87, v150
  v_mul_f32 v151, v87, v151
  v_cvt_pk_bf16_f32 v24, v24, v25
  v_cvt_pk_bf16_f32 v25, v26, v27
  v_cvt_pk_bf16_f32 v28, v28, v29
  v_cvt_pk_bf16_f32 v29, v30, v31
  v_cvt_pk_bf16_f32 v124, v124, v125
  v_cvt_pk_bf16_f32 v125, v126, v127
  v_cvt_pk_bf16_f32 v148, v148, v149
  v_cvt_pk_bf16_f32 v149, v150, v151
  s_waitcnt lgkmcnt(0)
  s_add_u32 s35, s51, 18432
  buffer_store_dwordx4 v[40:43], v92, s[20:23], s35 offen offset:0 sc0 sc1
  buffer_store_dwordx4 v[44:47], v92, s[20:23], s35 offen offset:3072 sc0 sc1
  ds_write2_b64 v90, v[24:25], v[28:29] offset0:0 offset1:4
  ds_write2_b64 v90, v[124:125], v[148:149] offset0:8 offset1:12
  ds_read_b128 v[40:43], v91 offset:0
  ds_read_b128 v[44:47], v91 offset:1152
  v_mul_f32 v172, v87, v172
  v_mul_f32 v173, v87, v173
  v_mul_f32 v174, v87, v174
  v_mul_f32 v175, v87, v175
  v_mul_f32 v196, v87, v196
  v_mul_f32 v197, v87, v197
  v_mul_f32 v198, v87, v198
  v_mul_f32 v199, v87, v199
  v_mul_f32 v220, v87, v220
  v_mul_f32 v221, v87, v221
  v_mul_f32 v222, v87, v222
  v_mul_f32 v223, v87, v223
  v_mul_f32 v244, v87, v244
  v_mul_f32 v245, v87, v245
  v_mul_f32 v246, v87, v246
  v_mul_f32 v247, v87, v247
  v_cvt_pk_bf16_f32 v172, v172, v173
  v_cvt_pk_bf16_f32 v173, v174, v175
  v_cvt_pk_bf16_f32 v196, v196, v197
  v_cvt_pk_bf16_f32 v197, v198, v199
  v_cvt_pk_bf16_f32 v220, v220, v221
  v_cvt_pk_bf16_f32 v221, v222, v223
  v_cvt_pk_bf16_f32 v244, v244, v245
  v_cvt_pk_bf16_f32 v245, v246, v247
  s_waitcnt lgkmcnt(0)
  s_add_u32 s35, s51, 18432
  buffer_store_dwordx4 v[40:43], v92, s[20:23], s35 offen offset:128 sc0 sc1
  buffer_store_dwordx4 v[44:47], v92, s[20:23], s35 offen offset:3200 sc0 sc1
  ds_write2_b64 v90, v[172:173], v[196:197] offset0:0 offset1:4
  ds_write2_b64 v90, v[220:221], v[244:245] offset0:8 offset1:12
  ds_read_b128 v[40:43], v91 offset:0
  ds_read_b128 v[44:47], v91 offset:1152
  v_accvgpr_read_b32 v24, a16
  v_accvgpr_read_b32 v25, a17
  v_accvgpr_read_b32 v26, a18
  v_accvgpr_read_b32 v27, a19
  v_accvgpr_read_b32 v28, a40
  v_accvgpr_read_b32 v29, a41
  v_accvgpr_read_b32 v30, a42
  v_accvgpr_read_b32 v31, a43
  v_accvgpr_read_b32 v32, a64
  v_accvgpr_read_b32 v33, a65
  v_accvgpr_read_b32 v34, a66
  v_accvgpr_read_b32 v35, a67
  v_accvgpr_read_b32 v36, a88
  v_accvgpr_read_b32 v37, a89
  v_accvgpr_read_b32 v38, a90
  v_accvgpr_read_b32 v39, a91
  v_mul_f32 v24, v88, v24
  v_mul_f32 v25, v88, v25
  v_mul_f32 v26, v88, v26
  v_mul_f32 v27, v88, v27
  v_mul_f32 v28, v88, v28
  v_mul_f32 v29, v88, v29
  v_mul_f32 v30, v88, v30
  v_mul_f32 v31, v88, v31
  v_mul_f32 v32, v88, v32
  v_mul_f32 v33, v88, v33
  v_mul_f32 v34, v88, v34
  v_mul_f32 v35, v88, v35
  v_mul_f32 v36, v88, v36
  v_mul_f32 v37, v88, v37
  v_mul_f32 v38, v88, v38
  v_mul_f32 v39, v88, v39
  v_cvt_pk_bf16_f32 v24, v24, v25
  v_cvt_pk_bf16_f32 v25, v26, v27
  v_cvt_pk_bf16_f32 v28, v28, v29
  v_cvt_pk_bf16_f32 v29, v30, v31
  v_cvt_pk_bf16_f32 v32, v32, v33
  v_cvt_pk_bf16_f32 v33, v34, v35
  v_cvt_pk_bf16_f32 v36, v36, v37
  v_cvt_pk_bf16_f32 v37, v38, v39
  s_waitcnt lgkmcnt(0)
  s_add_u32 s35, s51, 18432
  buffer_store_dwordx4 v[40:43], v92, s[20:23], s35 offen offset:256 sc0 sc1
  buffer_store_dwordx4 v[44:47], v92, s[20:23], s35 offen offset:3328 sc0 sc1
  ds_write2_b64 v90, v[24:25], v[28:29] offset0:0 offset1:4
  ds_write2_b64 v90, v[32:33], v[36:37] offset0:8 offset1:12
  ds_read_b128 v[40:43], v91 offset:0
  ds_read_b128 v[44:47], v91 offset:1152
  v_accvgpr_read_b32 v24, a112
  v_accvgpr_read_b32 v25, a113
  v_accvgpr_read_b32 v26, a114
  v_accvgpr_read_b32 v27, a115
  v_accvgpr_read_b32 v28, a136
  v_accvgpr_read_b32 v29, a137
  v_accvgpr_read_b32 v30, a138
  v_accvgpr_read_b32 v31, a139
  v_mul_f32 v24, v88, v24
  v_mul_f32 v25, v88, v25
  v_mul_f32 v26, v88, v26
  v_mul_f32 v27, v88, v27
  v_mul_f32 v28, v88, v28
  v_mul_f32 v29, v88, v29
  v_mul_f32 v30, v88, v30
  v_mul_f32 v31, v88, v31
  v_mul_f32 v128, v88, v128
  v_mul_f32 v129, v88, v129
  v_mul_f32 v130, v88, v130
  v_mul_f32 v131, v88, v131
  v_mul_f32 v152, v88, v152
  v_mul_f32 v153, v88, v153
  v_mul_f32 v154, v88, v154
  v_mul_f32 v155, v88, v155
  v_cvt_pk_bf16_f32 v24, v24, v25
  v_cvt_pk_bf16_f32 v25, v26, v27
  v_cvt_pk_bf16_f32 v28, v28, v29
  v_cvt_pk_bf16_f32 v29, v30, v31
  v_cvt_pk_bf16_f32 v128, v128, v129
  v_cvt_pk_bf16_f32 v129, v130, v131
  v_cvt_pk_bf16_f32 v152, v152, v153
  v_cvt_pk_bf16_f32 v153, v154, v155
  s_waitcnt lgkmcnt(0)
  s_add_u32 s35, s51, 24576
  buffer_store_dwordx4 v[40:43], v92, s[20:23], s35 offen offset:0 sc0 sc1
  buffer_store_dwordx4 v[44:47], v92, s[20:23], s35 offen offset:3072 sc0 sc1
  ds_write2_b64 v90, v[24:25], v[28:29] offset0:0 offset1:4
  ds_write2_b64 v90, v[128:129], v[152:153] offset0:8 offset1:12
  ds_read_b128 v[40:43], v91 offset:0
  ds_read_b128 v[44:47], v91 offset:1152
  v_mul_f32 v176, v88, v176
  v_mul_f32 v177, v88, v177
  v_mul_f32 v178, v88, v178
  v_mul_f32 v179, v88, v179
  v_mul_f32 v200, v88, v200
  v_mul_f32 v201, v88, v201
  v_mul_f32 v202, v88, v202
  v_mul_f32 v203, v88, v203
  v_mul_f32 v224, v88, v224
  v_mul_f32 v225, v88, v225
  v_mul_f32 v226, v88, v226
  v_mul_f32 v227, v88, v227
  v_mul_f32 v248, v88, v248
  v_mul_f32 v249, v88, v249
  v_mul_f32 v250, v88, v250
  v_mul_f32 v251, v88, v251
  v_cvt_pk_bf16_f32 v176, v176, v177
  v_cvt_pk_bf16_f32 v177, v178, v179
  v_cvt_pk_bf16_f32 v200, v200, v201
  v_cvt_pk_bf16_f32 v201, v202, v203
  v_cvt_pk_bf16_f32 v224, v224, v225
  v_cvt_pk_bf16_f32 v225, v226, v227
  v_cvt_pk_bf16_f32 v248, v248, v249
  v_cvt_pk_bf16_f32 v249, v250, v251
  s_waitcnt lgkmcnt(0)
  s_add_u32 s35, s51, 24576
  buffer_store_dwordx4 v[40:43], v92, s[20:23], s35 offen offset:128 sc0 sc1
  buffer_store_dwordx4 v[44:47], v92, s[20:23], s35 offen offset:3200 sc0 sc1
  ds_write2_b64 v90, v[176:177], v[200:201] offset0:0 offset1:4
  ds_write2_b64 v90, v[224:225], v[248:249] offset0:8 offset1:12
  ds_read_b128 v[40:43], v91 offset:0
  ds_read_b128 v[44:47], v91 offset:1152
  v_accvgpr_read_b32 v24, a20
  v_accvgpr_read_b32 v25, a21
  v_accvgpr_read_b32 v26, a22
  v_accvgpr_read_b32 v27, a23
  v_accvgpr_read_b32 v28, a44
  v_accvgpr_read_b32 v29, a45
  v_accvgpr_read_b32 v30, a46
  v_accvgpr_read_b32 v31, a47
  v_accvgpr_read_b32 v32, a68
  v_accvgpr_read_b32 v33, a69
  v_accvgpr_read_b32 v34, a70
  v_accvgpr_read_b32 v35, a71
  v_accvgpr_read_b32 v36, a92
  v_accvgpr_read_b32 v37, a93
  v_accvgpr_read_b32 v38, a94
  v_accvgpr_read_b32 v39, a95
  v_mul_f32 v24, v89, v24
  v_mul_f32 v25, v89, v25
  v_mul_f32 v26, v89, v26
  v_mul_f32 v27, v89, v27
  v_mul_f32 v28, v89, v28
  v_mul_f32 v29, v89, v29
  v_mul_f32 v30, v89, v30
  v_mul_f32 v31, v89, v31
  v_mul_f32 v32, v89, v32
  v_mul_f32 v33, v89, v33
  v_mul_f32 v34, v89, v34
  v_mul_f32 v35, v89, v35
  v_mul_f32 v36, v89, v36
  v_mul_f32 v37, v89, v37
  v_mul_f32 v38, v89, v38
  v_mul_f32 v39, v89, v39
  v_cvt_pk_bf16_f32 v24, v24, v25
  v_cvt_pk_bf16_f32 v25, v26, v27
  v_cvt_pk_bf16_f32 v28, v28, v29
  v_cvt_pk_bf16_f32 v29, v30, v31
  v_cvt_pk_bf16_f32 v32, v32, v33
  v_cvt_pk_bf16_f32 v33, v34, v35
  v_cvt_pk_bf16_f32 v36, v36, v37
  v_cvt_pk_bf16_f32 v37, v38, v39
  s_waitcnt lgkmcnt(0)
  s_add_u32 s35, s51, 24576
  buffer_store_dwordx4 v[40:43], v92, s[20:23], s35 offen offset:256 sc0 sc1
  buffer_store_dwordx4 v[44:47], v92, s[20:23], s35 offen offset:3328 sc0 sc1
  ds_write2_b64 v90, v[24:25], v[28:29] offset0:0 offset1:4
  ds_write2_b64 v90, v[32:33], v[36:37] offset0:8 offset1:12
  ds_read_b128 v[40:43], v91 offset:0
  ds_read_b128 v[44:47], v91 offset:1152
  v_accvgpr_read_b32 v24, a116
  v_accvgpr_read_b32 v25, a117
  v_accvgpr_read_b32 v26, a118
  v_accvgpr_read_b32 v27, a119
  v_mul_f32 v24, v89, v24
  v_mul_f32 v25, v89, v25
  v_mul_f32 v26, v89, v26
  v_mul_f32 v27, v89, v27
  v_mul_f32 v108, v89, v108
  v_mul_f32 v109, v89, v109
  v_mul_f32 v110, v89, v110
  v_mul_f32 v111, v89, v111
  v_mul_f32 v132, v89, v132
  v_mul_f32 v133, v89, v133
  v_mul_f32 v134, v89, v134
  v_mul_f32 v135, v89, v135
  v_mul_f32 v156, v89, v156
  v_mul_f32 v157, v89, v157
  v_mul_f32 v158, v89, v158
  v_mul_f32 v159, v89, v159
  v_cvt_pk_bf16_f32 v24, v24, v25
  v_cvt_pk_bf16_f32 v25, v26, v27
  v_cvt_pk_bf16_f32 v108, v108, v109
  v_cvt_pk_bf16_f32 v109, v110, v111
  v_cvt_pk_bf16_f32 v132, v132, v133
  v_cvt_pk_bf16_f32 v133, v134, v135
  v_cvt_pk_bf16_f32 v156, v156, v157
  v_cvt_pk_bf16_f32 v157, v158, v159
  s_waitcnt lgkmcnt(0)
  s_add_u32 s35, s51, 30720
  buffer_store_dwordx4 v[40:43], v92, s[20:23], s35 offen offset:0 sc0 sc1
  buffer_store_dwordx4 v[44:47], v92, s[20:23], s35 offen offset:3072 sc0 sc1
  ds_write2_b64 v90, v[24:25], v[108:109] offset0:0 offset1:4
  ds_write2_b64 v90, v[132:133], v[156:157] offset0:8 offset1:12
  ds_read_b128 v[40:43], v91 offset:0
  ds_read_b128 v[44:47], v91 offset:1152
  v_mul_f32 v180, v89, v180
  v_mul_f32 v181, v89, v181
  v_mul_f32 v182, v89, v182
  v_mul_f32 v183, v89, v183
  v_mul_f32 v204, v89, v204
  v_mul_f32 v205, v89, v205
  v_mul_f32 v206, v89, v206
  v_mul_f32 v207, v89, v207
  v_mul_f32 v228, v89, v228
  v_mul_f32 v229, v89, v229
  v_mul_f32 v230, v89, v230
  v_mul_f32 v231, v89, v231
  v_mul_f32 v252, v89, v252
  v_mul_f32 v253, v89, v253
  v_mul_f32 v254, v89, v254
  v_mul_f32 v255, v89, v255
  v_cvt_pk_bf16_f32 v180, v180, v181
  v_cvt_pk_bf16_f32 v181, v182, v183
  v_cvt_pk_bf16_f32 v204, v204, v205
  v_cvt_pk_bf16_f32 v205, v206, v207
  v_cvt_pk_bf16_f32 v228, v228, v229
  v_cvt_pk_bf16_f32 v229, v230, v231
  v_cvt_pk_bf16_f32 v252, v252, v253
  v_cvt_pk_bf16_f32 v253, v254, v255
  s_waitcnt lgkmcnt(0)
  s_add_u32 s35, s51, 30720
  buffer_store_dwordx4 v[40:43], v92, s[20:23], s35 offen offset:128 sc0 sc1
  buffer_store_dwordx4 v[44:47], v92, s[20:23], s35 offen offset:3200 sc0 sc1
  ds_write2_b64 v90, v[180:181], v[204:205] offset0:0 offset1:4
  ds_write2_b64 v90, v[228:229], v[252:253] offset0:8 offset1:12
  ds_read_b128 v[40:43], v91 offset:0
  ds_read_b128 v[44:47], v91 offset:1152
  s_add_u32 s35, s51, 30720
  s_waitcnt lgkmcnt(0)
  buffer_store_dwordx4 v[40:43], v92, s[20:23], s35 offen offset:256 sc0 sc1
  buffer_store_dwordx4 v[44:47], v92, s[20:23], s35 offen offset:3328 sc0 sc1
  s_cmp_lg_u32 s38, 0
  s_cbranch_scc1 L_fb
L_done:
  s_endpgm
L_epi:
  v_mul_f32 v160, v96, v160
  v_mul_f32 v161, v96, v161
  v_mul_f32 v162, v96, v162
  v_mul_f32 v163, v96, v163
  v_mul_f32 v184, v96, v184
  v_mul_f32 v185, v96, v185
  v_mul_f32 v186, v96, v186
  v_mul_f32 v187, v96, v187
  v_mul_f32 v208, v96, v208
  v_mul_f32 v209, v96, v209
  v_mul_f32 v210, v96, v210
  v_mul_f32 v211, v96, v211
  v_mul_f32 v232, v96, v232
  v_mul_f32 v233, v96, v233
  v_mul_f32 v234, v96, v234
  v_mul_f32 v235, v96, v235
  v_cvt_pk_bf16_f32 v160, v160, v161
  v_cvt_pk_bf16_f32 v161, v162, v163
  v_cvt_pk_bf16_f32 v184, v184, v185
  v_cvt_pk_bf16_f32 v185, v186, v187
  v_cvt_pk_bf16_f32 v208, v208, v209
  v_cvt_pk_bf16_f32 v209, v210, v211
  v_cvt_pk_bf16_f32 v232, v232, v233
  v_cvt_pk_bf16_f32 v233, v234, v235
  ds_write2_b64 v102, v[160:161], v[184:185] offset0:0 offset1:4
  ds_write2_b64 v102, v[208:209], v[232:233] offset0:8 offset1:12
  ds_read_b128 v[64:67], v103 offset:0
  ds_read_b128 v[68:71], v103 offset:1152
  v_accvgpr_read_b32 v48, a96
  v_accvgpr_read_b32 v49, a97
  v_accvgpr_read_b32 v50, a98
  v_accvgpr_read_b32 v51, a99
  v_accvgpr_read_b32 v52, a120
  v_accvgpr_read_b32 v53, a121
  v_accvgpr_read_b32 v54, a122
  v_accvgpr_read_b32 v55, a123
  v_mul_f32 v48, v96, v48
  v_mul_f32 v49, v96, v49
  v_mul_f32 v50, v96, v50
  v_mul_f32 v51, v96, v51
  v_mul_f32 v52, v96, v52
  v_mul_f32 v53, v96, v53
  v_mul_f32 v54, v96, v54
  v_mul_f32 v55, v96, v55
  v_mul_f32 v112, v96, v112
  v_mul_f32 v113, v96, v113
  v_mul_f32 v114, v96, v114
  v_mul_f32 v115, v96, v115
  v_mul_f32 v136, v96, v136
  v_mul_f32 v137, v96, v137
  v_mul_f32 v138, v96, v138
  v_mul_f32 v139, v96, v139
  v_cvt_pk_bf16_f32 v48, v48, v49
  v_cvt_pk_bf16_f32 v49, v50, v51
  v_cvt_pk_bf16_f32 v52, v52, v53
  v_cvt_pk_bf16_f32 v53, v54, v55
  v_cvt_pk_bf16_f32 v112, v112, v113
  v_cvt_pk_bf16_f32 v113, v114, v115
  v_cvt_pk_bf16_f32 v136, v136, v137
  v_cvt_pk_bf16_f32 v137, v138, v139
  s_waitcnt lgkmcnt(0)
  s_add_u32 s35, s51, 0
  buffer_store_dwordx4 v[64:67], v104, s[20:23], s35 offen offset:256 sc1
  buffer_store_dwordx4 v[68:71], v104, s[20:23], s35 offen offset:3328 sc1
  ds_write2_b64 v102, v[48:49], v[52:53] offset0:0 offset1:4
  ds_write2_b64 v102, v[112:113], v[136:137] offset0:8 offset1:12
  ds_read_b128 v[64:67], v103 offset:0
  ds_read_b128 v[68:71], v103 offset:1152
  v_accvgpr_read_b32 v48, a0
  v_accvgpr_read_b32 v49, a1
  v_accvgpr_read_b32 v50, a2
  v_accvgpr_read_b32 v51, a3
  v_accvgpr_read_b32 v52, a24
  v_accvgpr_read_b32 v53, a25
  v_accvgpr_read_b32 v54, a26
  v_accvgpr_read_b32 v55, a27
  v_accvgpr_read_b32 v56, a48
  v_accvgpr_read_b32 v57, a49
  v_accvgpr_read_b32 v58, a50
  v_accvgpr_read_b32 v59, a51
  v_accvgpr_read_b32 v60, a72
  v_accvgpr_read_b32 v61, a73
  v_accvgpr_read_b32 v62, a74
  v_accvgpr_read_b32 v63, a75
  v_mul_f32 v48, v96, v48
  v_mul_f32 v49, v96, v49
  v_mul_f32 v50, v96, v50
  v_mul_f32 v51, v96, v51
  v_mul_f32 v52, v96, v52
  v_mul_f32 v53, v96, v53
  v_mul_f32 v54, v96, v54
  v_mul_f32 v55, v96, v55
  v_mul_f32 v56, v96, v56
  v_mul_f32 v57, v96, v57
  v_mul_f32 v58, v96, v58
  v_mul_f32 v59, v96, v59
  v_mul_f32 v60, v96, v60
  v_mul_f32 v61, v96, v61
  v_mul_f32 v62, v96, v62
  v_mul_f32 v63, v96, v63
  v_cvt_pk_bf16_f32 v48, v48, v49
  v_cvt_pk_bf16_f32 v49, v50, v51
  v_cvt_pk_bf16_f32 v52, v52, v53
  v_cvt_pk_bf16_f32 v53, v54, v55
  v_cvt_pk_bf16_f32 v56, v56, v57
  v_cvt_pk_bf16_f32 v57, v58, v59
  v_cvt_pk_bf16_f32 v60, v60, v61
  v_cvt_pk_bf16_f32 v61, v62, v63
  s_waitcnt lgkmcnt(0)
  s_add_u32 s35, s51, 0
  buffer_store_dwordx4 v[64:67], v104, s[20:23], s35 offen offset:128 sc1
  buffer_store_dwordx4 v[68:71], v104, s[20:23], s35 offen offset:3200 sc1
  ds_write2_b64 v102, v[48:49], v[52:53] offset0:0 offset1:4
  ds_write2_b64 v102, v[56:57], v[60:61] offset0:8 offset1:12
  ds_read_b128 v[64:67], v103 offset:0
  ds_read_b128 v[68:71], v103 offset:1152
  v_mul_f32 v164, v97, v164
  v_mul_f32 v165, v97, v165
  v_mul_f32 v166, v97, v166
  v_mul_f32 v167, v97, v167
  v_mul_f32 v188, v97, v188
  v_mul_f32 v189, v97, v189
  v_mul_f32 v190, v97, v190
  v_mul_f32 v191, v97, v191
  v_mul_f32 v212, v97, v212
  v_mul_f32 v213, v97, v213
  v_mul_f32 v214, v97, v214
  v_mul_f32 v215, v97, v215
  v_mul_f32 v236, v97, v236
  v_mul_f32 v237, v97, v237
  v_mul_f32 v238, v97, v238
  v_mul_f32 v239, v97, v239
  v_cvt_pk_bf16_f32 v164, v164, v165
  v_cvt_pk_bf16_f32 v165, v166, v167
  v_cvt_pk_bf16_f32 v188, v188, v189
  v_cvt_pk_bf16_f32 v189, v190, v191
  v_cvt_pk_bf16_f32 v212, v212, v213
  v_cvt_pk_bf16_f32 v213, v214, v215
  v_cvt_pk_bf16_f32 v236, v236, v237
  v_cvt_pk_bf16_f32 v237, v238, v239
  s_waitcnt lgkmcnt(0)
  s_add_u32 s35, s51, 0
  buffer_store_dwordx4 v[64:67], v104, s[20:23], s35 offen offset:0 sc1
  buffer_store_dwordx4 v[68:71], v104, s[20:23], s35 offen offset:3072 sc1
  ds_write2_b64 v102, v[164:165], v[188:189] offset0:0 offset1:4
  ds_write2_b64 v102, v[212:213], v[236:237] offset0:8 offset1:12
  ds_read_b128 v[64:67], v103 offset:0
  ds_read_b128 v[68:71], v103 offset:1152
  v_accvgpr_read_b32 v48, a100
  v_accvgpr_read_b32 v49, a101
  v_accvgpr_read_b32 v50, a102
  v_accvgpr_read_b32 v51, a103
  v_accvgpr_read_b32 v52, a124
  v_accvgpr_read_b32 v53, a125
  v_accvgpr_read_b32 v54, a126
  v_accvgpr_read_b32 v55, a127
  v_mul_f32 v48, v97, v48
  v_mul_f32 v49, v97, v49
  v_mul_f32 v50, v97, v50
  v_mul_f32 v51, v97, v51
  v_mul_f32 v52, v97, v52
  v_mul_f32 v53, v97, v53
  v_mul_f32 v54, v97, v54
  v_mul_f32 v55, v97, v55
  v_mul_f32 v116, v97, v116
  v_mul_f32 v117, v97, v117
  v_mul_f32 v118, v97, v118
  v_mul_f32 v119, v97, v119
  v_mul_f32 v140, v97, v140
  v_mul_f32 v141, v97, v141
  v_mul_f32 v142, v97, v142
  v_mul_f32 v143, v97, v143
  v_cvt_pk_bf16_f32 v48, v48, v49
  v_cvt_pk_bf16_f32 v49, v50, v51
  v_cvt_pk_bf16_f32 v52, v52, v53
  v_cvt_pk_bf16_f32 v53, v54, v55
  v_cvt_pk_bf16_f32 v116, v116, v117
  v_cvt_pk_bf16_f32 v117, v118, v119
  v_cvt_pk_bf16_f32 v140, v140, v141
  v_cvt_pk_bf16_f32 v141, v142, v143
  s_waitcnt lgkmcnt(0)
  s_add_u32 s35, s51, 6144
  buffer_store_dwordx4 v[64:67], v104, s[20:23], s35 offen offset:256 sc1
  buffer_store_dwordx4 v[68:71], v104, s[20:23], s35 offen offset:3328 sc1
  ds_write2_b64 v102, v[48:49], v[52:53] offset0:0 offset1:4
  ds_write2_b64 v102, v[116:117], v[140:141] offset0:8 offset1:12
  ds_read_b128 v[64:67], v103 offset:0
  ds_read_b128 v[68:71], v103 offset:1152
  v_accvgpr_read_b32 v48, a4
  v_accvgpr_read_b32 v49, a5
  v_accvgpr_read_b32 v50, a6
  v_accvgpr_read_b32 v51, a7
  v_accvgpr_read_b32 v52, a28
  v_accvgpr_read_b32 v53, a29
  v_accvgpr_read_b32 v54, a30
  v_accvgpr_read_b32 v55, a31
  v_accvgpr_read_b32 v56, a52
  v_accvgpr_read_b32 v57, a53
  v_accvgpr_read_b32 v58, a54
  v_accvgpr_read_b32 v59, a55
  v_accvgpr_read_b32 v60, a76
  v_accvgpr_read_b32 v61, a77
  v_accvgpr_read_b32 v62, a78
  v_accvgpr_read_b32 v63, a79
  v_mul_f32 v48, v97, v48
  v_mul_f32 v49, v97, v49
  v_mul_f32 v50, v97, v50
  v_mul_f32 v51, v97, v51
  v_mul_f32 v52, v97, v52
  v_mul_f32 v53, v97, v53
  v_mul_f32 v54, v97, v54
  v_mul_f32 v55, v97, v55
  v_mul_f32 v56, v97, v56
  v_mul_f32 v57, v97, v57
  v_mul_f32 v58, v97, v58
  v_mul_f32 v59, v97, v59
  v_mul_f32 v60, v97, v60
  v_mul_f32 v61, v97, v61
  v_mul_f32 v62, v97, v62
  v_mul_f32 v63, v97, v63
  v_cvt_pk_bf16_f32 v48, v48, v49
  v_cvt_pk_bf16_f32 v49, v50, v51
  v_cvt_pk_bf16_f32 v52, v52, v53
  v_cvt_pk_bf16_f32 v53, v54, v55
  v_cvt_pk_bf16_f32 v56, v56, v57
  v_cvt_pk_bf16_f32 v57, v58, v59
  v_cvt_pk_bf16_f32 v60, v60, v61
  v_cvt_pk_bf16_f32 v61, v62, v63
  s_waitcnt lgkmcnt(0)
  s_add_u32 s35, s51, 6144
  buffer_store_dwordx4 v[64:67], v104, s[20:23], s35 offen offset:128 sc1
  buffer_store_dwordx4 v[68:71], v104, s[20:23], s35 offen offset:3200 sc1
  ds_write2_b64 v102, v[48:49], v[52:53] offset0:0 offset1:4
  ds_write2_b64 v102, v[56:57], v[60:61] offset0:8 offset1:12
  ds_read_b128 v[64:67], v103 offset:0
  ds_read_b128 v[68:71], v103 offset:1152
  v_mul_f32 v168, v98, v168
  v_mul_f32 v169, v98, v169
  v_mul_f32 v170, v98, v170
  v_mul_f32 v171, v98, v171
  v_mul_f32 v192, v98, v192
  v_mul_f32 v193, v98, v193
  v_mul_f32 v194, v98, v194
  v_mul_f32 v195, v98, v195
  v_mul_f32 v216, v98, v216
  v_mul_f32 v217, v98, v217
  v_mul_f32 v218, v98, v218
  v_mul_f32 v219, v98, v219
  v_mul_f32 v240, v98, v240
  v_mul_f32 v241, v98, v241
  v_mul_f32 v242, v98, v242
  v_mul_f32 v243, v98, v243
  v_cvt_pk_bf16_f32 v168, v168, v169
  v_cvt_pk_bf16_f32 v169, v170, v171
  v_cvt_pk_bf16_f32 v192, v192, v193
  v_cvt_pk_bf16_f32 v193, v194, v195
  v_cvt_pk_bf16_f32 v216, v216, v217
  v_cvt_pk_bf16_f32 v217, v218, v219
  v_cvt_pk_bf16_f32 v240, v240, v241
  v_cvt_pk_bf16_f32 v241, v242, v243
  s_waitcnt lgkmcnt(0)
  s_add_u32 s35, s51, 6144
  buffer_store_dwordx4 v[64:67], v104, s[20:23], s35 offen offset:0 sc1
  buffer_store_dwordx4 v[68:71], v104, s[20:23], s35 offen offset:3072 sc1
  ds_write2_b64 v102, v[168:169], v[192:193] offset0:0 offset1:4
  ds_write2_b64 v102, v[216:217], v[240:241] offset0:8 offset1:12
  ds_read_b128 v[64:67], v103 offset:0
  ds_read_b128 v[68:71], v103 offset:1152
  v_accvgpr_read_b32 v48, a104
  v_accvgpr_read_b32 v49, a105
  v_accvgpr_read_b32 v50, a106
  v_accvgpr_read_b32 v51, a107
  v_accvgpr_read_b32 v52, a128
  v_accvgpr_read_b32 v53, a129
  v_accvgpr_read_b32 v54, a130
  v_accvgpr_read_b32 v55, a131
  v_mul_f32 v48, v98, v48
  v_mul_f32 v49, v98, v49
  v_mul_f32 v50, v98, v50
  v_mul_f32 v51, v98, v51
  v_mul_f32 v52, v98, v52
  v_mul_f32 v53, v98, v53
  v_mul_f32 v54, v98, v54
  v_mul_f32 v55, v98, v55
  v_mul_f32 v120, v98, v120
  v_mul_f32 v121, v98, v121
  v_mul_f32 v122, v98, v122
  v_mul_f32 v123, v98, v123
  v_mul_f32 v144, v98, v144
  v_mul_f32 v145, v98, v145
  v_mul_f32 v146, v98, v146
  v_mul_f32 v147, v98, v147
  v_cvt_pk_bf16_f32 v48, v48, v49
  v_cvt_pk_bf16_f32 v49, v50, v51
  v_cvt_pk_bf16_f32 v52, v52, v53
  v_cvt_pk_bf16_f32 v53, v54, v55
  v_cvt_pk_bf16_f32 v120, v120, v121
  v_cvt_pk_bf16_f32 v121, v122, v123
  v_cvt_pk_bf16_f32 v144, v144, v145
  v_cvt_pk_bf16_f32 v145, v146, v147
  s_waitcnt lgkmcnt(0)
  s_add_u32 s35, s51, 12288
  buffer_store_dwordx4 v[64:67], v104, s[20:23], s35 offen offset:256 sc1
  buffer_store_dwordx4 v[68:71], v104, s[20:23], s35 offen offset:3328 sc1
  ds_write2_b64 v102, v[48:49], v[52:53] offset0:0 offset1:4
  ds_write2_b64 v102, v[120:121], v[144:145] offset0:8 offset1:12
  ds_read_b128 v[64:67], v103 offset:0
  ds_read_b128 v[68:71], v103 offset:1152
  v_accvgpr_read_b32 v48, a8
  v_accvgpr_read_b32 v49, a9
  v_accvgpr_read_b32 v50, a10
  v_accvgpr_read_b32 v51, a11
  v_accvgpr_read_b32 v52, a32
  v_accvgpr_read_b32 v53, a33
  v_accvgpr_read_b32 v54, a34
  v_accvgpr_read_b32 v55, a35
  v_accvgpr_read_b32 v56, a56
  v_accvgpr_read_b32 v57, a57
  v_accvgpr_read_b32 v58, a58
  v_accvgpr_read_b32 v59, a59
  v_accvgpr_read_b32 v60, a80
  v_accvgpr_read_b32 v61, a81
  v_accvgpr_read_b32 v62, a82
  v_accvgpr_read_b32 v63, a83
  v_mul_f32 v48, v98, v48
  v_mul_f32 v49, v98, v49
  v_mul_f32 v50, v98, v50
  v_mul_f32 v51, v98, v51
  v_mul_f32 v52, v98, v52
  v_mul_f32 v53, v98, v53
  v_mul_f32 v54, v98, v54
  v_mul_f32 v55, v98, v55
  v_mul_f32 v56, v98, v56
  v_mul_f32 v57, v98, v57
  v_mul_f32 v58, v98, v58
  v_mul_f32 v59, v98, v59
  v_mul_f32 v60, v98, v60
  v_mul_f32 v61, v98, v61
  v_mul_f32 v62, v98, v62
  v_mul_f32 v63, v98, v63
  v_cvt_pk_bf16_f32 v48, v48, v49
  v_cvt_pk_bf16_f32 v49, v50, v51
  v_cvt_pk_bf16_f32 v52, v52, v53
  v_cvt_pk_bf16_f32 v53, v54, v55
  v_cvt_pk_bf16_f32 v56, v56, v57
  v_cvt_pk_bf16_f32 v57, v58, v59
  v_cvt_pk_bf16_f32 v60, v60, v61
  v_cvt_pk_bf16_f32 v61, v62, v63
  s_waitcnt lgkmcnt(0)
  s_add_u32 s35, s51, 12288
  buffer_store_dwordx4 v[64:67], v104, s[20:23], s35 offen offset:128 sc1
  buffer_store_dwordx4 v[68:71], v104, s[20:23], s35 offen offset:3200 sc1
  ds_write2_b64 v102, v[48:49], v[52:53] offset0:0 offset1:4
  ds_write2_b64 v102, v[56:57], v[60:61] offset0:8 offset1:12
  ds_read_b128 v[64:67], v103 offset:0
  ds_read_b128 v[68:71], v103 offset:1152
  v_mul_f32 v172, v99, v172
  v_mul_f32 v173, v99, v173
  v_mul_f32 v174, v99, v174
  v_mul_f32 v175, v99, v175
  v_mul_f32 v196, v99, v196
  v_mul_f32 v197, v99, v197
  v_mul_f32 v198, v99, v198
  v_mul_f32 v199, v99, v199
  v_mul_f32 v220, v99, v220
  v_mul_f32 v221, v99, v221
  v_mul_f32 v222, v99, v222
  v_mul_f32 v223, v99, v223
  v_mul_f32 v244, v99, v244
  v_mul_f32 v245, v99, v245
  v_mul_f32 v246, v99, v246
  v_mul_f32 v247, v99, v247
  v_cvt_pk_bf16_f32 v172, v172, v173
  v_cvt_pk_bf16_f32 v173, v174, v175
  v_cvt_pk_bf16_f32 v196, v196, v197
  v_cvt_pk_bf16_f32 v197, v198, v199
  v_cvt_pk_bf16_f32 v220, v220, v221
  v_cvt_pk_bf16_f32 v221, v222, v223
  v_cvt_pk_bf16_f32 v244, v244, v245
  v_cvt_pk_bf16_f32 v245, v246, v247
  s_waitcnt lgkmcnt(0)
  s_add_u32 s35, s51, 12288
  buffer_store_dwordx4 v[64:67], v104, s[20:23], s35 offen offset:0 sc1
  buffer_store_dwordx4 v[68:71], v104, s[20:23], s35 offen offset:3072 sc1
  ds_write2_b64 v102, v[172:173], v[196:197] offset0:0 offset1:4
  ds_write2_b64 v102, v[220:221], v[244:245] offset0:8 offset1:12
  ds_read_b128 v[64:67], v103 offset:0
  ds_read_b128 v[68:71], v103 offset:1152
  v_accvgpr_read_b32 v48, a108
  v_accvgpr_read_b32 v49, a109
  v_accvgpr_read_b32 v50, a110
  v_accvgpr_read_b32 v51, a111
  v_accvgpr_read_b32 v52, a132
  v_accvgpr_read_b32 v53, a133
  v_accvgpr_read_b32 v54, a134
  v_accvgpr_read_b32 v55, a135
  v_mul_f32 v48, v99, v48
  v_mul_f32 v49, v99, v49
  v_mul_f32 v50, v99, v50
  v_mul_f32 v51, v99, v51
  v_mul_f32 v52, v99, v52
  v_mul_f32 v53, v99, v53
  v_mul_f32 v54, v99, v54
  v_mul_f32 v55, v99, v55
  v_mul_f32 v124, v99, v124
  v_mul_f32 v125, v99, v125
  v_mul_f32 v126, v99, v126
  v_mul_f32 v127, v99, v127
  v_mul_f32 v148, v99, v148
  v_mul_f32 v149, v99, v149
  v_mul_f32 v150, v99, v150
  v_mul_f32 v151, v99, v151
  v_cvt_pk_bf16_f32 v48, v48, v49
  v_cvt_pk_bf16_f32 v49, v50, v51
  v_cvt_pk_bf16_f32 v52, v52, v53
  v_cvt_pk_bf16_f32 v53, v54, v55
  v_cvt_pk_bf16_f32 v124, v124, v125
  v_cvt_pk_bf16_f32 v125, v126, v127
  v_cvt_pk_bf16_f32 v148, v148, v149
  v_cvt_pk_bf16_f32 v149, v150, v151
  s_waitcnt lgkmcnt(0)
  s_add_u32 s35, s51, 18432
  buffer_store_dwordx4 v[64:67], v104, s[20:23], s35 offen offset:256 sc1
  buffer_store_dwordx4 v[68:71], v104, s[20:23], s35 offen offset:3328 sc1
  ds_write2_b64 v102, v[48:49], v[52:53] offset0:0 offset1:4
  ds_write2_b64 v102, v[124:125], v[148:149] offset0:8 offset1:12
  ds_read_b128 v[64:67], v103 offset:0
  ds_read_b128 v[68:71], v103 offset:1152
  v_accvgpr_read_b32 v48, a12
  v_accvgpr_read_b32 v49, a13
  v_accvgpr_read_b32 v50, a14
  v_accvgpr_read_b32 v51, a15
  v_accvgpr_read_b32 v52, a36
  v_accvgpr_read_b32 v53, a37
  v_accvgpr_read_b32 v54, a38
  v_accvgpr_read_b32 v55, a39
  v_accvgpr_read_b32 v56, a60
  v_accvgpr_read_b32 v57, a61
  v_accvgpr_read_b32 v58, a62
  v_accvgpr_read_b32 v59, a63
  v_accvgpr_read_b32 v60, a84
  v_accvgpr_read_b32 v61, a85
  v_accvgpr_read_b32 v62, a86
  v_accvgpr_read_b32 v63, a87
  v_mul_f32 v48, v99, v48
  v_mul_f32 v49, v99, v49
  v_mul_f32 v50, v99, v50
  v_mul_f32 v51, v99, v51
  v_mul_f32 v52, v99, v52
  v_mul_f32 v53, v99, v53
  v_mul_f32 v54, v99, v54
  v_mul_f32 v55, v99, v55
  v_mul_f32 v56, v99, v56
  v_mul_f32 v57, v99, v57
  v_mul_f32 v58, v99, v58
  v_mul_f32 v59, v99, v59
  v_mul_f32 v60, v99, v60
  v_mul_f32 v61, v99, v61
  v_mul_f32 v62, v99, v62
  v_mul_f32 v63, v99, v63
  v_cvt_pk_bf16_f32 v48, v48, v49
  v_cvt_pk_bf16_f32 v49, v50, v51
  v_cvt_pk_bf16_f32 v52, v52, v53
  v_cvt_pk_bf16_f32 v53, v54, v55
  v_cvt_pk_bf16_f32 v56, v56, v57
  v_cvt_pk_bf16_f32 v57, v58, v59
  v_cvt_pk_bf16_f32 v60, v60, v61
  v_cvt_pk_bf16_f32 v61, v62, v63
  s_waitcnt lgkmcnt(0)
  s_add_u32 s35, s51, 18432
  buffer_store_dwordx4 v[64:67], v104, s[20:23], s35 offen offset:128 sc1
  buffer_store_dwordx4 v[68:71], v104, s[20:23], s35 offen offset:3200 sc1
  ds_write2_b64 v102, v[48:49], v[52:53] offset0:0 offset1:4
  ds_write2_b64 v102, v[56:57], v[60:61] offset0:8 offset1:12
  ds_read_b128 v[64:67], v103 offset:0
  ds_read_b128 v[68:71], v103 offset:1152
  v_mul_f32 v176, v100, v176
  v_mul_f32 v177, v100, v177
  v_mul_f32 v178, v100, v178
  v_mul_f32 v179, v100, v179
  v_mul_f32 v200, v100, v200
  v_mul_f32 v201, v100, v201
  v_mul_f32 v202, v100, v202
  v_mul_f32 v203, v100, v203
  v_mul_f32 v224, v100, v224
  v_mul_f32 v225, v100, v225
  v_mul_f32 v226, v100, v226
  v_mul_f32 v227, v100, v227
  v_mul_f32 v248, v100, v248
  v_mul_f32 v249, v100, v249
  v_mul_f32 v250, v100, v250
  v_mul_f32 v251, v100, v251
  v_cvt_pk_bf16_f32 v176, v176, v177
  v_cvt_pk_bf16_f32 v177, v178, v179
  v_cvt_pk_bf16_f32 v200, v200, v201
  v_cvt_pk_bf16_f32 v201, v202, v203
  v_cvt_pk_bf16_f32 v224, v224, v225
  v_cvt_pk_bf16_f32 v225, v226, v227
  v_cvt_pk_bf16_f32 v248, v248, v249
  v_cvt_pk_bf16_f32 v249, v250, v251
  s_waitcnt lgkmcnt(0)
  s_add_u32 s35, s51, 18432
  buffer_store_dwordx4 v[64:67], v104, s[20:23], s35 offen offset:0 sc1
  buffer_store_dwordx4 v[68:71], v104, s[20:23], s35 offen offset:3072 sc1
  ds_write2_b64 v102, v[176:177], v[200:201] offset0:0 offset1:4
  ds_write2_b64 v102, v[224:225], v[248:249] offset0:8 offset1:12
  ds_read_b128 v[64:67], v103 offset:0
  ds_read_b128 v[68:71], v103 offset:1152
  v_accvgpr_read_b32 v48, a112
  v_accvgpr_read_b32 v49, a113
  v_accvgpr_read_b32 v50, a114
  v_accvgpr_read_b32 v51, a115
  v_accvgpr_read_b32 v52, a136
  v_accvgpr_read_b32 v53, a137
  v_accvgpr_read_b32 v54, a138
  v_accvgpr_read_b32 v55, a139
  v_mul_f32 v48, v100, v48
  v_mul_f32 v49, v100, v49
  v_mul_f32 v50, v100, v50
  v_mul_f32 v51, v100, v51
  v_mul_f32 v52, v100, v52
  v_mul_f32 v53, v100, v53
  v_mul_f32 v54, v100, v54
  v_mul_f32 v55, v100, v55
  v_mul_f32 v128, v100, v128
  v_mul_f32 v129, v100, v129
  v_mul_f32 v130, v100, v130
  v_mul_f32 v131, v100, v131
  v_mul_f32 v152, v100, v152
  v_mul_f32 v153, v100, v153
  v_mul_f32 v154, v100, v154
  v_mul_f32 v155, v100, v155
  v_cvt_pk_bf16_f32 v48, v48, v49
  v_cvt_pk_bf16_f32 v49, v50, v51
  v_cvt_pk_bf16_f32 v52, v52, v53
  v_cvt_pk_bf16_f32 v53, v54, v55
  v_cvt_pk_bf16_f32 v128, v128, v129
  v_cvt_pk_bf16_f32 v129, v130, v131
  v_cvt_pk_bf16_f32 v152, v152, v153
  v_cvt_pk_bf16_f32 v153, v154, v155
  s_waitcnt lgkmcnt(0)
  s_add_u32 s35, s51, 24576
  buffer_store_dwordx4 v[64:67], v104, s[20:23], s35 offen offset:256 sc1
  buffer_store_dwordx4 v[68:71], v104, s[20:23], s35 offen offset:3328 sc1
  ds_write2_b64 v102, v[48:49], v[52:53] offset0:0 offset1:4
  ds_write2_b64 v102, v[128:129], v[152:153] offset0:8 offset1:12
  ds_read_b128 v[64:67], v103 offset:0
  ds_read_b128 v[68:71], v103 offset:1152
  v_accvgpr_read_b32 v48, a16
  v_accvgpr_read_b32 v49, a17
  v_accvgpr_read_b32 v50, a18
  v_accvgpr_read_b32 v51, a19
  v_accvgpr_read_b32 v52, a40
  v_accvgpr_read_b32 v53, a41
  v_accvgpr_read_b32 v54, a42
  v_accvgpr_read_b32 v55, a43
  v_accvgpr_read_b32 v56, a64
  v_accvgpr_read_b32 v57, a65
  v_accvgpr_read_b32 v58, a66
  v_accvgpr_read_b32 v59, a67
  v_accvgpr_read_b32 v60, a88
  v_accvgpr_read_b32 v61, a89
  v_accvgpr_read_b32 v62, a90
  v_accvgpr_read_b32 v63, a91
  v_mul_f32 v48, v100, v48
  v_mul_f32 v49, v100, v49
  v_mul_f32 v50, v100, v50
  v_mul_f32 v51, v100, v51
  v_mul_f32 v52, v100, v52
  v_mul_f32 v53, v100, v53
  v_mul_f32 v54, v100, v54
  v_mul_f32 v55, v100, v55
  v_mul_f32 v56, v100, v56
  v_mul_f32 v57, v100, v57
  v_mul_f32 v58, v100, v58
  v_mul_f32 v59, v100, v59
  v_mul_f32 v60, v100, v60
  v_mul_f32 v61, v100, v61
  v_mul_f32 v62, v100, v62
  v_mul_f32 v63, v100, v63
  v_cvt_pk_bf16_f32 v48, v48, v49
  v_cvt_pk_bf16_f32 v49, v50, v51
  v_cvt_pk_bf16_f32 v52, v52, v53
  v_cvt_pk_bf16_f32 v53, v54, v55
  v_cvt_pk_bf16_f32 v56, v56, v57
  v_cvt_pk_bf16_f32 v57, v58, v59
  v_cvt_pk_bf16_f32 v60, v60, v61
  v_cvt_pk_bf16_f32 v61, v62, v63
  s_waitcnt lgkmcnt(0)
  s_add_u32 s35, s51, 24576
  buffer_store_dwordx4 v[64:67], v104, s[20:23], s35 offen offset:128 sc1
  buffer_store_dwordx4 v[68:71], v104, s[20:23], s35 offen offset:3200 sc1
  ds_write2_b64 v102, v[48:49], v[52:53] offset0:0 offset1:4
  ds_write2_b64 v102, v[56:57], v[60:61] offset0:8 offset1:12
  ds_read_b128 v[64:67], v103 offset:0
  ds_read_b128 v[68:71], v103 offset:1152
  v_mul_f32 v180, v101, v180
  v_mul_f32 v181, v101, v181
  v_mul_f32 v182, v101, v182
  v_mul_f32 v183, v101, v183
  v_mul_f32 v204, v101, v204
  v_mul_f32 v205, v101, v205
  v_mul_f32 v206, v101, v206
  v_mul_f32 v207, v101, v207
  v_mul_f32 v228, v101, v228
  v_mul_f32 v229, v101, v229
  v_mul_f32 v230, v101, v230
  v_mul_f32 v231, v101, v231
  v_mul_f32 v252, v101, v252
  v_mul_f32 v253, v101, v253
  v_mul_f32 v254, v101, v254
  v_mul_f32 v255, v101, v255
  v_cvt_pk_bf16_f32 v180, v180, v181
  v_cvt_pk_bf16_f32 v181, v182, v183
  v_cvt_pk_bf16_f32 v204, v204, v205
  v_cvt_pk_bf16_f32 v205, v206, v207
  v_cvt_pk_bf16_f32 v228, v228, v229
  v_cvt_pk_bf16_f32 v229, v230, v231
  v_cvt_pk_bf16_f32 v252, v252, v253
  v_cvt_pk_bf16_f32 v253, v254, v255
  s_waitcnt lgkmcnt(0)
  s_add_u32 s35, s51, 24576
  buffer_store_dwordx4 v[64:67], v104, s[20:23], s35 offen offset:0 sc1
  buffer_store_dwordx4 v[68:71], v104, s[20:23], s35 offen offset:3072 sc1
  ds_write2_b64 v102, v[180:181], v[204:205] offset0:0 offset1:4
  ds_write2_b64 v102, v[228:229], v[252:253] offset0:8 offset1:12
  ds_read_b128 v[64:67], v103 offset:0
  ds_read_b128 v[68:71], v103 offset:1152
  v_accvgpr_read_b32 v48, a116
  v_accvgpr_read_b32 v49, a117
  v_accvgpr_read_b32 v50, a118
  v_accvgpr_read_b32 v51, a119
  v_mul_f32 v48, v101, v48
  v_mul_f32 v49, v101, v49
  v_mul_f32 v50, v101, v50
  v_mul_f32 v51, v101, v51
  v_mul_f32 v108, v101, v108
  v_mul_f32 v109, v101, v109
  v_mul_f32 v110, v101, v110
  v_mul_f32 v111, v101, v111
  v_mul_f32 v132, v101, v132
  v_mul_f32 v133, v101, v133
  v_mul_f32 v134, v101, v134
  v_mul_f32 v135, v101, v135
  v_mul_f32 v156, v101, v156
  v_mul_f32 v157, v101, v157
  v_mul_f32 v158, v101, v158
  v_mul_f32 v159, v101, v159
  v_cvt_pk_bf16_f32 v48, v48, v49
  v_cvt_pk_bf16_f32 v49, v50, v51
  v_cvt_pk_bf16_f32 v108, v108, v109
  v_cvt_pk_bf16_f32 v109, v110, v111
  v_cvt_pk_bf16_f32 v132, v132, v133
  v_cvt_pk_bf16_f32 v133, v134, v135
  v_cvt_pk_bf16_f32 v156, v156, v157
  v_cvt_pk_bf16_f32 v157, v158, v159
  s_waitcnt lgkmcnt(0)
  s_add_u32 s35, s51, 30720
  buffer_store_dwordx4 v[64:67], v104, s[20:23], s35 offen offset:256 sc1
  buffer_store_dwordx4 v[68:71], v104, s[20:23], s35 offen offset:3328 sc1
  ds_write2_b64 v102, v[48:49], v[108:109] offset0:0 offset1:4
  ds_write2_b64 v102, v[132:133], v[156:157] offset0:8 offset1:12
  ds_read_b128 v[64:67], v103 offset:0
  ds_read_b128 v[68:71], v103 offset:1152
  v_accvgpr_read_b32 v48, a20
  v_accvgpr_read_b32 v49, a21
  v_accvgpr_read_b32 v50, a22
  v_accvgpr_read_b32 v51, a23
  v_accvgpr_read_b32 v52, a44
  v_accvgpr_read_b32 v53, a45
  v_accvgpr_read_b32 v54, a46
  v_accvgpr_read_b32 v55, a47
  v_accvgpr_read_b32 v56, a68
  v_accvgpr_read_b32 v57, a69
  v_accvgpr_read_b32 v58, a70
  v_accvgpr_read_b32 v59, a71
  v_accvgpr_read_b32 v60, a92
  v_accvgpr_read_b32 v61, a93
  v_accvgpr_read_b32 v62, a94
  v_accvgpr_read_b32 v63, a95
  v_mul_f32 v48, v101, v48
  v_mul_f32 v49, v101, v49
  v_mul_f32 v50, v101, v50
  v_mul_f32 v51, v101, v51
  v_mul_f32 v52, v101, v52
  v_mul_f32 v53, v101, v53
  v_mul_f32 v54, v101, v54
  v_mul_f32 v55, v101, v55
  v_mul_f32 v56, v101, v56
  v_mul_f32 v57, v101, v57
  v_mul_f32 v58, v101, v58
  v_mul_f32 v59, v101, v59
  v_mul_f32 v60, v101, v60
  v_mul_f32 v61, v101, v61
  v_mul_f32 v62, v101, v62
  v_mul_f32 v63, v101, v63
  v_cvt_pk_bf16_f32 v48, v48, v49
  v_cvt_pk_bf16_f32 v49, v50, v51
  v_cvt_pk_bf16_f32 v52, v52, v53
  v_cvt_pk_bf16_f32 v53, v54, v55
  v_cvt_pk_bf16_f32 v56, v56, v57
  v_cvt_pk_bf16_f32 v57, v58, v59
  v_cvt_pk_bf16_f32 v60, v60, v61
  v_cvt_pk_bf16_f32 v61, v62, v63
  s_waitcnt lgkmcnt(0)
  s_add_u32 s35, s51, 30720
  buffer_store_dwordx4 v[64:67], v104, s[20:23], s35 offen offset:128 sc1
  buffer_store_dwordx4 v[68:71], v104, s[20:23], s35 offen offset:3200 sc1
  ds_write2_b64 v102, v[48:49], v[52:53] offset0:0 offset1:4
  ds_write2_b64 v102, v[56:57], v[60:61] offset0:8 offset1:12
  ds_read_b128 v[64:67], v103 offset:0
  ds_read_b128 v[68:71], v103 offset:1152
  s_add_u32 s35, s51, 30720
  s_waitcnt lgkmcnt(0)
  buffer_store_dwordx4 v[64:67], v104, s[20:23], s35 offen offset:0 sc1
  buffer_store_dwordx4 v[68:71], v104, s[20:23], s35 offen offset:3072 sc1
  s_cmp_lg_u32 s38, 0
  s_cbranch_scc0 L_done
L_fb:
  s_waitcnt vmcnt(0) lgkmcnt(0)
  s_and_b32 s35, s38, 1
  s_xor_b32 s33, s35, 1
  s_lshl_b32 s35, 1, s33
  s_xor_b32 s38, s38, s35
  s_mul_i32 s35, s33, 4718592
  s_add_u32 s51, s52, s35
  s_mul_i32 s35, s33, 6291456
  s_add_u32 s34, s53, s35
  v_mbcnt_lo_u32_b32 v42, -1, 0
  v_mbcnt_hi_u32_b32 v42, -1, v42
  v_and_b32 v43, 15, v42
  v_lshrrev_b32 v42, 4, v42
  v_mul_u32_u24 v43, 384, v43
  v_lshl_add_u32 v36, v42, 4, v43
  v_add_u32 v37, 6144, v36
  s_and_b32 s35, s24, 1
  s_mul_i32 s35, s35, 0x50
  s_sub_u32 s37, s36, 49152
  v_xor_b32 v38, s35, v4
  v_add_u32 v38, s37, v38
  v_xor_b32 v39, s35, v5
  v_add_u32 v39, s37, v39
  v_xor_b32 v40, s35, v6
  v_add_u32 v40, s37, v40
  v_xor_b32 v41, s35, v7
  v_add_u32 v41, s37, v41
  s_add_u32 s35, s51, 0
  buffer_load_dwordx4 a[140:143], v36, s[8:11], s35 offen offset:0
  buffer_load_dwordx4 a[144:147], v36, s[8:11], s35 offen offset:64
  buffer_load_dwordx4 a[148:151], v36, s[8:11], s35 offen offset:128
  buffer_load_dwordx4 a[152:155], v36, s[8:11], s35 offen offset:192
  buffer_load_dwordx4 a[156:159], v36, s[8:11], s35 offen offset:256
  buffer_load_dwordx4 a[160:163], v36, s[8:11], s35 offen offset:320
  v_mov_b32 v9, 0xff800000
  v_mov_b32 v15, 0
  v_accvgpr_write_b32 a0, 0
  v_accvgpr_write_b32 a1, 0
  v_accvgpr_write_b32 a2, 0
  v_accvgpr_write_b32 a3, 0
  v_accvgpr_write_b32 a24, 0
  v_accvgpr_write_b32 a25, 0
  v_accvgpr_write_b32 a26, 0
  v_accvgpr_write_b32 a27, 0
  v_accvgpr_write_b32 a48, 0
  v_accvgpr_write_b32 a49, 0
  v_accvgpr_write_b32 a50, 0
  v_accvgpr_write_b32 a51, 0
  v_accvgpr_write_b32 a72, 0
  v_accvgpr_write_b32 a73, 0
  v_accvgpr_write_b32 a74, 0
  v_accvgpr_write_b32 a75, 0
  v_accvgpr_write_b32 a96, 0
  v_accvgpr_write_b32 a97, 0
  v_accvgpr_write_b32 a98, 0
  v_accvgpr_write_b32 a99, 0
  v_accvgpr_write_b32 a120, 0
  v_accvgpr_write_b32 a121, 0
  v_accvgpr_write_b32 a122, 0
  v_accvgpr_write_b32 a123, 0
  v_mov_b32 v112, 0
  v_mov_b32 v113, 0
  v_mov_b32 v114, 0
  v_mov_b32 v115, 0
  v_mov_b32 v136, 0
  v_mov_b32 v137, 0
  v_mov_b32 v138, 0
  v_mov_b32 v139, 0
  v_mov_b32 v160, 0
  v_mov_b32 v161, 0
  v_mov_b32 v162, 0
  v_mov_b32 v163, 0
  v_mov_b32 v184, 0
  v_mov_b32 v185, 0
  v_mov_b32 v186, 0
  v_mov_b32 v187, 0
  v_mov_b32 v208, 0
  v_mov_b32 v209, 0
  v_mov_b32 v210, 0
  v_mov_b32 v211, 0
  v_mov_b32 v232, 0
  v_mov_b32 v233, 0
  v_mov_b32 v234, 0
  v_mov_b32 v235, 0
  s_add_u32 s35, s51, 6144
  buffer_load_dwordx4 a[164:167], v36, s[8:11], s35 offen offset:0
  buffer_load_dwordx4 a[168:171], v36, s[8:11], s35 offen offset:64
  buffer_load_dwordx4 a[172:175], v36, s[8:11], s35 offen offset:128
  buffer_load_dwordx4 a[176:179], v36, s[8:11], s35 offen offset:192
  buffer_load_dwordx4 a[180:183], v36, s[8:11], s35 offen offset:256
  buffer_load_dwordx4 a[184:187], v36, s[8:11], s35 offen offset:320
  v_mov_b32 v10, 0xff800000
  v_mov_b32 v16, 0
  v_accvgpr_write_b32 a4, 0
  v_accvgpr_write_b32 a5, 0
  v_accvgpr_write_b32 a6, 0
  v_accvgpr_write_b32 a7, 0
  v_accvgpr_write_b32 a28, 0
  v_accvgpr_write_b32 a29, 0
  v_accvgpr_write_b32 a30, 0
  v_accvgpr_write_b32 a31, 0
  v_accvgpr_write_b32 a52, 0
  v_accvgpr_write_b32 a53, 0
  v_accvgpr_write_b32 a54, 0
  v_accvgpr_write_b32 a55, 0
  v_accvgpr_write_b32 a76, 0
  v_accvgpr_write_b32 a77, 0
  v_accvgpr_write_b32 a78, 0
  v_accvgpr_write_b32 a79, 0
  v_accvgpr_write_b32 a100, 0
  v_accvgpr_write_b32 a101, 0
  v_accvgpr_write_b32 a102, 0
  v_accvgpr_write_b32 a103, 0
  v_accvgpr_write_b32 a124, 0
  v_accvgpr_write_b32 a125, 0
  v_accvgpr_write_b32 a126, 0
  v_accvgpr_write_b32 a127, 0
  v_mov_b32 v116, 0
  v_mov_b32 v117, 0
  v_mov_b32 v118, 0
  v_mov_b32 v119, 0
  v_mov_b32 v140, 0
  v_mov_b32 v141, 0
  v_mov_b32 v142, 0
  v_mov_b32 v143, 0
  v_mov_b32 v164, 0
  v_mov_b32 v165, 0
  v_mov_b32 v166, 0
  v_mov_b32 v167, 0
  v_mov_b32 v188, 0
  v_mov_b32 v189, 0
  v_mov_b32 v190, 0
  v_mov_b32 v191, 0
  v_mov_b32 v212, 0
  v_mov_b32 v213, 0
  v_mov_b32 v214, 0
  v_mov_b32 v215, 0
  v_mov_b32 v236, 0
  v_mov_b32 v237, 0
  v_mov_b32 v238, 0
  v_mov_b32 v239, 0
  s_add_u32 s35, s51, 12288
  buffer_load_dwordx4 a[188:191], v36, s[8:11], s35 offen offset:0
  buffer_load_dwordx4 a[192:195], v36, s[8:11], s35 offen offset:64
  buffer_load_dwordx4 a[196:199], v36, s[8:11], s35 offen offset:128
  buffer_load_dwordx4 a[200:203], v36, s[8:11], s35 offen offset:192
  buffer_load_dwordx4 a[204:207], v36, s[8:11], s35 offen offset:256
  buffer_load_dwordx4 a[208:211], v36, s[8:11], s35 offen offset:320
  v_mov_b32 v11, 0xff800000
  v_mov_b32 v17, 0
  v_accvgpr_write_b32 a8, 0
  v_accvgpr_write_b32 a9, 0
  v_accvgpr_write_b32 a10, 0
  v_accvgpr_write_b32 a11, 0
  v_accvgpr_write_b32 a32, 0
  v_accvgpr_write_b32 a33, 0
  v_accvgpr_write_b32 a34, 0
  v_accvgpr_write_b32 a35, 0
  v_accvgpr_write_b32 a56, 0
  v_accvgpr_write_b32 a57, 0
  v_accvgpr_write_b32 a58, 0
  v_accvgpr_write_b32 a59, 0
  v_accvgpr_write_b32 a80, 0
  v_accvgpr_write_b32 a81, 0
  v_accvgpr_write_b32 a82, 0
  v_accvgpr_write_b32 a83, 0
  v_accvgpr_write_b32 a104, 0
  v_accvgpr_write_b32 a105, 0
  v_accvgpr_write_b32 a106, 0
  v_accvgpr_write_b32 a107, 0
  v_accvgpr_write_b32 a128, 0
  v_accvgpr_write_b32 a129, 0
  v_accvgpr_write_b32 a130, 0
  v_accvgpr_write_b32 a131, 0
  v_mov_b32 v120, 0
  v_mov_b32 v121, 0
  v_mov_b32 v122, 0
  v_mov_b32 v123, 0
  v_mov_b32 v144, 0
  v_mov_b32 v145, 0
  v_mov_b32 v146, 0
  v_mov_b32 v147, 0
  v_mov_b32 v168, 0
  v_mov_b32 v169, 0
  v_mov_b32 v170, 0
  v_mov_b32 v171, 0
  v_mov_b32 v192, 0
  v_mov_b32 v193, 0
  v_mov_b32 v194, 0
  v_mov_b32 v195, 0
  v_mov_b32 v216, 0
  v_mov_b32 v217, 0
  v_mov_b32 v218, 0
  v_mov_b32 v219, 0
  v_mov_b32 v240, 0
  v_mov_b32 v241, 0
  v_mov_b32 v242, 0
  v_mov_b32 v243, 0
  s_mov_b32 s26, s34
  s_mov_b32 s54, 0
L_fa0:
  buffer_load_dwordx4 v[48:51], v36, s[12:15], s26 offen offset:0
  buffer_load_dwordx4 v[52:55], v37, s[12:15], s26 offen offset:0
  buffer_load_dwordx4 v[56:59], v36, s[12:15], s26 offen offset:64
  buffer_load_dwordx4 v[60:63], v37, s[12:15], s26 offen offset:64
  buffer_load_dwordx4 v[64:67], v36, s[12:15], s26 offen offset:128
  buffer_load_dwordx4 v[68:71], v37, s[12:15], s26 offen offset:128
  buffer_load_dwordx4 v[84:87], v36, s[12:15], s26 offen offset:192
  buffer_load_dwordx4 v[88:91], v37, s[12:15], s26 offen offset:192
  buffer_load_dwordx4 v[92:95], v36, s[12:15], s26 offen offset:256
  buffer_load_dwordx4 v[96:99], v37, s[12:15], s26 offen offset:256
  buffer_load_dwordx4 v[100:103], v36, s[12:15], s26 offen offset:320
  buffer_load_dwordx4 v[104:107], v37, s[12:15], s26 offen offset:320
  s_waitcnt vmcnt(0)
  v_mfma_f32_16x16x32_bf16 v[24:27], v[48:51], a[140:143], 0
  v_mfma_f32_16x16x32_bf16 v[28:31], v[48:51], a[164:167], 0
  v_mfma_f32_16x16x32_bf16 v[32:35], v[48:51], a[188:191], 0
  v_mfma_f32_16x16x32_bf16 v[72:75], v[52:55], a[140:143], 0
  v_mfma_f32_16x16x32_bf16 v[76:79], v[52:55], a[164:167], 0
  v_mfma_f32_16x16x32_bf16 v[80:83], v[52:55], a[188:191], 0
  v_mfma_f32_16x16x32_bf16 v[24:27], v[56:59], a[144:147], v[24:27]
  v_mfma_f32_16x16x32_bf16 v[28:31], v[56:59], a[168:171], v[28:31]
  v_mfma_f32_16x16x32_bf16 v[32:35], v[56:59], a[192:195], v[32:35]
  v_mfma_f32_16x16x32_bf16 v[72:75], v[60:63], a[144:147], v[72:75]
  v_mfma_f32_16x16x32_bf16 v[76:79], v[60:63], a[168:171], v[76:79]
  v_mfma_f32_16x16x32_bf16 v[80:83], v[60:63], a[192:195], v[80:83]
  v_mfma_f32_16x16x32_bf16 v[24:27], v[64:67], a[148:151], v[24:27]
  v_mfma_f32_16x16x32_bf16 v[28:31], v[64:67], a[172:175], v[28:31]
  v_mfma_f32_16x16x32_bf16 v[32:35], v[64:67], a[196:199], v[32:35]
  v_mfma_f32_16x16x32_bf16 v[72:75], v[68:71], a[148:151], v[72:75]
  v_mfma_f32_16x16x32_bf16 v[76:79], v[68:71], a[172:175], v[76:79]
  v_mfma_f32_16x16x32_bf16 v[80:83], v[68:71], a[196:199], v[80:83]
  v_mfma_f32_16x16x32_bf16 v[24:27], v[84:87], a[152:155], v[24:27]
  v_mfma_f32_16x16x32_bf16 v[28:31], v[84:87], a[176:179], v[28:31]
  v_mfma_f32_16x16x32_bf16 v[32:35], v[84:87], a[200:203], v[32:35]
  v_mfma_f32_16x16x32_bf16 v[72:75], v[88:91], a[152:155], v[72:75]
  v_mfma_f32_16x16x32_bf16 v[76:79], v[88:91], a[176:179], v[76:79]
  v_mfma_f32_16x16x32_bf16 v[80:83], v[88:91], a[200:203], v[80:83]
  v_mfma_f32_16x16x32_bf16 v[24:27], v[92:95], a[156:159], v[24:27]
  v_mfma_f32_16x16x32_bf16 v[28:31], v[92:95], a[180:183], v[28:31]
  v_mfma_f32_16x16x32_bf16 v[32:35], v[92:95], a[204:207], v[32:35]
  v_mfma_f32_16x16x32_bf16 v[72:75], v[96:99], a[156:159], v[72:75]
  v_mfma_f32_16x16x32_bf16 v[76:79], v[96:99], a[180:183], v[76:79]
  v_mfma_f32_16x16x32_bf16 v[80:83], v[96:99], a[204:207], v[80:83]
  v_mfma_f32_16x16x32_bf16 v[24:27], v[100:103], a[160:163], v[24:27]
  v_mfma_f32_16x16x32_bf16 v[28:31], v[100:103], a[184:187], v[28:31]
  v_mfma_f32_16x16x32_bf16 v[32:35], v[100:103], a[208:211], v[32:35]
  v_mfma_f32_16x16x32_bf16 v[72:75], v[104:107], a[160:163], v[72:75]
  v_mfma_f32_16x16x32_bf16 v[76:79], v[104:107], a[184:187], v[76:79]
  v_mfma_f32_16x16x32_bf16 v[80:83], v[104:107], a[208:211], v[80:83]
  s_nop 7
  v_max3_f32 v9, v9, v24, v25
  v_max3_f32 v9, v9, v26, v27
  v_max3_f32 v9, v9, v72, v73
  v_max3_f32 v9, v9, v74, v75
  v_max3_f32 v10, v10, v28, v29
  v_max3_f32 v10, v10, v30, v31
  v_max3_f32 v10, v10, v76, v77
  v_max3_f32 v10, v10, v78, v79
  v_max3_f32 v11, v11, v32, v33
  v_max3_f32 v11, v11, v34, v35
  v_max3_f32 v11, v11, v80, v81
  v_max3_f32 v11, v11, v82, v83
  s_add_u32 s26, s26, 12288
  s_add_u32 s54, s54, 1
  s_cmp_lt_u32 s54, 16
  s_cbranch_scc1 L_fa0
  v_mov_b32 v44, v9
  v_mov_b32 v45, v10
  v_mov_b32 v46, v11
  v_permlane32_swap_b32 v44, v9
  v_permlane32_swap_b32 v45, v10
  v_permlane32_swap_b32 v46, v11
  v_max_f32 v9, v9, v44
  v_max_f32 v10, v10, v45
  v_max_f32 v11, v11, v46
  v_mov_b32 v44, v9
  v_mov_b32 v45, v10
  v_mov_b32 v46, v11
  v_permlane16_swap_b32 v44, v9
  v_permlane16_swap_b32 v45, v10
  v_permlane16_swap_b32 v46, v11
  v_max_f32 v9, v9, v44
  v_max_f32 v10, v10, v45
  v_max_f32 v11, v11, v46
  v_mov_b32 v44, 0x40c00000
  v_fma_f32 v9, v9, s31, v44
  v_fma_f32 v10, v10, s31, v44
  v_fma_f32 v11, v11, s31, v44
  s_mov_b32 s26, s34
  s_mov_b32 s54, 0
L_fc0:
  buffer_load_dwordx4 v[48:51], v36, s[12:15], s26 offen offset:0
  buffer_load_dwordx4 v[52:55], v37, s[12:15], s26 offen offset:0
  buffer_load_dwordx4 v[56:59], v36, s[12:15], s26 offen offset:64
  buffer_load_dwordx4 v[60:63], v37, s[12:15], s26 offen offset:64
  buffer_load_dwordx4 v[64:67], v36, s[12:15], s26 offen offset:128
  buffer_load_dwordx4 v[68:71], v37, s[12:15], s26 offen offset:128
  buffer_load_dwordx4 v[84:87], v36, s[12:15], s26 offen offset:192
  buffer_load_dwordx4 v[88:91], v37, s[12:15], s26 offen offset:192
  buffer_load_dwordx4 v[92:95], v36, s[12:15], s26 offen offset:256
  buffer_load_dwordx4 v[96:99], v37, s[12:15], s26 offen offset:256
  buffer_load_dwordx4 v[100:103], v36, s[12:15], s26 offen offset:320
  buffer_load_dwordx4 v[104:107], v37, s[12:15], s26 offen offset:320
  s_add_u32 s35, s26, 0
  s_add_u32 m0, s36, 0
  s_nop 0
  buffer_load_dwordx4 v8, s[16:19], s35 offen offset:0 nt lds
  s_add_u32 m0, s36, 3968
  s_nop 0
  buffer_load_dwordx4 v8, s[16:19], s35 offen offset:128 nt lds
  s_add_u32 m0, s36, 7936
  s_nop 0
  buffer_load_dwordx4 v8, s[16:19], s35 offen offset:256 nt lds
  s_add_u32 s35, s26, 3072
  s_add_u32 m0, s36, 1024
  s_nop 0
  buffer_load_dwordx4 v23, s[16:19], s35 offen offset:0 nt lds
  s_add_u32 m0, s36, 4992
  s_nop 0
  buffer_load_dwordx4 v23, s[16:19], s35 offen offset:128 nt lds
  s_add_u32 m0, s36, 8960
  s_nop 0
  buffer_load_dwordx4 v23, s[16:19], s35 offen offset:256 nt lds
  s_add_u32 s35, s26, 6144
  s_add_u32 m0, s36, 2048
  s_nop 0
  buffer_load_dwordx4 v8, s[16:19], s35 offen offset:0 nt lds
  s_add_u32 m0, s36, 6016
  s_nop 0
  buffer_load_dwordx4 v8, s[16:19], s35 offen offset:128 nt lds
  s_add_u32 m0, s36, 9984
  s_nop 0
  buffer_load_dwordx4 v8, s[16:19], s35 offen offset:256 nt lds
  s_add_u32 s35, s26, 9216
  s_add_u32 m0, s36, 3072
  s_nop 0
  buffer_load_dwordx4 v23, s[16:19], s35 offen offset:0 nt lds
  s_add_u32 m0, s36, 7040
  s_nop 0
  buffer_load_dwordx4 v23, s[16:19], s35 offen offset:128 nt lds
  s_add_u32 m0, s36, 11008
  s_nop 0
  buffer_load_dwordx4 v23, s[16:19], s35 offen offset:256 nt lds
  s_waitcnt vmcnt(0)
  v_mfma_f32_16x16x32_bf16 v[24:27], v[48:51], a[140:143], 0
  v_mfma_f32_16x16x32_bf16 v[28:31], v[48:51], a[164:167], 0
  v_mfma_f32_16x16x32_bf16 v[32:35], v[48:51], a[188:191], 0
  v_mfma_f32_16x16x32_bf16 v[72:75], v[52:55], a[140:143], 0
  v_mfma_f32_16x16x32_bf16 v[76:79], v[52:55], a[164:167], 0
  v_mfma_f32_16x16x32_bf16 v[80:83], v[52:55], a[188:191], 0
  v_mfma_f32_16x16x32_bf16 v[24:27], v[56:59], a[144:147], v[24:27]
  v_mfma_f32_16x16x32_bf16 v[28:31], v[56:59], a[168:171], v[28:31]
  v_mfma_f32_16x16x32_bf16 v[32:35], v[56:59], a[192:195], v[32:35]
  v_mfma_f32_16x16x32_bf16 v[72:75], v[60:63], a[144:147], v[72:75]
  v_mfma_f32_16x16x32_bf16 v[76:79], v[60:63], a[168:171], v[76:79]
  v_mfma_f32_16x16x32_bf16 v[80:83], v[60:63], a[192:195], v[80:83]
  v_mfma_f32_16x16x32_bf16 v[24:27], v[64:67], a[148:151], v[24:27]
  v_mfma_f32_16x16x32_bf16 v[28:31], v[64:67], a[172:175], v[28:31]
  v_mfma_f32_16x16x32_bf16 v[32:35], v[64:67], a[196:199], v[32:35]
  v_mfma_f32_16x16x32_bf16 v[72:75], v[68:71], a[148:151], v[72:75]
  v_mfma_f32_16x16x32_bf16 v[76:79], v[68:71], a[172:175], v[76:79]
  v_mfma_f32_16x16x32_bf16 v[80:83], v[68:71], a[196:199], v[80:83]
  v_mfma_f32_16x16x32_bf16 v[24:27], v[84:87], a[152:155], v[24:27]
  v_mfma_f32_16x16x32_bf16 v[28:31], v[84:87], a[176:179], v[28:31]
  v_mfma_f32_16x16x32_bf16 v[32:35], v[84:87], a[200:203], v[32:35]
  v_mfma_f32_16x16x32_bf16 v[72:75], v[88:91], a[152:155], v[72:75]
  v_mfma_f32_16x16x32_bf16 v[76:79], v[88:91], a[176:179], v[76:79]
  v_mfma_f32_16x16x32_bf16 v[80:83], v[88:91], a[200:203], v[80:83]
  v_mfma_f32_16x16x32_bf16 v[24:27], v[92:95], a[156:159], v[24:27]
  v_mfma_f32_16x16x32_bf16 v[28:31], v[92:95], a[180:183], v[28:31]
  v_mfma_f32_16x16x32_bf16 v[32:35], v[92:95], a[204:207], v[32:35]
  v_mfma_f32_16x16x32_bf16 v[72:75], v[96:99], a[156:159], v[72:75]
  v_mfma_f32_16x16x32_bf16 v[76:79], v[96:99], a[180:183], v[76:79]
  v_mfma_f32_16x16x32_bf16 v[80:83], v[96:99], a[204:207], v[80:83]
  v_mfma_f32_16x16x32_bf16 v[24:27], v[100:103], a[160:163], v[24:27]
  v_mfma_f32_16x16x32_bf16 v[28:31], v[100:103], a[184:187], v[28:31]
  v_mfma_f32_16x16x32_bf16 v[32:35], v[100:103], a[208:211], v[32:35]
  v_mfma_f32_16x16x32_bf16 v[72:75], v[104:107], a[160:163], v[72:75]
  v_mfma_f32_16x16x32_bf16 v[76:79], v[104:107], a[184:187], v[76:79]
  v_mfma_f32_16x16x32_bf16 v[80:83], v[104:107], a[208:211], v[80:83]
  s_nop 7
  v_fma_f32 v24, v24, s30, v9
  v_fma_f32 v25, v25, s30, v9
  v_fma_f32 v26, v26, s30, v9
  v_fma_f32 v27, v27, s30, v9
  v_fma_f32 v72, v72, s30, v9
  v_fma_f32 v73, v73, s30, v9
  v_fma_f32 v74, v74, s30, v9
  v_fma_f32 v75, v75, s30, v9
  v_fma_f32 v28, v28, s30, v10
  v_fma_f32 v29, v29, s30, v10
  v_fma_f32 v30, v30, s30, v10
  v_fma_f32 v31, v31, s30, v10
  v_fma_f32 v76, v76, s30, v10
  v_fma_f32 v77, v77, s30, v10
  v_fma_f32 v78, v78, s30, v10
  v_fma_f32 v79, v79, s30, v10
  v_fma_f32 v32, v32, s30, v11
  v_fma_f32 v33, v33, s30, v11
  v_fma_f32 v34, v34, s30, v11
  v_fma_f32 v35, v35, s30, v11
  v_fma_f32 v80, v80, s30, v11
  v_fma_f32 v81, v81, s30, v11
  v_fma_f32 v82, v82, s30, v11
  v_fma_f32 v83, v83, s30, v11
  v_exp_f32 v24, v24
  v_exp_f32 v25, v25
  v_exp_f32 v26, v26
  v_exp_f32 v27, v27
  v_exp_f32 v72, v72
  v_exp_f32 v73, v73
  v_exp_f32 v74, v74
  v_exp_f32 v75, v75
  v_exp_f32 v28, v28
  v_exp_f32 v29, v29
  v_exp_f32 v30, v30
  v_exp_f32 v31, v31
  v_exp_f32 v76, v76
  v_exp_f32 v77, v77
  v_exp_f32 v78, v78
  v_exp_f32 v79, v79
  v_exp_f32 v32, v32
  v_exp_f32 v33, v33
  v_exp_f32 v34, v34
  v_exp_f32 v35, v35
  v_exp_f32 v80, v80
  v_exp_f32 v81, v81
  v_exp_f32 v82, v82
  v_exp_f32 v83, v83
  s_nop 0
  v_add_f32 v15, v15, v24
  v_add_f32 v15, v15, v25
  v_add_f32 v15, v15, v26
  v_add_f32 v15, v15, v27
  v_add_f32 v15, v15, v72
  v_add_f32 v15, v15, v73
  v_add_f32 v15, v15, v74
  v_add_f32 v15, v15, v75
  v_add_f32 v16, v16, v28
  v_add_f32 v16, v16, v29
  v_add_f32 v16, v16, v30
  v_add_f32 v16, v16, v31
  v_add_f32 v16, v16, v76
  v_add_f32 v16, v16, v77
  v_add_f32 v16, v16, v78
  v_add_f32 v16, v16, v79
  v_add_f32 v17, v17, v32
  v_add_f32 v17, v17, v33
  v_add_f32 v17, v17, v34
  v_add_f32 v17, v17, v35
  v_add_f32 v17, v17, v80
  v_add_f32 v17, v17, v81
  v_add_f32 v17, v17, v82
  v_add_f32 v17, v17, v83
  v_cvt_pk_bf16_f32 v24, v24, v25
  v_cvt_pk_bf16_f32 v25, v26, v27
  v_cvt_pk_bf16_f32 v26, v72, v73
  v_cvt_pk_bf16_f32 v27, v74, v75
  v_cvt_pk_bf16_f32 v28, v28, v29
  v_cvt_pk_bf16_f32 v29, v30, v31
  v_cvt_pk_bf16_f32 v30, v76, v77
  v_cvt_pk_bf16_f32 v31, v78, v79
  v_cvt_pk_bf16_f32 v32, v32, v33
  v_cvt_pk_bf16_f32 v33, v34, v35
  v_cvt_pk_bf16_f32 v34, v80, v81
  v_cvt_pk_bf16_f32 v35, v82, v83
  ds_read_b64_tr_b16 a[236:237], v38 offset:0
  ds_read_b64_tr_b16 a[238:239], v38 offset:2048
  s_waitcnt lgkmcnt(0)
  v_mfma_f32_16x16x32_bf16 a[0:3], a[236:239], v[24:27], a[0:3]
  v_mfma_f32_16x16x32_bf16 a[4:7], a[236:239], v[28:31], a[4:7]
  v_mfma_f32_16x16x32_bf16 a[8:11], a[236:239], v[32:35], a[8:11]
  ds_read_b64_tr_b16 a[236:237], v39 offset:0
  ds_read_b64_tr_b16 a[238:239], v39 offset:2048
  s_waitcnt lgkmcnt(0)
  v_mfma_f32_16x16x32_bf16 a[24:27], a[236:239], v[24:27], a[24:27]
  v_mfma_f32_16x16x32_bf16 a[28:31], a[236:239], v[28:31], a[28:31]
  v_mfma_f32_16x16x32_bf16 a[32:35], a[236:239], v[32:35], a[32:35]
  ds_read_b64_tr_b16 a[236:237], v40 offset:0
  ds_read_b64_tr_b16 a[238:239], v40 offset:2048
  s_waitcnt lgkmcnt(0)
  v_mfma_f32_16x16x32_bf16 a[48:51], a[236:239], v[24:27], a[48:51]
  v_mfma_f32_16x16x32_bf16 a[52:55], a[236:239], v[28:31], a[52:55]
  v_mfma_f32_16x16x32_bf16 a[56:59], a[236:239], v[32:35], a[56:59]
  ds_read_b64_tr_b16 a[236:237], v41 offset:0
  ds_read_b64_tr_b16 a[238:239], v41 offset:2048
  s_waitcnt lgkmcnt(0)
  v_mfma_f32_16x16x32_bf16 a[72:75], a[236:239], v[24:27], a[72:75]
  v_mfma_f32_16x16x32_bf16 a[76:79], a[236:239], v[28:31], a[76:79]
  v_mfma_f32_16x16x32_bf16 a[80:83], a[236:239], v[32:35], a[80:83]
  ds_read_b64_tr_b16 a[236:237], v38 offset:4096
  ds_read_b64_tr_b16 a[238:239], v38 offset:6144
  s_waitcnt lgkmcnt(0)
  v_mfma_f32_16x16x32_bf16 a[96:99], a[236:239], v[24:27], a[96:99]
  v_mfma_f32_16x16x32_bf16 a[100:103], a[236:239], v[28:31], a[100:103]
  v_mfma_f32_16x16x32_bf16 a[104:107], a[236:239], v[32:35], a[104:107]
  ds_read_b64_tr_b16 a[236:237], v39 offset:4096
  ds_read_b64_tr_b16 a[238:239], v39 offset:6144
  s_waitcnt lgkmcnt(0)
  v_mfma_f32_16x16x32_bf16 a[120:123], a[236:239], v[24:27], a[120:123]
  v_mfma_f32_16x16x32_bf16 a[124:127], a[236:239], v[28:31], a[124:127]
  v_mfma_f32_16x16x32_bf16 a[128:131], a[236:239], v[32:35], a[128:131]
  ds_read_b64_tr_b16 a[236:237], v40 offset:4096
  ds_read_b64_tr_b16 a[238:239], v40 offset:6144
  s_waitcnt lgkmcnt(0)
  v_mfma_f32_16x16x32_bf16 v[112:115], a[236:239], v[24:27], v[112:115]
  v_mfma_f32_16x16x32_bf16 v[116:119], a[236:239], v[28:31], v[116:119]
  v_mfma_f32_16x16x32_bf16 v[120:123], a[236:239], v[32:35], v[120:123]
  ds_read_b64_tr_b16 a[236:237], v41 offset:4096
  ds_read_b64_tr_b16 a[238:239], v41 offset:6144
  s_waitcnt lgkmcnt(0)
  v_mfma_f32_16x16x32_bf16 v[136:139], a[236:239], v[24:27], v[136:139]
  v_mfma_f32_16x16x32_bf16 v[140:143], a[236:239], v[28:31], v[140:143]
  v_mfma_f32_16x16x32_bf16 v[144:147], a[236:239], v[32:35], v[144:147]
  ds_read_b64_tr_b16 a[236:237], v38 offset:8192
  ds_read_b64_tr_b16 a[238:239], v38 offset:10240
  s_waitcnt lgkmcnt(0)
  v_mfma_f32_16x16x32_bf16 v[160:163], a[236:239], v[24:27], v[160:163]
  v_mfma_f32_16x16x32_bf16 v[164:167], a[236:239], v[28:31], v[164:167]
  v_mfma_f32_16x16x32_bf16 v[168:171], a[236:239], v[32:35], v[168:171]
  ds_read_b64_tr_b16 a[236:237], v39 offset:8192
  ds_read_b64_tr_b16 a[238:239], v39 offset:10240
  s_waitcnt lgkmcnt(0)
  v_mfma_f32_16x16x32_bf16 v[184:187], a[236:239], v[24:27], v[184:187]
  v_mfma_f32_16x16x32_bf16 v[188:191], a[236:239], v[28:31], v[188:191]
  v_mfma_f32_16x16x32_bf16 v[192:195], a[236:239], v[32:35], v[192:195]
  ds_read_b64_tr_b16 a[236:237], v40 offset:8192
  ds_read_b64_tr_b16 a[238:239], v40 offset:10240
  s_waitcnt lgkmcnt(0)
  v_mfma_f32_16x16x32_bf16 v[208:211], a[236:239], v[24:27], v[208:211]
  v_mfma_f32_16x16x32_bf16 v[212:215], a[236:239], v[28:31], v[212:215]
  v_mfma_f32_16x16x32_bf16 v[216:219], a[236:239], v[32:35], v[216:219]
  ds_read_b64_tr_b16 a[236:237], v41 offset:8192
  ds_read_b64_tr_b16 a[238:239], v41 offset:10240
  s_waitcnt lgkmcnt(0)
  v_mfma_f32_16x16x32_bf16 v[232:235], a[236:239], v[24:27], v[232:235]
  v_mfma_f32_16x16x32_bf16 v[236:239], a[236:239], v[28:31], v[236:239]
  v_mfma_f32_16x16x32_bf16 v[240:243], a[236:239], v[32:35], v[240:243]
  s_add_u32 s26, s26, 12288
  s_add_u32 s54, s54, 1
  s_cmp_lt_u32 s54, 16
  s_cbranch_scc1 L_fc0
  s_add_u32 s35, s51, 18432
  buffer_load_dwordx4 a[140:143], v36, s[8:11], s35 offen offset:0
  buffer_load_dwordx4 a[144:147], v36, s[8:11], s35 offen offset:64
  buffer_load_dwordx4 a[148:151], v36, s[8:11], s35 offen offset:128
  buffer_load_dwordx4 a[152:155], v36, s[8:11], s35 offen offset:192
  buffer_load_dwordx4 a[156:159], v36, s[8:11], s35 offen offset:256
  buffer_load_dwordx4 a[160:163], v36, s[8:11], s35 offen offset:320
  v_mov_b32 v12, 0xff800000
  v_mov_b32 v18, 0
  v_accvgpr_write_b32 a12, 0
  v_accvgpr_write_b32 a13, 0
  v_accvgpr_write_b32 a14, 0
  v_accvgpr_write_b32 a15, 0
  v_accvgpr_write_b32 a36, 0
  v_accvgpr_write_b32 a37, 0
  v_accvgpr_write_b32 a38, 0
  v_accvgpr_write_b32 a39, 0
  v_accvgpr_write_b32 a60, 0
  v_accvgpr_write_b32 a61, 0
  v_accvgpr_write_b32 a62, 0
  v_accvgpr_write_b32 a63, 0
  v_accvgpr_write_b32 a84, 0
  v_accvgpr_write_b32 a85, 0
  v_accvgpr_write_b32 a86, 0
  v_accvgpr_write_b32 a87, 0
  v_accvgpr_write_b32 a108, 0
  v_accvgpr_write_b32 a109, 0
  v_accvgpr_write_b32 a110, 0
  v_accvgpr_write_b32 a111, 0
  v_accvgpr_write_b32 a132, 0
  v_accvgpr_write_b32 a133, 0
  v_accvgpr_write_b32 a134, 0
  v_accvgpr_write_b32 a135, 0
  v_mov_b32 v124, 0
  v_mov_b32 v125, 0
  v_mov_b32 v126, 0
  v_mov_b32 v127, 0
  v_mov_b32 v148, 0
  v_mov_b32 v149, 0
  v_mov_b32 v150, 0
  v_mov_b32 v151, 0
  v_mov_b32 v172, 0
  v_mov_b32 v173, 0
  v_mov_b32 v174, 0
  v_mov_b32 v175, 0
  v_mov_b32 v196, 0
  v_mov_b32 v197, 0
  v_mov_b32 v198, 0
  v_mov_b32 v199, 0
  v_mov_b32 v220, 0
  v_mov_b32 v221, 0
  v_mov_b32 v222, 0
  v_mov_b32 v223, 0
  v_mov_b32 v244, 0
  v_mov_b32 v245, 0
  v_mov_b32 v246, 0
  v_mov_b32 v247, 0
  s_add_u32 s35, s51, 24576
  buffer_load_dwordx4 a[164:167], v36, s[8:11], s35 offen offset:0
  buffer_load_dwordx4 a[168:171], v36, s[8:11], s35 offen offset:64
  buffer_load_dwordx4 a[172:175], v36, s[8:11], s35 offen offset:128
  buffer_load_dwordx4 a[176:179], v36, s[8:11], s35 offen offset:192
  buffer_load_dwordx4 a[180:183], v36, s[8:11], s35 offen offset:256
  buffer_load_dwordx4 a[184:187], v36, s[8:11], s35 offen offset:320
  v_mov_b32 v13, 0xff800000
  v_mov_b32 v19, 0
  v_accvgpr_write_b32 a16, 0
  v_accvgpr_write_b32 a17, 0
  v_accvgpr_write_b32 a18, 0
  v_accvgpr_write_b32 a19, 0
  v_accvgpr_write_b32 a40, 0
  v_accvgpr_write_b32 a41, 0
  v_accvgpr_write_b32 a42, 0
  v_accvgpr_write_b32 a43, 0
  v_accvgpr_write_b32 a64, 0
  v_accvgpr_write_b32 a65, 0
  v_accvgpr_write_b32 a66, 0
  v_accvgpr_write_b32 a67, 0
  v_accvgpr_write_b32 a88, 0
  v_accvgpr_write_b32 a89, 0
  v_accvgpr_write_b32 a90, 0
  v_accvgpr_write_b32 a91, 0
  v_accvgpr_write_b32 a112, 0
  v_accvgpr_write_b32 a113, 0
  v_accvgpr_write_b32 a114, 0
  v_accvgpr_write_b32 a115, 0
  v_accvgpr_write_b32 a136, 0
  v_accvgpr_write_b32 a137, 0
  v_accvgpr_write_b32 a138, 0
  v_accvgpr_write_b32 a139, 0
  v_mov_b32 v128, 0
  v_mov_b32 v129, 0
  v_mov_b32 v130, 0
  v_mov_b32 v131, 0
  v_mov_b32 v152, 0
  v_mov_b32 v153, 0
  v_mov_b32 v154, 0
  v_mov_b32 v155, 0
  v_mov_b32 v176, 0
  v_mov_b32 v177, 0
  v_mov_b32 v178, 0
  v_mov_b32 v179, 0
  v_mov_b32 v200, 0
  v_mov_b32 v201, 0
  v_mov_b32 v202, 0
  v_mov_b32 v203, 0
  v_mov_b32 v224, 0
  v_mov_b32 v225, 0
  v_mov_b32 v226, 0
  v_mov_b32 v227, 0
  v_mov_b32 v248, 0
  v_mov_b32 v249, 0
  v_mov_b32 v250, 0
  v_mov_b32 v251, 0
  s_add_u32 s35, s51, 30720
  buffer_load_dwordx4 a[188:191], v36, s[8:11], s35 offen offset:0
  buffer_load_dwordx4 a[192:195], v36, s[8:11], s35 offen offset:64
  buffer_load_dwordx4 a[196:199], v36, s[8:11], s35 offen offset:128
  buffer_load_dwordx4 a[200:203], v36, s[8:11], s35 offen offset:192
  buffer_load_dwordx4 a[204:207], v36, s[8:11], s35 offen offset:256
  buffer_load_dwordx4 a[208:211], v36, s[8:11], s35 offen offset:320
  v_mov_b32 v14, 0xff800000
  v_mov_b32 v20, 0
  v_accvgpr_write_b32 a20, 0
  v_accvgpr_write_b32 a21, 0
  v_accvgpr_write_b32 a22, 0
  v_accvgpr_write_b32 a23, 0
  v_accvgpr_write_b32 a44, 0
  v_accvgpr_write_b32 a45, 0
  v_accvgpr_write_b32 a46, 0
  v_accvgpr_write_b32 a47, 0
  v_accvgpr_write_b32 a68, 0
  v_accvgpr_write_b32 a69, 0
  v_accvgpr_write_b32 a70, 0
  v_accvgpr_write_b32 a71, 0
  v_accvgpr_write_b32 a92, 0
  v_accvgpr_write_b32 a93, 0
  v_accvgpr_write_b32 a94, 0
  v_accvgpr_write_b32 a95, 0
  v_accvgpr_write_b32 a116, 0
  v_accvgpr_write_b32 a117, 0
  v_accvgpr_write_b32 a118, 0
  v_accvgpr_write_b32 a119, 0
  v_mov_b32 v108, 0
  v_mov_b32 v109, 0
  v_mov_b32 v110, 0
  v_mov_b32 v111, 0
  v_mov_b32 v132, 0
  v_mov_b32 v133, 0
  v_mov_b32 v134, 0
  v_mov_b32 v135, 0
  v_mov_b32 v156, 0
  v_mov_b32 v157, 0
  v_mov_b32 v158, 0
  v_mov_b32 v159, 0
  v_mov_b32 v180, 0
  v_mov_b32 v181, 0
  v_mov_b32 v182, 0
  v_mov_b32 v183, 0
  v_mov_b32 v204, 0
  v_mov_b32 v205, 0
  v_mov_b32 v206, 0
  v_mov_b32 v207, 0
  v_mov_b32 v228, 0
  v_mov_b32 v229, 0
  v_mov_b32 v230, 0
  v_mov_b32 v231, 0
  v_mov_b32 v252, 0
  v_mov_b32 v253, 0
  v_mov_b32 v254, 0
  v_mov_b32 v255, 0
  s_mov_b32 s26, s34
  s_mov_b32 s54, 0
L_fa1:
  buffer_load_dwordx4 v[48:51], v36, s[12:15], s26 offen offset:0
  buffer_load_dwordx4 v[52:55], v37, s[12:15], s26 offen offset:0
  buffer_load_dwordx4 v[56:59], v36, s[12:15], s26 offen offset:64
  buffer_load_dwordx4 v[60:63], v37, s[12:15], s26 offen offset:64
  buffer_load_dwordx4 v[64:67], v36, s[12:15], s26 offen offset:128
  buffer_load_dwordx4 v[68:71], v37, s[12:15], s26 offen offset:128
  buffer_load_dwordx4 v[84:87], v36, s[12:15], s26 offen offset:192
  buffer_load_dwordx4 v[88:91], v37, s[12:15], s26 offen offset:192
  buffer_load_dwordx4 v[92:95], v36, s[12:15], s26 offen offset:256
  buffer_load_dwordx4 v[96:99], v37, s[12:15], s26 offen offset:256
  buffer_load_dwordx4 v[100:103], v36, s[12:15], s26 offen offset:320
  buffer_load_dwordx4 v[104:107], v37, s[12:15], s26 offen offset:320
  s_waitcnt vmcnt(0)
  v_mfma_f32_16x16x32_bf16 v[24:27], v[48:51], a[140:143], 0
  v_mfma_f32_16x16x32_bf16 v[28:31], v[48:51], a[164:167], 0
  v_mfma_f32_16x16x32_bf16 v[32:35], v[48:51], a[188:191], 0
  v_mfma_f32_16x16x32_bf16 v[72:75], v[52:55], a[140:143], 0
  v_mfma_f32_16x16x32_bf16 v[76:79], v[52:55], a[164:167], 0
  v_mfma_f32_16x16x32_bf16 v[80:83], v[52:55], a[188:191], 0
  v_mfma_f32_16x16x32_bf16 v[24:27], v[56:59], a[144:147], v[24:27]
  v_mfma_f32_16x16x32_bf16 v[28:31], v[56:59], a[168:171], v[28:31]
  v_mfma_f32_16x16x32_bf16 v[32:35], v[56:59], a[192:195], v[32:35]
  v_mfma_f32_16x16x32_bf16 v[72:75], v[60:63], a[144:147], v[72:75]
  v_mfma_f32_16x16x32_bf16 v[76:79], v[60:63], a[168:171], v[76:79]
  v_mfma_f32_16x16x32_bf16 v[80:83], v[60:63], a[192:195], v[80:83]
  v_mfma_f32_16x16x32_bf16 v[24:27], v[64:67], a[148:151], v[24:27]
  v_mfma_f32_16x16x32_bf16 v[28:31], v[64:67], a[172:175], v[28:31]
  v_mfma_f32_16x16x32_bf16 v[32:35], v[64:67], a[196:199], v[32:35]
  v_mfma_f32_16x16x32_bf16 v[72:75], v[68:71], a[148:151], v[72:75]
  v_mfma_f32_16x16x32_bf16 v[76:79], v[68:71], a[172:175], v[76:79]
  v_mfma_f32_16x16x32_bf16 v[80:83], v[68:71], a[196:199], v[80:83]
  v_mfma_f32_16x16x32_bf16 v[24:27], v[84:87], a[152:155], v[24:27]
  v_mfma_f32_16x16x32_bf16 v[28:31], v[84:87], a[176:179], v[28:31]
  v_mfma_f32_16x16x32_bf16 v[32:35], v[84:87], a[200:203], v[32:35]
  v_mfma_f32_16x16x32_bf16 v[72:75], v[88:91], a[152:155], v[72:75]
  v_mfma_f32_16x16x32_bf16 v[76:79], v[88:91], a[176:179], v[76:79]
  v_mfma_f32_16x16x32_bf16 v[80:83], v[88:91], a[200:203], v[80:83]
  v_mfma_f32_16x16x32_bf16 v[24:27], v[92:95], a[156:159], v[24:27]
  v_mfma_f32_16x16x32_bf16 v[28:31], v[92:95], a[180:183], v[28:31]
  v_mfma_f32_16x16x32_bf16 v[32:35], v[92:95], a[204:207], v[32:35]
  v_mfma_f32_16x16x32_bf16 v[72:75], v[96:99], a[156:159], v[72:75]
  v_mfma_f32_16x16x32_bf16 v[76:79], v[96:99], a[180:183], v[76:79]
  v_mfma_f32_16x16x32_bf16 v[80:83], v[96:99], a[204:207], v[80:83]
  v_mfma_f32_16x16x32_bf16 v[24:27], v[100:103], a[160:163], v[24:27]
  v_mfma_f32_16x16x32_bf16 v[28:31], v[100:103], a[184:187], v[28:31]
  v_mfma_f32_16x16x32_bf16 v[32:35], v[100:103], a[208:211], v[32:35]
  v_mfma_f32_16x16x32_bf16 v[72:75], v[104:107], a[160:163], v[72:75]
  v_mfma_f32_16x16x32_bf16 v[76:79], v[104:107], a[184:187], v[76:79]
  v_mfma_f32_16x16x32_bf16 v[80:83], v[104:107], a[208:211], v[80:83]
  s_nop 7
  v_max3_f32 v12, v12, v24, v25
  v_max3_f32 v12, v12, v26, v27
  v_max3_f32 v12, v12, v72, v73
  v_max3_f32 v12, v12, v74, v75
  v_max3_f32 v13, v13, v28, v29
  v_max3_f32 v13, v13, v30, v31
  v_max3_f32 v13, v13, v76, v77
  v_max3_f32 v13, v13, v78, v79
  v_max3_f32 v14, v14, v32, v33
  v_max3_f32 v14, v14, v34, v35
  v_max3_f32 v14, v14, v80, v81
  v_max3_f32 v14, v14, v82, v83
  s_add_u32 s26, s26, 12288
  s_add_u32 s54, s54, 1
  s_cmp_lt_u32 s54, 16
  s_cbranch_scc1 L_fa1
  v_mov_b32 v44, v12
  v_mov_b32 v45, v13
  v_mov_b32 v46, v14
  v_permlane32_swap_b32 v44, v12
  v_permlane32_swap_b32 v45, v13
  v_permlane32_swap_b32 v46, v14
  v_max_f32 v12, v12, v44
  v_max_f32 v13, v13, v45
  v_max_f32 v14, v14, v46
  v_mov_b32 v44, v12
  v_mov_b32 v45, v13
  v_mov_b32 v46, v14
  v_permlane16_swap_b32 v44, v12
  v_permlane16_swap_b32 v45, v13
  v_permlane16_swap_b32 v46, v14
  v_max_f32 v12, v12, v44
  v_max_f32 v13, v13, v45
  v_max_f32 v14, v14, v46
  v_mov_b32 v44, 0x40c00000
  v_fma_f32 v12, v12, s31, v44
  v_fma_f32 v13, v13, s31, v44
  v_fma_f32 v14, v14, s31, v44
  s_mov_b32 s26, s34
  s_mov_b32 s54, 0
L_fc1:
  buffer_load_dwordx4 v[48:51], v36, s[12:15], s26 offen offset:0
  buffer_load_dwordx4 v[52:55], v37, s[12:15], s26 offen offset:0
  buffer_load_dwordx4 v[56:59], v36, s[12:15], s26 offen offset:64
  buffer_load_dwordx4 v[60:63], v37, s[12:15], s26 offen offset:64
  buffer_load_dwordx4 v[64:67], v36, s[12:15], s26 offen offset:128
  buffer_load_dwordx4 v[68:71], v37, s[12:15], s26 offen offset:128
  buffer_load_dwordx4 v[84:87], v36, s[12:15], s26 offen offset:192
  buffer_load_dwordx4 v[88:91], v37, s[12:15], s26 offen offset:192
  buffer_load_dwordx4 v[92:95], v36, s[12:15], s26 offen offset:256
  buffer_load_dwordx4 v[96:99], v37, s[12:15], s26 offen offset:256
  buffer_load_dwordx4 v[100:103], v36, s[12:15], s26 offen offset:320
  buffer_load_dwordx4 v[104:107], v37, s[12:15], s26 offen offset:320
  s_add_u32 s35, s26, 0
  s_add_u32 m0, s36, 0
  s_nop 0
  buffer_load_dwordx4 v8, s[16:19], s35 offen offset:0 nt lds
  s_add_u32 m0, s36, 3968
  s_nop 0
  buffer_load_dwordx4 v8, s[16:19], s35 offen offset:128 nt lds
  s_add_u32 m0, s36, 7936
  s_nop 0
  buffer_load_dwordx4 v8, s[16:19], s35 offen offset:256 nt lds
  s_add_u32 s35, s26, 3072
  s_add_u32 m0, s36, 1024
  s_nop 0
  buffer_load_dwordx4 v23, s[16:19], s35 offen offset:0 nt lds
  s_add_u32 m0, s36, 4992
  s_nop 0
  buffer_load_dwordx4 v23, s[16:19], s35 offen offset:128 nt lds
  s_add_u32 m0, s36, 8960
  s_nop 0
  buffer_load_dwordx4 v23, s[16:19], s35 offen offset:256 nt lds
  s_add_u32 s35, s26, 6144
  s_add_u32 m0, s36, 2048
  s_nop 0
  buffer_load_dwordx4 v8, s[16:19], s35 offen offset:0 nt lds
  s_add_u32 m0, s36, 6016
  s_nop 0
  buffer_load_dwordx4 v8, s[16:19], s35 offen offset:128 nt lds
  s_add_u32 m0, s36, 9984
  s_nop 0
  buffer_load_dwordx4 v8, s[16:19], s35 offen offset:256 nt lds
  s_add_u32 s35, s26, 9216
  s_add_u32 m0, s36, 3072
  s_nop 0
  buffer_load_dwordx4 v23, s[16:19], s35 offen offset:0 nt lds
  s_add_u32 m0, s36, 7040
  s_nop 0
  buffer_load_dwordx4 v23, s[16:19], s35 offen offset:128 nt lds
  s_add_u32 m0, s36, 11008
  s_nop 0
  buffer_load_dwordx4 v23, s[16:19], s35 offen offset:256 nt lds
  s_waitcnt vmcnt(0)
  v_mfma_f32_16x16x32_bf16 v[24:27], v[48:51], a[140:143], 0
  v_mfma_f32_16x16x32_bf16 v[28:31], v[48:51], a[164:167], 0
  v_mfma_f32_16x16x32_bf16 v[32:35], v[48:51], a[188:191], 0
  v_mfma_f32_16x16x32_bf16 v[72:75], v[52:55], a[140:143], 0
  v_mfma_f32_16x16x32_bf16 v[76:79], v[52:55], a[164:167], 0
  v_mfma_f32_16x16x32_bf16 v[80:83], v[52:55], a[188:191], 0
  v_mfma_f32_16x16x32_bf16 v[24:27], v[56:59], a[144:147], v[24:27]
  v_mfma_f32_16x16x32_bf16 v[28:31], v[56:59], a[168:171], v[28:31]
  v_mfma_f32_16x16x32_bf16 v[32:35], v[56:59], a[192:195], v[32:35]
  v_mfma_f32_16x16x32_bf16 v[72:75], v[60:63], a[144:147], v[72:75]
  v_mfma_f32_16x16x32_bf16 v[76:79], v[60:63], a[168:171], v[76:79]
  v_mfma_f32_16x16x32_bf16 v[80:83], v[60:63], a[192:195], v[80:83]
  v_mfma_f32_16x16x32_bf16 v[24:27], v[64:67], a[148:151], v[24:27]
  v_mfma_f32_16x16x32_bf16 v[28:31], v[64:67], a[172:175], v[28:31]
  v_mfma_f32_16x16x32_bf16 v[32:35], v[64:67], a[196:199], v[32:35]
  v_mfma_f32_16x16x32_bf16 v[72:75], v[68:71], a[148:151], v[72:75]
  v_mfma_f32_16x16x32_bf16 v[76:79], v[68:71], a[172:175], v[76:79]
  v_mfma_f32_16x16x32_bf16 v[80:83], v[68:71], a[196:199], v[80:83]
  v_mfma_f32_16x16x32_bf16 v[24:27], v[84:87], a[152:155], v[24:27]
  v_mfma_f32_16x16x32_bf16 v[28:31], v[84:87], a[176:179], v[28:31]
  v_mfma_f32_16x16x32_bf16 v[32:35], v[84:87], a[200:203], v[32:35]
  v_mfma_f32_16x16x32_bf16 v[72:75], v[88:91], a[152:155], v[72:75]
  v_mfma_f32_16x16x32_bf16 v[76:79], v[88:91], a[176:179], v[76:79]
  v_mfma_f32_16x16x32_bf16 v[80:83], v[88:91], a[200:203], v[80:83]
  v_mfma_f32_16x16x32_bf16 v[24:27], v[92:95], a[156:159], v[24:27]
  v_mfma_f32_16x16x32_bf16 v[28:31], v[92:95], a[180:183], v[28:31]
  v_mfma_f32_16x16x32_bf16 v[32:35], v[92:95], a[204:207], v[32:35]
  v_mfma_f32_16x16x32_bf16 v[72:75], v[96:99], a[156:159], v[72:75]
  v_mfma_f32_16x16x32_bf16 v[76:79], v[96:99], a[180:183], v[76:79]
  v_mfma_f32_16x16x32_bf16 v[80:83], v[96:99], a[204:207], v[80:83]
  v_mfma_f32_16x16x32_bf16 v[24:27], v[100:103], a[160:163], v[24:27]
  v_mfma_f32_16x16x32_bf16 v[28:31], v[100:103], a[184:187], v[28:31]
  v_mfma_f32_16x16x32_bf16 v[32:35], v[100:103], a[208:211], v[32:35]
  v_mfma_f32_16x16x32_bf16 v[72:75], v[104:107], a[160:163], v[72:75]
  v_mfma_f32_16x16x32_bf16 v[76:79], v[104:107], a[184:187], v[76:79]
  v_mfma_f32_16x16x32_bf16 v[80:83], v[104:107], a[208:211], v[80:83]
  s_nop 7
  v_fma_f32 v24, v24, s30, v12
  v_fma_f32 v25, v25, s30, v12
  v_fma_f32 v26, v26, s30, v12
  v_fma_f32 v27, v27, s30, v12
  v_fma_f32 v72, v72, s30, v12
  v_fma_f32 v73, v73, s30, v12
  v_fma_f32 v74, v74, s30, v12
  v_fma_f32 v75, v75, s30, v12
  v_fma_f32 v28, v28, s30, v13
  v_fma_f32 v29, v29, s30, v13
  v_fma_f32 v30, v30, s30, v13
  v_fma_f32 v31, v31, s30, v13
  v_fma_f32 v76, v76, s30, v13
  v_fma_f32 v77, v77, s30, v13
  v_fma_f32 v78, v78, s30, v13
  v_fma_f32 v79, v79, s30, v13
  v_fma_f32 v32, v32, s30, v14
  v_fma_f32 v33, v33, s30, v14
  v_fma_f32 v34, v34, s30, v14
  v_fma_f32 v35, v35, s30, v14
  v_fma_f32 v80, v80, s30, v14
  v_fma_f32 v81, v81, s30, v14
  v_fma_f32 v82, v82, s30, v14
  v_fma_f32 v83, v83, s30, v14
  v_exp_f32 v24, v24
  v_exp_f32 v25, v25
  v_exp_f32 v26, v26
  v_exp_f32 v27, v27
  v_exp_f32 v72, v72
  v_exp_f32 v73, v73
  v_exp_f32 v74, v74
  v_exp_f32 v75, v75
  v_exp_f32 v28, v28
  v_exp_f32 v29, v29
  v_exp_f32 v30, v30
  v_exp_f32 v31, v31
  v_exp_f32 v76, v76
  v_exp_f32 v77, v77
  v_exp_f32 v78, v78
  v_exp_f32 v79, v79
  v_exp_f32 v32, v32
  v_exp_f32 v33, v33
  v_exp_f32 v34, v34
  v_exp_f32 v35, v35
  v_exp_f32 v80, v80
  v_exp_f32 v81, v81
  v_exp_f32 v82, v82
  v_exp_f32 v83, v83
  s_nop 0
  v_add_f32 v18, v18, v24
  v_add_f32 v18, v18, v25
  v_add_f32 v18, v18, v26
  v_add_f32 v18, v18, v27
  v_add_f32 v18, v18, v72
  v_add_f32 v18, v18, v73
  v_add_f32 v18, v18, v74
  v_add_f32 v18, v18, v75
  v_add_f32 v19, v19, v28
  v_add_f32 v19, v19, v29
  v_add_f32 v19, v19, v30
  v_add_f32 v19, v19, v31
  v_add_f32 v19, v19, v76
  v_add_f32 v19, v19, v77
  v_add_f32 v19, v19, v78
  v_add_f32 v19, v19, v79
  v_add_f32 v20, v20, v32
  v_add_f32 v20, v20, v33
  v_add_f32 v20, v20, v34
  v_add_f32 v20, v20, v35
  v_add_f32 v20, v20, v80
  v_add_f32 v20, v20, v81
  v_add_f32 v20, v20, v82
  v_add_f32 v20, v20, v83
  v_cvt_pk_bf16_f32 v24, v24, v25
  v_cvt_pk_bf16_f32 v25, v26, v27
  v_cvt_pk_bf16_f32 v26, v72, v73
  v_cvt_pk_bf16_f32 v27, v74, v75
  v_cvt_pk_bf16_f32 v28, v28, v29
  v_cvt_pk_bf16_f32 v29, v30, v31
  v_cvt_pk_bf16_f32 v30, v76, v77
  v_cvt_pk_bf16_f32 v31, v78, v79
  v_cvt_pk_bf16_f32 v32, v32, v33
  v_cvt_pk_bf16_f32 v33, v34, v35
  v_cvt_pk_bf16_f32 v34, v80, v81
  v_cvt_pk_bf16_f32 v35, v82, v83
  ds_read_b64_tr_b16 a[236:237], v38 offset:0
  ds_read_b64_tr_b16 a[238:239], v38 offset:2048
  s_waitcnt lgkmcnt(0)
  v_mfma_f32_16x16x32_bf16 a[12:15], a[236:239], v[24:27], a[12:15]
  v_mfma_f32_16x16x32_bf16 a[16:19], a[236:239], v[28:31], a[16:19]
  v_mfma_f32_16x16x32_bf16 a[20:23], a[236:239], v[32:35], a[20:23]
  ds_read_b64_tr_b16 a[236:237], v39 offset:0
  ds_read_b64_tr_b16 a[238:239], v39 offset:2048
  s_waitcnt lgkmcnt(0)
  v_mfma_f32_16x16x32_bf16 a[36:39], a[236:239], v[24:27], a[36:39]
  v_mfma_f32_16x16x32_bf16 a[40:43], a[236:239], v[28:31], a[40:43]
  v_mfma_f32_16x16x32_bf16 a[44:47], a[236:239], v[32:35], a[44:47]
  ds_read_b64_tr_b16 a[236:237], v40 offset:0
  ds_read_b64_tr_b16 a[238:239], v40 offset:2048
  s_waitcnt lgkmcnt(0)
  v_mfma_f32_16x16x32_bf16 a[60:63], a[236:239], v[24:27], a[60:63]
  v_mfma_f32_16x16x32_bf16 a[64:67], a[236:239], v[28:31], a[64:67]
  v_mfma_f32_16x16x32_bf16 a[68:71], a[236:239], v[32:35], a[68:71]
  ds_read_b64_tr_b16 a[236:237], v41 offset:0
  ds_read_b64_tr_b16 a[238:239], v41 offset:2048
  s_waitcnt lgkmcnt(0)
  v_mfma_f32_16x16x32_bf16 a[84:87], a[236:239], v[24:27], a[84:87]
  v_mfma_f32_16x16x32_bf16 a[88:91], a[236:239], v[28:31], a[88:91]
  v_mfma_f32_16x16x32_bf16 a[92:95], a[236:239], v[32:35], a[92:95]
  ds_read_b64_tr_b16 a[236:237], v38 offset:4096
  ds_read_b64_tr_b16 a[238:239], v38 offset:6144
  s_waitcnt lgkmcnt(0)
  v_mfma_f32_16x16x32_bf16 a[108:111], a[236:239], v[24:27], a[108:111]
  v_mfma_f32_16x16x32_bf16 a[112:115], a[236:239], v[28:31], a[112:115]
  v_mfma_f32_16x16x32_bf16 a[116:119], a[236:239], v[32:35], a[116:119]
  ds_read_b64_tr_b16 a[236:237], v39 offset:4096
  ds_read_b64_tr_b16 a[238:239], v39 offset:6144
  s_waitcnt lgkmcnt(0)
  v_mfma_f32_16x16x32_bf16 a[132:135], a[236:239], v[24:27], a[132:135]
  v_mfma_f32_16x16x32_bf16 a[136:139], a[236:239], v[28:31], a[136:139]
  v_mfma_f32_16x16x32_bf16 v[108:111], a[236:239], v[32:35], v[108:111]
  ds_read_b64_tr_b16 a[236:237], v40 offset:4096
  ds_read_b64_tr_b16 a[238:239], v40 offset:6144
  s_waitcnt lgkmcnt(0)
  v_mfma_f32_16x16x32_bf16 v[124:127], a[236:239], v[24:27], v[124:127]
  v_mfma_f32_16x16x32_bf16 v[128:131], a[236:239], v[28:31], v[128:131]
  v_mfma_f32_16x16x32_bf16 v[132:135], a[236:239], v[32:35], v[132:135]
  ds_read_b64_tr_b16 a[236:237], v41 offset:4096
  ds_read_b64_tr_b16 a[238:239], v41 offset:6144
  s_waitcnt lgkmcnt(0)
  v_mfma_f32_16x16x32_bf16 v[148:151], a[236:239], v[24:27], v[148:151]
  v_mfma_f32_16x16x32_bf16 v[152:155], a[236:239], v[28:31], v[152:155]
  v_mfma_f32_16x16x32_bf16 v[156:159], a[236:239], v[32:35], v[156:159]
  ds_read_b64_tr_b16 a[236:237], v38 offset:8192
  ds_read_b64_tr_b16 a[238:239], v38 offset:10240
  s_waitcnt lgkmcnt(0)
  v_mfma_f32_16x16x32_bf16 v[172:175], a[236:239], v[24:27], v[172:175]
  v_mfma_f32_16x16x32_bf16 v[176:179], a[236:239], v[28:31], v[176:179]
  v_mfma_f32_16x16x32_bf16 v[180:183], a[236:239], v[32:35], v[180:183]
  ds_read_b64_tr_b16 a[236:237], v39 offset:8192
  ds_read_b64_tr_b16 a[238:239], v39 offset:10240
  s_waitcnt lgkmcnt(0)
  v_mfma_f32_16x16x32_bf16 v[196:199], a[236:239], v[24:27], v[196:199]
  v_mfma_f32_16x16x32_bf16 v[200:203], a[236:239], v[28:31], v[200:203]
  v_mfma_f32_16x16x32_bf16 v[204:207], a[236:239], v[32:35], v[204:207]
  ds_read_b64_tr_b16 a[236:237], v40 offset:8192
  ds_read_b64_tr_b16 a[238:239], v40 offset:10240
  s_waitcnt lgkmcnt(0)
  v_mfma_f32_16x16x32_bf16 v[220:223], a[236:239], v[24:27], v[220:223]
  v_mfma_f32_16x16x32_bf16 v[224:227], a[236:239], v[28:31], v[224:227]
  v_mfma_f32_16x16x32_bf16 v[228:231], a[236:239], v[32:35], v[228:231]
  ds_read_b64_tr_b16 a[236:237], v41 offset:8192
  ds_read_b64_tr_b16 a[238:239], v41 offset:10240
  s_waitcnt lgkmcnt(0)
  v_mfma_f32_16x16x32_bf16 v[244:247], a[236:239], v[24:27], v[244:247]
  v_mfma_f32_16x16x32_bf16 v[248:251], a[236:239], v[28:31], v[248:251]
  v_mfma_f32_16x16x32_bf16 v[252:255], a[236:239], v[32:35], v[252:255]
  s_add_u32 s26, s26, 12288
  s_add_u32 s54, s54, 1
  s_cmp_lt_u32 s54, 16
  s_cbranch_scc1 L_fc1
  v_mov_b32 v72, v15
  v_mov_b32 v73, v16
  v_mov_b32 v74, v17
  v_mov_b32 v75, v18
  v_mov_b32 v76, v19
  v_mov_b32 v77, v20
  v_permlane32_swap_b32 v72, v15
  v_permlane32_swap_b32 v73, v16
  v_permlane32_swap_b32 v74, v17
  v_permlane32_swap_b32 v75, v18
  v_permlane32_swap_b32 v76, v19
  v_permlane32_swap_b32 v77, v20
  v_add_f32 v15, v15, v72
  v_add_f32 v16, v16, v73
  v_add_f32 v17, v17, v74
  v_add_f32 v18, v18, v75
  v_add_f32 v19, v19, v76
  v_add_f32 v20, v20, v77
  v_mov_b32 v72, v15
  v_mov_b32 v73, v16
  v_mov_b32 v74, v17
  v_mov_b32 v75, v18
  v_mov_b32 v76, v19
  v_mov_b32 v77, v20
  v_permlane16_swap_b32 v72, v15
  v_permlane16_swap_b32 v73, v16
  v_permlane16_swap_b32 v74, v17
  v_permlane16_swap_b32 v75, v18
  v_permlane16_swap_b32 v76, v19
  v_permlane16_swap_b32 v77, v20
  v_add_f32 v15, v15, v72
  v_add_f32 v16, v16, v73
  v_add_f32 v17, v17, v74
  v_add_f32 v18, v18, v75
  v_add_f32 v19, v19, v76
  v_add_f32 v20, v20, v77
  v_rcp_f32 v96, v15
  v_rcp_f32 v97, v16
  v_rcp_f32 v98, v17
  v_rcp_f32 v99, v18
  v_rcp_f32 v100, v19
  v_rcp_f32 v101, v20
  v_mbcnt_lo_u32_b32 v30, -1, 0
  v_mbcnt_hi_u32_b32 v30, -1, v30
  v_and_b32 v31, 15, v30
  v_lshrrev_b32 v32, 4, v30
  v_mul_u32_u24 v31, 144, v31
  v_lshlrev_b32 v32, 3, v32
  v_add3_u32 v102, v31, v32, s50
  v_lshrrev_b32 v31, 3, v30
  v_and_b32 v33, 7, v30
  v_lshlrev_b32 v33, 4, v33
  v_mul_u32_u24 v32, 144, v31
  v_add3_u32 v103, v32, v33, s50
  v_mul_u32_u24 v31, 384, v31
  v_add_u32 v104, v33, v31
  s_branch L_epi
.section .rodata,"a"
.p2align 6
.amdhsa_kernel standalone__mha_softmax__near_ridge_kernel
  .amdhsa_next_free_vgpr 512
  .amdhsa_next_free_sgpr 96
  .amdhsa_accum_offset 256
  .amdhsa_group_segment_fixed_size 0
  .amdhsa_kernarg_size 48
  .amdhsa_user_sgpr_count 2
  .amdhsa_user_sgpr_kernarg_segment_ptr 1
  .amdhsa_system_sgpr_workgroup_id_x 1
.end_amdhsa_kernel
```
